```python
import torch

def _softmax(x, axis=-1):
    return torch.softmax(x, dim=axis)
def _gelu(x):
    return torch.nn.functional.gelu(x, approximate="tanh")
def _silu(x):
    return torch.nn.functional.silu(x)
def _sigmoid(x):
    return torch.sigmoid(x)
def _layernorm(x, axis=-1, eps=1e-5):
    m = x.mean(dim=axis, keepdim=True)
    v = x.var(dim=axis, keepdim=True, unbiased=False)
    return (x - m) / torch.sqrt(v + eps)
def _scatter_add(tgt, idx, src, axis=0):
    return tgt.clone().index_add_(axis, idx, src)
def _segment_sum(src, seg, n):
    out = torch.zeros((n,) + src.shape[1:], dtype=src.dtype)
    return out.index_add_(0, seg, src)
def _pad(x, pw):
    flat = tuple(v for pair in reversed(pw) for v in pair)
    return torch.nn.functional.pad(x, flat)

kernel_name = 'parallel_sum__spectral_gfnet__glu_gated_swiglu__prompt'

def setup_inputs():

    _w = (lambda a: (lambda t: t.to(torch.bfloat16) if t.is_floating_point() else t)(torch.as_tensor(a)))
    def _A_setup():
        B, S, D = 1, 2048, 512
        Df = D // 2 + 1
        return {
            "x": _w((lambda *s: torch.randn(*s, dtype=torch.bfloat16) * 0.05)(B, S, D)),
            "w_r": _w((lambda *s: torch.randn(*s, dtype=torch.bfloat16) * 0.4)(S, Df) * 0.02),
            "w_i": _w((lambda *s: torch.randn(*s, dtype=torch.bfloat16) * 0.4)(S, Df) * 0.02),
        }
    _A_in = _A_setup()

    def _B_setup():
        B, S, D, F = 1, 2048, 512, 1792
        return {
            "x": _w((lambda *s: torch.randn(*s, dtype=torch.bfloat16) * 0.05)(B, S, D)),
            "w1": _w((lambda *s: torch.randn(*s, dtype=torch.bfloat16) * 0.2)(D, F) * (2.0 / D) ** 0.5),
            "w3": _w((lambda *s: torch.randn(*s, dtype=torch.bfloat16) * 0.2)(D, F) * (2.0 / D) ** 0.5),
            "w2": _w((lambda *s: torch.randn(*s, dtype=torch.bfloat16) * 0.2)(F, D) * (2.0 / F) ** 0.5),
        }
    _B_in = _B_setup()

    return {
        "A_x": _A_in["x"],
        "A_w_r": _A_in["w_r"],
        "A_w_i": _A_in["w_i"],
        "B_x": _B_in["x"],
        "B_w1": _B_in["w1"],
        "B_w3": _B_in["w3"],
        "B_w2": _B_in["w2"],
    }

def reference(A_x, A_w_r, A_w_i, B_x, B_w1, B_w3, B_w2):
    def _A_ref(x, w_r, w_i):
        B, S, D = x.shape
        X = (lambda x, axes=(-2,-1): torch.fft.rfft2(x.float(), dim=axes))(x, axes=(-2, -1))
        W = w_r + 1j * w_i
        X = X * W
        y = (lambda x, s, axes=(-2,-1): torch.fft.irfft2(x, s=s, dim=axes).to(torch.bfloat16))(X, (S, D), axes=(-2, -1))
        return y

    def _B_ref(x, w1, w3, w2):
        gate = torch.einsum("bsd,df->bsf", x, w1)
        up = torch.einsum("bsd,df->bsf", x, w3)
        h = _silu(gate) * up
        out = torch.einsum("bsf,fd->bsd", h, w2)
        return out

    x = A_x
    xn = _layernorm(x, axis=-1)
    return x + _A_ref(xn, A_w_r, A_w_i) + _B_ref(xn, B_w1, B_w3, B_w2)
```

```asm
; @launch grid=(256,1,1) block=(256,1,1) lds=163840
.amdgcn_target "amdgcn-amd-amdhsa--gfx950"
.text
.globl parallel_sum__spectral_gfnet__glu_gated_swiglu__prompt_kernel
.p2align 8
.type parallel_sum__spectral_gfnet__glu_gated_swiglu__prompt_kernel,@function
parallel_sum__spectral_gfnet__glu_gated_swiglu__prompt_kernel:
    s_cmp_ge_u32 s2, 256
    s_cbranch_scc1 L_end
    s_load_dwordx16 s[64:79], s[0:1], 0
    s_load_dwordx4 s[80:83], s[0:1], 64
    v_and_b32 v1, 63, v0
    v_lshrrev_b32 v76, 6, v0
    s_nop 0
    v_readfirstlane_b32 s40, v76
    s_and_b32 s56, s2, 7
    s_lshr_b32 s57, s2, 3
    s_and_b32 s41, s40, 1
    s_lshr_b32 s42, s40, 1
    s_and_b32 s43, s56, 1
    s_lshl_b32 s43, s43, 3
    s_and_b32 s58, s57, 7
    s_add_u32 s43, s43, s58
    s_lshr_b32 s45, s56, 1
    s_lshr_b32 s58, s57, 3
    s_mul_i32 s44, s45, 3
    s_add_u32 s44, s44, s58
    s_add_u32 s59, s45, 12
    s_cmp_eq_u32 s58, 3
    s_cselect_b32 s44, s59, s44
    s_lshl_b32 s58, s56, 2
    s_and_b32 s59, s57, 3
    s_add_u32 s58, s58, s59
    s_lshr_b32 s84, s58, 1
    s_and_b32 s85, s58, 1
    s_lshr_b32 s86, s57, 2
    s_lshr_b32 s3, s43, 1
    s_lshr_b32 s58, s57, 3
    s_add_u32 s47, s3, s58
    s_and_b32 s47, s47, 3
    s_lshl_b32 s47, s47, 1
    s_and_b32 s89, s43, 1
    s_lshr_b32 s58, s56, 1
    s_add_u32 s58, s58, s56
    s_and_b32 s58, s58, 1
    s_add_u32 s47, s47, s58
    s_lshr_b32 s90, s2, 2
    s_and_b32 s91, s2, 3
    v_lshrrev_b32 v76, 3, v1
    v_and_b32 v77, 3, v76
    v_lshlrev_b32 v77, 15, v77
    v_lshrrev_b32 v78, 2, v76
    v_lshl_add_u32 v77, v78, 10, v77
    s_lshl_b32 s58, s40, 13
    v_add_u32 v77, s58, v77
    v_and_b32 v78, 7, v1
    v_lshrrev_b32 v79, 4, v1
    v_add_u32 v79, 0, v79
    v_and_b32 v79, 7, v79
    v_xor_b32 v79, v79, v78
    v_lshl_add_u32 v9, v79, 4, v77
    v_lshrrev_b32 v79, 4, v1
    v_add_u32 v79, 4, v79
    v_and_b32 v79, 7, v79
    v_xor_b32 v79, v79, v78
    v_lshl_add_u32 v10, v79, 4, v77
    v_add_u32 v10, 1024, v10
    v_lshrrev_b32 v79, 4, v1
    v_add_u32 v79, 8, v79
    v_and_b32 v79, 7, v79
    v_xor_b32 v79, v79, v78
    v_lshl_add_u32 v11, v79, 4, v77
    v_add_u32 v11, 2048, v11
    v_lshrrev_b32 v79, 4, v1
    v_add_u32 v79, 12, v79
    v_and_b32 v79, 7, v79
    v_xor_b32 v79, v79, v78
    v_lshl_add_u32 v12, v79, 4, v77
    v_add_u32 v12, 3072, v12
    s_lshl_b32 s58, s40, 4
    v_add_u32 v76, s58, v76
    v_bfe_u32 v77, v1, 4, 1
    v_bfe_u32 v78, v1, 1, 2
    v_xor_b32 v77, v77, v78
    v_mul_u32_u24 v76, 3584, v76
    v_and_b32 v78, 1, v1
    v_lshl_add_u32 v76, v78, 4, v76
    v_lshl_add_u32 v13, v77, 5, v76
    v_add_u32 v14, 27648, v13
    v_xor_b32 v77, 2, v77
    v_lshl_add_u32 v15, v77, 5, v76
    v_add_u32 v16, 27648, v15
    s_lshl_b32 s58, s40, 12
    v_lshl_add_u32 v17, v1, 4, s58
    s_lshl_b32 s54, s40, 12
    s_lshl_b32 s55, s40, 11
    s_add_u32 s55, s55, 65536
    s_lshl_b32 s48, s43, 17
    s_lshl_b32 s49, s44, 8
    s_add_u32 s50, s49, 128
    s_lshl_b32 s58, s45, 7
    s_add_u32 s58, s58, 3072
    s_cmp_ge_u32 s44, 12
    s_cselect_b32 s50, s58, s50
    s_lshl_b32 s51, s45, 17
    s_add_u32 s51, s51, 0
    s_getpc_b64 s[28:29]
    s_add_u32 s28, s28, TABS@rel32@lo+4
    s_addc_u32 s29, s29, TABS@rel32@hi+12
    s_mov_b32 s30, 581632
    s_mov_b32 s31, 0x20000
    s_waitcnt lgkmcnt(0)
    s_load_dword s46, s[82:83], 0
    s_mov_b32 s4, s64
    s_mov_b32 s5, s65
    s_mov_b32 s6, 2097152
    s_mov_b32 s7, 0x20000
    s_mov_b32 s8, s72
    s_mov_b32 s9, s73
    s_mov_b32 s10, 1835008
    s_mov_b32 s11, 0x20000
    s_mov_b32 s12, s74
    s_mov_b32 s13, s75
    s_mov_b32 s14, 1835008
    s_mov_b32 s15, 0x20000
    s_cmp_ge_u32 s44, 12
    s_cbranch_scc1 L_typeB
    s_mov_b32 s32, s66
    s_mov_b32 s33, s67
    s_mov_b32 s34, 1052672
    s_mov_b32 s35, 0x20000
    s_mov_b32 s36, s68
    s_mov_b32 s37, s69
    s_mov_b32 s38, 1052672
    s_mov_b32 s39, 0x20000
    s_lshl_b32 s56, s43, 7
    s_lshl_b32 s57, s44, 3
    s_add_u32 s56, s56, s57
    s_lshl_b32 s57, s40, 1
    s_add_u32 s92, s56, s57
    s_lshl_b32 s56, s92, 10
    v_lshlrev_b32 v76, 4, v1
    buffer_load_dwordx4 v[40:43], v76, s[4:7], s56 offen offset:0
    buffer_load_dwordx4 v[44:47], v76, s[4:7], s56 offen offset:1024
    s_add_u32 s101, s47, 0
    s_and_b32 s101, s101, 7
    s_lshl_b32 s87, s101, 7
    s_add_u32 m0, s54, 0
    s_add_u32 s87, s48, s87
    buffer_load_dwordx4 v9, s[4:7], s87 offen offset:0 lds
    buffer_load_dwordx4 v10, s[4:7], s87 offen offset:1024 lds
    buffer_load_dwordx4 v11, s[4:7], s87 offen offset:2048 lds
    buffer_load_dwordx4 v12, s[4:7], s87 offen offset:3072 lds
    s_mul_i32 s88, s101, 229376
    s_add_u32 m0, s55, 0
    s_add_u32 s88, s49, s88
    buffer_load_dwordx4 v13, s[8:11], s88 offen offset:0 lds
    buffer_load_dwordx4 v14, s[8:11], s88 offen offset:1024 lds
    s_add_u32 m0, s55, 8192
    s_nop 0
    buffer_load_dwordx4 v15, s[12:15], s88 offen offset:0 lds
    buffer_load_dwordx4 v16, s[12:15], s88 offen offset:1024 lds
    s_mov_b32 s16, s76
    s_mov_b32 s17, s77
    s_mov_b32 s18, 1835008
    s_mov_b32 s19, 0x20000
    s_mov_b32 s24, s78
    s_mov_b32 s25, s79
    s_mov_b32 s26, 2097152
    s_mov_b32 s27, 0x20000
    s_mov_b32 s20, s82
    s_mov_b32 s21, s83
    s_mov_b32 s22, 20971520
    s_mov_b32 s23, 0x20000
    s_mov_b32 s68, s80
    s_mov_b32 s69, s81
    s_mov_b32 s70, 256
    s_mov_b32 s71, 0x20000
    s_mov_b32 s100, 100000
    v_and_b32 v76, 31, v1
    v_lshrrev_b32 v77, 5, v1
    v_bfe_u32 v78, v76, 1, 3
    v_xor_b32 v77, v77, v78
    v_lshlrev_b32 v77, 4, v77
    s_lshl_b32 s56, s41, 13
    v_lshl_add_u32 v76, v76, 7, s56
    v_xor_b32 v2, 0, v77
    v_add_u32 v2, v2, v76
    v_xor_b32 v3, 32, v77
    v_add_u32 v3, v3, v76
    v_xor_b32 v4, 64, v77
    v_add_u32 v4, v4, v76
    v_xor_b32 v5, 96, v77
    v_add_u32 v5, v5, v76
    v_bfe_u32 v76, v1, 4, 1
    v_bfe_u32 v77, v1, 2, 2
    v_lshrrev_b32 v78, 1, v77
    v_lshl_or_b32 v78, v76, 1, v78
    v_lshlrev_b32 v76, 13, v76
    v_lshl_add_u32 v76, v77, 7, v76
    v_lshrrev_b32 v77, 5, v1
    v_lshl_add_u32 v76, v77, 10, v76
    v_and_b32 v77, 3, v1
    v_lshl_add_u32 v76, v77, 3, v76
    v_add_u32 v76, 65536, v76
    s_lshl_b32 s56, s42, 1
    s_add_u32 s57, s56, 0
    v_xor_b32 v77, s57, v78
    v_lshl_add_u32 v6, v77, 5, v76
    s_add_u32 s57, s56, 1
    v_xor_b32 v77, s57, v78
    v_lshl_add_u32 v7, v77, 5, v76
    s_lshl_b32 s56, s42, 11
    s_add_u32 s56, s56, 65536
    v_lshl_add_u32 v8, v1, 4, s56
    s_mul_i32 s56, s41, 229376
    v_lshl_add_u32 v32, v1, 4, s56
    s_mul_i32 s52, s43, 458752
    s_add_u32 s52, s52, 8388608
    s_mul_i32 s56, s45, 28
    s_lshr_b32 s57, s2, 6
    s_lshl_b32 s57, s57, 2
    s_add_u32 s56, s56, s57
    s_lshl_b32 s57, s42, 1
    s_add_u32 s56, s56, s57
    s_lshl_b32 s56, s56, 10
    s_add_u32 s52, s52, s56
    v_and_b32 v76, 15, v1
    v_mul_u32_u24 v76, 528, v76
    v_bfe_u32 v77, v1, 4, 1
    v_lshl_add_u32 v76, v77, 3, v76
    v_lshrrev_b32 v77, 5, v1
    v_lshl_add_u32 v76, v77, 4, v76
    s_mul_i32 s56, s42, 16896
    s_lshl_b32 s57, s41, 8
    s_add_u32 s56, s56, s57
    v_add_u32 v33, s56, v76
    v_lshrrev_b32 v76, 5, v1
    v_mul_u32_u24 v76, 528, v76
    v_and_b32 v77, 31, v1
    v_lshl_add_u32 v76, v77, 4, v76
    s_mul_i32 s56, s40, 8448
    v_add_u32 v34, s56, v76
    v_lshrrev_b32 v76, 5, v1
    v_mul_u32_u24 v76, 8704, v76
    v_lshl_add_u32 v76, v77, 4, v76
    s_mul_i32 s56, s40, 139264
    v_add_u32 v35, s56, v76
    s_mul_i32 s53, s45, 557056
    s_lshl_b32 s56, s43, 9
    s_add_u32 s53, s53, s56
    s_add_u32 s53, s53, 3407872
    v_cmp_eq_u32 vcc, 0, v1
    v_mov_b32 v76, 0x7fffffff
    s_nop 0
    v_cndmask_b32 v22, v76, 0, vcc
    v_mov_b32 v36, 0x3f803f80
    v_mov_b32 v37, 0x3f803f80
    v_mov_b32 v38, 0x3f803f80
    v_mov_b32 v39, 0x3f803f80
    v_mov_b32 v25, 0
    v_mov_b32 v26, 0
    v_mov_b32 v27, 0
    v_mov_b32 v29, 0
    v_mov_b32 v30, 0
    v_mov_b32 v31, 0
    s_waitcnt lgkmcnt(0)
    s_mul_i32 s46, s46, 0x19660D
    s_add_u32 s46, s46, 0x3C6EF35F
    s_add_u32 s101, s47, 1
    s_and_b32 s101, s101, 7
    s_lshl_b32 s87, s101, 7
    s_add_u32 m0, s54, 16384
    s_add_u32 s87, s48, s87
    buffer_load_dwordx4 v9, s[4:7], s87 offen offset:0 lds
    buffer_load_dwordx4 v10, s[4:7], s87 offen offset:1024 lds
    buffer_load_dwordx4 v11, s[4:7], s87 offen offset:2048 lds
    buffer_load_dwordx4 v12, s[4:7], s87 offen offset:3072 lds
    s_mul_i32 s88, s101, 229376
    s_add_u32 m0, s55, 16384
    s_add_u32 s88, s49, s88
    buffer_load_dwordx4 v13, s[8:11], s88 offen offset:0 lds
    buffer_load_dwordx4 v14, s[8:11], s88 offen offset:1024 lds
    s_add_u32 m0, s55, 24576
    s_nop 0
    buffer_load_dwordx4 v15, s[12:15], s88 offen offset:0 lds
    buffer_load_dwordx4 v16, s[12:15], s88 offen offset:1024 lds
    s_waitcnt vmcnt(16)
    v_lshlrev_b32 v192, 16, v40
    v_and_b32 v193, 0xffff0000, v40
    v_lshlrev_b32 v200, 16, v44
    v_and_b32 v201, 0xffff0000, v44
    v_lshlrev_b32 v194, 16, v41
    v_and_b32 v195, 0xffff0000, v41
    v_lshlrev_b32 v202, 16, v45
    v_and_b32 v203, 0xffff0000, v45
    v_lshlrev_b32 v196, 16, v42
    v_and_b32 v197, 0xffff0000, v42
    v_lshlrev_b32 v204, 16, v46
    v_and_b32 v205, 0xffff0000, v46
    v_lshlrev_b32 v198, 16, v43
    v_and_b32 v199, 0xffff0000, v43
    v_lshlrev_b32 v206, 16, v47
    v_and_b32 v207, 0xffff0000, v47
    v_add_f32 v208, v192, v193
    v_mul_f32 v210, v192, v192
    v_add_f32 v209, v200, v201
    v_mul_f32 v211, v200, v200
    v_fma_f32 v210, v193, v193, v210
    v_fma_f32 v211, v201, v201, v211
    v_add_f32 v208, v208, v194
    v_fma_f32 v210, v194, v194, v210
    v_add_f32 v209, v209, v202
    v_fma_f32 v211, v202, v202, v211
    v_add_f32 v208, v208, v195
    v_fma_f32 v210, v195, v195, v210
    v_add_f32 v209, v209, v203
    v_fma_f32 v211, v203, v203, v211
    v_add_f32 v208, v208, v196
    v_fma_f32 v210, v196, v196, v210
    v_add_f32 v209, v209, v204
    v_fma_f32 v211, v204, v204, v211
    v_add_f32 v208, v208, v197
    v_fma_f32 v210, v197, v197, v210
    v_add_f32 v209, v209, v205
    v_fma_f32 v211, v205, v205, v211
    v_add_f32 v208, v208, v198
    v_fma_f32 v210, v198, v198, v210
    v_add_f32 v209, v209, v206
    v_fma_f32 v211, v206, v206, v211
    v_add_f32 v208, v208, v199
    v_fma_f32 v210, v199, v199, v210
    v_add_f32 v209, v209, v207
    v_fma_f32 v211, v207, v207, v211
    s_nop 1
    v_permlane32_swap_b32 v208, v209
    v_permlane32_swap_b32 v210, v211
    s_nop 0
    v_add_f32 v208, v208, v209
    v_add_f32 v210, v210, v211
    s_nop 1
    v_permlane16_swap_b32 v208, v210
    s_nop 1
    v_add_f32 v208, v208, v210
    s_nop 1
    v_add_f32_dpp v208, v208, v208 row_ror:8 row_mask:0xf bank_mask:0xf
    s_nop 1
    v_add_f32_dpp v208, v208, v208 row_ror:4 row_mask:0xf bank_mask:0xf
    s_nop 1
    v_add_f32_dpp v208, v208, v208 row_ror:2 row_mask:0xf bank_mask:0xf
    s_nop 1
    v_add_f32_dpp v208, v208, v208 row_ror:1 row_mask:0xf bank_mask:0xf
    v_mov_b32 v210, v208
    s_nop 1
    v_permlane16_swap_b32 v208, v210
    s_nop 1
    v_mul_f32 v208, 0x3b000000, v208
    v_mul_f32 v210, 0x3b000000, v210
    v_fma_f32 v210, -v208, v208, v210
    v_max_f32 v210, 0, v210
    v_cvt_pk_bf16_f32 v208, v208, v210
    v_and_b32 v210, 0xffff0000, v208
    v_add_f32 v210, 0x3727c5ac, v210
    v_cvt_pk_bf16_f32 v210, v210, v210
    v_and_b32 v210, 0xffff0000, v210
    v_sqrt_f32 v210, v210
    v_mov_b32 v212, 0xffff
    v_cvt_pk_bf16_f32 v210, v210, v210
    v_bfi_b32 v209, v212, v208, v210
    v_mov_b32 v210, s46
    v_and_b32 v212, 31, v1
    v_cmp_eq_u32 vcc, 0, v212
    v_lshrrev_b32 v212, 2, v1
    v_mov_b32 v213, 0x7fffffff
    s_lshl_b32 s93, s92, 3
    v_cndmask_b32 v212, v213, v212, vcc
    s_add_u32 s93, s93, 65536
    v_mov_b32 v208, v209
    v_mov_b32 v209, v210
    buffer_store_dwordx2 v[208:209], v212, s[20:23], s93 offen sc1
    s_waitcnt vmcnt(9)
    s_barrier
    ds_read_b128 a[0:3], v2 offset:0
    ds_read_b128 a[128:131], v2 offset:4096
    ds_read_b64_tr_b16 v[104:105], v6 offset:0
    ds_read_b64_tr_b16 v[106:107], v6 offset:512
    ds_read_b64_tr_b16 v[108:109], v7 offset:0
    ds_read_b64_tr_b16 v[110:111], v7 offset:512
    ds_read_b128 a[4:7], v3 offset:0
    ds_read_b128 a[132:135], v3 offset:4096
    ds_read_b64_tr_b16 v[112:113], v6 offset:2048
    ds_read_b64_tr_b16 v[114:115], v6 offset:2560
    ds_read_b64_tr_b16 v[116:117], v7 offset:2048
    ds_read_b64_tr_b16 v[118:119], v7 offset:2560
    s_waitcnt lgkmcnt(6)
    v_mfma_f32_32x32x16_bf16 v[128:143], v[104:107], a[0:3], 0
    ds_read_b128 a[8:11], v4 offset:0
    ds_read_b128 a[136:139], v4 offset:4096
    s_cmp_eq_u32 s89, 0
    s_cselect_b32 s94, s49, s50
    s_mul_i32 s93, s3, 229376
    s_add_u32 s93, s93, s94
    s_lshl_b32 s94, s40, 11
    s_add_u32 m0, s94, 131072
    s_nop 0
    buffer_load_dwordx4 v13, s[8:11], s93 offen offset:0 lds
    buffer_load_dwordx4 v14, s[8:11], s93 offen offset:1024 lds
    s_add_u32 m0, s94, 139264
    s_nop 0
    buffer_load_dwordx4 v15, s[12:15], s93 offen offset:0 lds
    buffer_load_dwordx4 v16, s[12:15], s93 offen offset:1024 lds
L_cs1d_A:
    v_mfma_f32_32x32x16_bf16 v[144:159], v[104:107], a[128:131], 0
    ds_read_b64_tr_b16 v[120:121], v6 offset:4096
    ds_read_b64_tr_b16 v[122:123], v6 offset:4608
    s_lshl_b32 s56, s40, 9
    s_add_u32 s56, s56, s90
    s_mul_i32 s56, s56, 514
    s_lshl_b32 s57, s91, 7
    s_add_u32 s56, s56, s57
    s_add_u32 s56, s56, 2
    v_lshrrev_b32 v77, 3, v1
    v_mul_u32_u24 v77, 32896, v77
    v_and_b32 v78, 7, v1
    v_lshl_add_u32 v77, v78, 4, v77
    buffer_load_dwordx4 v[48:51], v77, s[32:35], s56 offen
    buffer_load_dwordx4 v[52:55], v77, s[36:39], s56 offen
    v_mfma_f32_32x32x16_bf16 v[160:175], v[108:111], a[0:3], 0
    ds_read_b64_tr_b16 v[124:125], v7 offset:4096
    s_add_u32 s101, s47, 2
    s_and_b32 s101, s101, 7
    s_lshl_b32 s87, s101, 7
    s_add_u32 m0, s54, 32768
    s_add_u32 s87, s48, s87
    buffer_load_dwordx4 v9, s[4:7], s87 offen offset:0 lds
    v_mfma_f32_32x32x16_bf16 v[176:191], v[108:111], a[128:131], 0
    ds_read_b64_tr_b16 v[126:127], v7 offset:4608
    buffer_load_dwordx4 v10, s[4:7], s87 offen offset:1024 lds
    s_waitcnt lgkmcnt(6)
    v_mfma_f32_32x32x16_bf16 v[128:143], v[112:115], a[4:7], v[128:143]
    ds_read_b128 a[12:15], v5 offset:0
    ds_read_b128 a[140:143], v5 offset:4096
    buffer_load_dwordx4 v11, s[4:7], s87 offen offset:2048 lds
    v_mfma_f32_32x32x16_bf16 v[144:159], v[112:115], a[132:135], v[144:159]
    ds_read_b64_tr_b16 v[104:105], v6 offset:6144
    ds_read_b64_tr_b16 v[106:107], v6 offset:6656
    buffer_load_dwordx4 v12, s[4:7], s87 offen offset:3072 lds
    v_mfma_f32_32x32x16_bf16 v[160:175], v[116:119], a[4:7], v[160:175]
    ds_read_b64_tr_b16 v[108:109], v7 offset:6144
    s_mul_i32 s88, s101, 229376
    s_add_u32 m0, s55, 32768
    s_add_u32 s88, s49, s88
    buffer_load_dwordx4 v13, s[8:11], s88 offen offset:0 lds
    v_mfma_f32_32x32x16_bf16 v[176:191], v[116:119], a[132:135], v[176:191]
    ds_read_b64_tr_b16 v[110:111], v7 offset:6656
    buffer_load_dwordx4 v14, s[8:11], s88 offen offset:1024 lds
    s_waitcnt lgkmcnt(6)
    v_mfma_f32_32x32x16_bf16 v[128:143], v[120:123], a[8:11], v[128:143]
    s_add_u32 m0, s55, 40960
    s_nop 0
    buffer_load_dwordx4 v15, s[12:15], s88 offen offset:0 lds
    v_mfma_f32_32x32x16_bf16 v[144:159], v[120:123], a[136:139], v[144:159]
    s_waitcnt vmcnt(10) lgkmcnt(0)
    s_barrier
    ds_read_b128 a[16:19], v2 offset:16384
    ds_read_b128 a[144:147], v2 offset:20480
    buffer_load_dwordx4 v16, s[12:15], s88 offen offset:1024 lds
    v_mfma_f32_32x32x16_bf16 v[160:175], v[124:127], a[8:11], v[160:175]
    ds_read_b64_tr_b16 v[112:113], v6 offset:16384
    ds_read_b64_tr_b16 v[114:115], v6 offset:16896
    s_add_u32 s101, s47, 3
    s_and_b32 s101, s101, 7
    s_lshl_b32 s87, s101, 7
    s_add_u32 m0, s54, 49152
    s_add_u32 s87, s48, s87
    buffer_load_dwordx4 v9, s[4:7], s87 offen offset:0 lds
    v_mfma_f32_32x32x16_bf16 v[176:191], v[124:127], a[136:139], v[176:191]
    ds_read_b64_tr_b16 v[116:117], v7 offset:16384
    ds_read_b64_tr_b16 v[118:119], v7 offset:16896
    buffer_load_dwordx4 v10, s[4:7], s87 offen offset:1024 lds
    v_mfma_f32_32x32x16_bf16 v[128:143], v[104:107], a[12:15], v[128:143]
    ds_read_b128 a[20:23], v3 offset:16384
    ds_read_b128 a[148:151], v3 offset:20480
    buffer_load_dwordx4 v11, s[4:7], s87 offen offset:2048 lds
    v_mfma_f32_32x32x16_bf16 v[144:159], v[104:107], a[140:143], v[144:159]
    ds_read_b64_tr_b16 v[120:121], v6 offset:18432
    ds_read_b64_tr_b16 v[122:123], v6 offset:18944
    buffer_load_dwordx4 v12, s[4:7], s87 offen offset:3072 lds
    v_mfma_f32_32x32x16_bf16 v[160:175], v[108:111], a[12:15], v[160:175]
    ds_read_b64_tr_b16 v[124:125], v7 offset:18432
    s_mul_i32 s88, s101, 229376
    s_add_u32 m0, s55, 49152
    s_add_u32 s88, s49, s88
    buffer_load_dwordx4 v13, s[8:11], s88 offen offset:0 lds
    v_mfma_f32_32x32x16_bf16 v[176:191], v[108:111], a[140:143], v[176:191]
    ds_read_b64_tr_b16 v[126:127], v7 offset:18944
    buffer_load_dwordx4 v14, s[8:11], s88 offen offset:1024 lds
    s_waitcnt lgkmcnt(6)
    v_mfma_f32_32x32x16_bf16 v[128:143], v[112:115], a[16:19], v[128:143]
    ds_read_b128 a[24:27], v4 offset:16384
    ds_read_b128 a[152:155], v4 offset:20480
    s_add_u32 m0, s55, 57344
    s_nop 0
    buffer_load_dwordx4 v15, s[12:15], s88 offen offset:0 lds
    v_mfma_f32_32x32x16_bf16 v[144:159], v[112:115], a[144:147], v[144:159]
    ds_read_b64_tr_b16 v[104:105], v6 offset:20480
    ds_read_b64_tr_b16 v[106:107], v6 offset:20992
    buffer_load_dwordx4 v16, s[12:15], s88 offen offset:1024 lds
    v_mfma_f32_32x32x16_bf16 v[160:175], v[116:119], a[16:19], v[160:175]
    ds_read_b64_tr_b16 v[108:109], v7 offset:20480
    s_add_u32 s101, s47, 4
    s_and_b32 s101, s101, 7
    s_lshl_b32 s87, s101, 7
    s_add_u32 m0, s54, 0
    s_add_u32 s87, s48, s87
    buffer_load_dwordx4 v9, s[4:7], s87 offen offset:0 lds
    v_mfma_f32_32x32x16_bf16 v[176:191], v[116:119], a[144:147], v[176:191]
    ds_read_b64_tr_b16 v[110:111], v7 offset:20992
    buffer_load_dwordx4 v10, s[4:7], s87 offen offset:1024 lds
    s_waitcnt lgkmcnt(6)
    v_mfma_f32_32x32x16_bf16 v[128:143], v[120:123], a[20:23], v[128:143]
    ds_read_b128 a[28:31], v5 offset:16384
    ds_read_b128 a[156:159], v5 offset:20480
    buffer_load_dwordx4 v11, s[4:7], s87 offen offset:2048 lds
    v_mfma_f32_32x32x16_bf16 v[144:159], v[120:123], a[148:151], v[144:159]
    ds_read_b64_tr_b16 v[112:113], v6 offset:22528
    ds_read_b64_tr_b16 v[114:115], v6 offset:23040
    buffer_load_dwordx4 v12, s[4:7], s87 offen offset:3072 lds
    v_mfma_f32_32x32x16_bf16 v[160:175], v[124:127], a[20:23], v[160:175]
    ds_read_b64_tr_b16 v[116:117], v7 offset:22528
    s_mul_i32 s88, s101, 229376
    s_add_u32 m0, s55, 0
    s_add_u32 s88, s49, s88
    buffer_load_dwordx4 v13, s[8:11], s88 offen offset:0 lds
    v_mfma_f32_32x32x16_bf16 v[176:191], v[124:127], a[148:151], v[176:191]
    ds_read_b64_tr_b16 v[118:119], v7 offset:23040
    buffer_load_dwordx4 v14, s[8:11], s88 offen offset:1024 lds
    s_waitcnt lgkmcnt(6)
    v_mfma_f32_32x32x16_bf16 v[128:143], v[104:107], a[24:27], v[128:143]
    s_add_u32 m0, s55, 8192
    s_nop 0
    buffer_load_dwordx4 v15, s[12:15], s88 offen offset:0 lds
    v_mfma_f32_32x32x16_bf16 v[144:159], v[104:107], a[152:155], v[144:159]
    s_waitcnt vmcnt(15) lgkmcnt(0)
    s_barrier
    ds_read_b128 a[32:35], v2 offset:32768
    ds_read_b128 a[160:163], v2 offset:36864
    buffer_load_dwordx4 v16, s[12:15], s88 offen offset:1024 lds
    v_mfma_f32_32x32x16_bf16 v[160:175], v[108:111], a[24:27], v[160:175]
    ds_read_b64_tr_b16 v[120:121], v6 offset:32768
    ds_read_b64_tr_b16 v[122:123], v6 offset:33280
    s_add_u32 s101, s47, 5
    s_and_b32 s101, s101, 7
    s_lshl_b32 s87, s101, 7
    s_add_u32 m0, s54, 16384
    s_add_u32 s87, s48, s87
    buffer_load_dwordx4 v9, s[4:7], s87 offen offset:0 lds
    v_mfma_f32_32x32x16_bf16 v[176:191], v[108:111], a[152:155], v[176:191]
    ds_read_b64_tr_b16 v[124:125], v7 offset:32768
    ds_read_b64_tr_b16 v[126:127], v7 offset:33280
    buffer_load_dwordx4 v10, s[4:7], s87 offen offset:1024 lds
    s_mov_b32 s95, 1
    v_mov_b32 v76, v6
    s_cmp_eq_u32 s41, 0
    s_cbranch_scc1 L_cs1c_Aa
    v_mov_b32 v76, v7
L_cs1c_Aa:
    v_add_u32 v76, 65536, v76
    ds_read_b64_tr_b16 v[68:69], v76 offset:0
    ds_read_b64_tr_b16 v[70:71], v76 offset:512
    ds_read_b64_tr_b16 v[72:73], v76 offset:2048
    ds_read_b64_tr_b16 v[74:75], v76 offset:2560
    s_waitcnt lgkmcnt(0)
    v_mfma_f32_32x32x16_bf16 v[88:103], v[36:39], v[68:71], 0
    v_mfma_f32_32x32x16_bf16 v[88:103], v[36:39], v[72:75], v[88:103]
    ds_read_b64_tr_b16 v[68:69], v76 offset:4096
    ds_read_b64_tr_b16 v[70:71], v76 offset:4608
    ds_read_b64_tr_b16 v[72:73], v76 offset:6144
    ds_read_b64_tr_b16 v[74:75], v76 offset:6656
    s_waitcnt lgkmcnt(0)
    v_mfma_f32_32x32x16_bf16 v[88:103], v[36:39], v[68:71], v[88:103]
    v_mfma_f32_32x32x16_bf16 v[88:103], v[36:39], v[72:75], v[88:103]
L_cs1c_A:
    v_mfma_f32_32x32x16_bf16 v[128:143], v[112:115], a[28:31], v[128:143]
    ds_read_b128 a[36:39], v3 offset:32768
    ds_read_b128 a[164:167], v3 offset:36864
    buffer_load_dwordx4 v11, s[4:7], s87 offen offset:2048 lds
    s_cmp_eq_u32 s95, 0
    s_cbranch_scc1 L_csst_A_1
    s_lshl_b32 s93, s44, 3
    s_lshl_b32 s94, s42, 1
    s_add_u32 s93, s93, s94
    s_add_u32 s93, s93, s41
    s_lshl_b32 s94, s89, 2
    s_add_u32 s93, s93, s94
    s_lshl_b32 s93, s93, 3
    s_add_u32 s93, s93, s3
    s_lshl_b32 s93, s93, 8
    s_add_u32 s93, s93, 131072
    v_mov_b32 v89, s46
    v_lshlrev_b32 v76, 3, v1
    v_cmp_gt_u32 vcc, 32, v1
    v_mov_b32 v77, 0x7fffffff
    s_nop 0
    v_cndmask_b32 v76, v77, v76, vcc
    buffer_store_dwordx2 v[88:89], v76, s[20:23], s93 offen sc1
L_csst_A_1:
    v_mfma_f32_32x32x16_bf16 v[144:159], v[112:115], a[156:159], v[144:159]
    ds_read_b64_tr_b16 v[104:105], v6 offset:34816
    ds_read_b64_tr_b16 v[106:107], v6 offset:35328
    buffer_load_dwordx4 v12, s[4:7], s87 offen offset:3072 lds
    s_cmp_lg_u32 s40, 0
    s_cbranch_scc1 L_tp_A_0
    s_and_b32 s96, s43, 7
    s_lshl_b32 s96, s96, 6
    v_add_u32 v45, s96, v1
    v_mul_u32_u24 v45, 3584, v45
    buffer_load_dword v0, v45, s[8:11], s50 offen
L_tp_A_0:
    v_mfma_f32_32x32x16_bf16 v[160:175], v[116:119], a[28:31], v[160:175]
    ds_read_b64_tr_b16 v[108:109], v7 offset:34816
    s_mul_i32 s88, s101, 229376
    s_add_u32 m0, s55, 16384
    s_add_u32 s88, s49, s88
    buffer_load_dwordx4 v13, s[8:11], s88 offen offset:0 lds
    v_mfma_f32_32x32x16_bf16 v[176:191], v[116:119], a[156:159], v[176:191]
    ds_read_b64_tr_b16 v[110:111], v7 offset:35328
    buffer_load_dwordx4 v14, s[8:11], s88 offen offset:1024 lds
    s_waitcnt lgkmcnt(6)
    v_mfma_f32_32x32x16_bf16 v[128:143], v[120:123], a[32:35], v[128:143]
    ds_read_b128 a[40:43], v4 offset:32768
    ds_read_b128 a[168:171], v4 offset:36864
    s_add_u32 m0, s55, 24576
    s_nop 0
    buffer_load_dwordx4 v15, s[12:15], s88 offen offset:0 lds
    v_and_b32 v76, 7, v1
    v_mfma_f32_32x32x16_bf16 v[144:159], v[120:123], a[160:163], v[144:159]
    ds_read_b64_tr_b16 v[112:113], v6 offset:36864
    ds_read_b64_tr_b16 v[114:115], v6 offset:37376
    buffer_load_dwordx4 v16, s[12:15], s88 offen offset:1024 lds
    v_lshrrev_b32 v77, 3, v1
    s_lshl_b32 s93, s40, 1
    v_lshrrev_b32 v78, 2, v77
    v_mfma_f32_32x32x16_bf16 v[160:175], v[124:127], a[32:35], v[160:175]
    ds_read_b64_tr_b16 v[116:117], v7 offset:36864
    v_add_u32 v78, s93, v78
    v_xor_b32 v78, v78, v76
    v_lshlrev_b32 v78, 4, v78
    v_and_b32 v77, 3, v77
    v_lshl_add_u32 v78, v77, 2, v78
    v_mfma_f32_32x32x16_bf16 v[176:191], v[124:127], a[160:163], v[176:191]
    ds_read_b64_tr_b16 v[118:119], v7 offset:37376
    v_mul_u32_u24 v76, 1152, v76
    v_add_u32 v78, v78, v76
    v_add_u32 v78, 147456, v78
    s_mov_b32 s93, 0x05040100
    s_mov_b32 s94, 0x07060302
    s_waitcnt lgkmcnt(6)
    v_mfma_f32_32x32x16_bf16 v[128:143], v[104:107], a[36:39], v[128:143]
    ds_read_b128 a[44:47], v5 offset:32768
    ds_read_b128 a[172:175], v5 offset:36864
    v_perm_b32 v56, v52, v48, s93
    v_perm_b32 v57, v52, v48, s94
    v_perm_b32 v58, v53, v49, s93
    v_mfma_f32_32x32x16_bf16 v[144:159], v[104:107], a[164:167], v[144:159]
    ds_read_b64_tr_b16 v[120:121], v6 offset:38912
    ds_read_b64_tr_b16 v[122:123], v6 offset:39424
    v_perm_b32 v59, v53, v49, s94
    v_perm_b32 v60, v54, v50, s93
    v_perm_b32 v61, v54, v50, s94
    v_perm_b32 v62, v55, v51, s93
    v_mfma_f32_32x32x16_bf16 v[160:175], v[108:111], a[36:39], v[160:175]
    ds_read_b64_tr_b16 v[124:125], v7 offset:38912
    v_perm_b32 v63, v55, v51, s94
    ds_write_b32 v78, v56 offset:0
    ds_write_b32 v78, v57 offset:144
    ds_write_b32 v78, v58 offset:288
    ds_write_b32 v78, v59 offset:432
    v_mfma_f32_32x32x16_bf16 v[176:191], v[108:111], a[164:167], v[176:191]
    ds_read_b64_tr_b16 v[126:127], v7 offset:39424
    ds_write_b32 v78, v60 offset:576
    ds_write_b32 v78, v61 offset:720
    ds_write_b32 v78, v62 offset:864
    ds_write_b32 v78, v63 offset:1008
    s_cmp_lg_u32 s40, 1
    s_cbranch_scc1 L_tp_A_1
    s_and_b32 s96, s43, 7
    s_lshl_b32 s96, s96, 6
    v_add_u32 v45, s96, v1
    v_mul_u32_u24 v45, 3584, v45
    buffer_load_dword v0, v45, s[12:15], s50 offen
L_tp_A_1:
    s_waitcnt lgkmcnt(14)
    v_mfma_f32_32x32x16_bf16 v[128:143], v[112:115], a[40:43], v[128:143]
    v_and_b32 v76, 31, v1
    v_and_b32 v77, 3, v76
    v_lshlrev_b32 v78, 8, v77
    v_lshrrev_b32 v77, 3, v76
    v_lshl_add_u32 v78, v77, 4, v78
    v_bfe_u32 v77, v76, 2, 1
    v_mfma_f32_32x32x16_bf16 v[144:159], v[112:115], a[168:171], v[144:159]
    s_waitcnt vmcnt(16) lgkmcnt(4)
    s_barrier
    ds_read_b128 a[48:51], v2 offset:49152
    ds_read_b128 a[176:179], v2 offset:53248
    s_add_u32 s101, s47, 6
    s_and_b32 s101, s101, 7
    s_lshl_b32 s87, s101, 7
    s_add_u32 m0, s54, 32768
    s_add_u32 s87, s48, s87
    buffer_load_dwordx4 v9, s[4:7], s87 offen offset:0 lds
    v_mfma_f32_32x32x16_bf16 v[160:175], v[116:119], a[40:43], v[160:175]
    ds_read_b64_tr_b16 v[104:105], v6 offset:49152
    ds_read_b64_tr_b16 v[106:107], v6 offset:49664
    v_lshl_add_u32 v78, v77, 3, v78
    s_lshl_b32 s94, s41, 7
    v_add_u32 v78, s94, v78
    v_add_u32 v79, 64, v78
    v_mfma_f32_32x32x16_bf16 v[176:191], v[116:119], a[168:171], v[176:191]
    ds_read_b64_tr_b16 v[108:109], v7 offset:49152
    ds_read_b64_tr_b16 v[110:111], v7 offset:49664
    buffer_load_dwordx4 v10, s[4:7], s87 offen offset:1024 lds
    s_lshl_b32 s94, s43, 10
    s_add_u32 s94, s94, 65536
    buffer_load_dwordx2 v[64:65], v78, s[20:23], s94 offen sc1
    v_mfma_f32_32x32x16_bf16 v[128:143], v[120:123], a[44:47], v[128:143]
    ds_read_b128 a[52:55], v3 offset:49152
    ds_read_b128 a[180:183], v3 offset:53248
    buffer_load_dwordx2 v[66:67], v79, s[20:23], s94 offen sc1
    s_cmp_lg_u32 s40, 0
    s_cbranch_scc1 L_tw_A_0
    v_lshlrev_b32 v45, 7, v1
    s_lshr_b32 s96, s2, 3
    s_mul_i32 s96, s96, 57344
    s_add_u32 s96, s96, 0
    buffer_load_dword v0, v45, s[16:19], s96 offen
L_tw_A_0:
    v_mfma_f32_32x32x16_bf16 v[144:159], v[120:123], a[172:175], v[144:159]
    ds_read_b64_tr_b16 v[112:113], v6 offset:51200
    ds_read_b64_tr_b16 v[114:115], v6 offset:51712
    buffer_load_dwordx4 v11, s[4:7], s87 offen offset:2048 lds
    v_mfma_f32_32x32x16_bf16 v[160:175], v[124:127], a[44:47], v[160:175]
    ds_read_b64_tr_b16 v[116:117], v7 offset:51200
    v_mfma_f32_32x32x16_bf16 v[176:191], v[124:127], a[172:175], v[176:191]
    ds_read_b64_tr_b16 v[118:119], v7 offset:51712
    buffer_load_dwordx4 v12, s[4:7], s87 offen offset:3072 lds
    s_waitcnt lgkmcnt(6)
    v_mfma_f32_32x32x16_bf16 v[128:143], v[104:107], a[48:51], v[128:143]
    ds_read_b128 a[56:59], v4 offset:49152
    ds_read_b128 a[184:187], v4 offset:53248
    v_mfma_f32_32x32x16_bf16 v[144:159], v[104:107], a[176:179], v[144:159]
    ds_read_b64_tr_b16 v[120:121], v6 offset:53248
    ds_read_b64_tr_b16 v[122:123], v6 offset:53760
    s_mul_i32 s88, s101, 229376
    s_add_u32 m0, s55, 32768
    s_add_u32 s88, s49, s88
    buffer_load_dwordx4 v13, s[8:11], s88 offen offset:0 lds
    v_mfma_f32_32x32x16_bf16 v[160:175], v[108:111], a[48:51], v[160:175]
    ds_read_b64_tr_b16 v[124:125], v7 offset:53248
    v_mfma_f32_32x32x16_bf16 v[176:191], v[108:111], a[176:179], v[176:191]
    ds_read_b64_tr_b16 v[126:127], v7 offset:53760
    buffer_load_dwordx4 v14, s[8:11], s88 offen offset:1024 lds
    s_waitcnt lgkmcnt(6)
    v_mfma_f32_32x32x16_bf16 v[128:143], v[112:115], a[52:55], v[128:143]
    ds_read_b128 a[60:63], v5 offset:49152
    ds_read_b128 a[188:191], v5 offset:53248
    s_cmp_lg_u32 s40, 3
    s_cbranch_scc1 L_tch_Ab
    v_lshlrev_b32 v45, 7, v1
    s_lshr_b32 s96, s2, 3
    s_min_u32 s96, s96, 6
    s_lshl_b32 s96, s96, 13
    s_add_u32 s97, s96, 524288
    buffer_load_dword v0, v45, s[28:31], s97 offen
L_tch_Ab:
    v_mfma_f32_32x32x16_bf16 v[144:159], v[112:115], a[180:183], v[144:159]
    ds_read_b64_tr_b16 v[104:105], v6 offset:55296
    ds_read_b64_tr_b16 v[106:107], v6 offset:55808
    s_add_u32 m0, s55, 40960
    s_nop 0
    buffer_load_dwordx4 v15, s[12:15], s88 offen offset:0 lds
    v_mfma_f32_32x32x16_bf16 v[160:175], v[116:119], a[52:55], v[160:175]
    ds_read_b64_tr_b16 v[108:109], v7 offset:55296
    v_mfma_f32_32x32x16_bf16 v[176:191], v[116:119], a[180:183], v[176:191]
    ds_read_b64_tr_b16 v[110:111], v7 offset:55808
    buffer_load_dwordx4 v16, s[12:15], s88 offen offset:1024 lds
    s_waitcnt lgkmcnt(6)
    v_mfma_f32_32x32x16_bf16 v[128:143], v[120:123], a[56:59], v[128:143]
    v_mfma_f32_32x32x16_bf16 v[144:159], v[120:123], a[184:187], v[144:159]
    s_waitcnt vmcnt(18) lgkmcnt(0)
    s_barrier
    ds_read_b128 a[64:67], v2 offset:0
    ds_read_b128 a[192:195], v2 offset:4096
    s_add_u32 s101, s47, 7
    s_and_b32 s101, s101, 7
    s_lshl_b32 s87, s101, 7
    s_add_u32 m0, s54, 49152
    s_add_u32 s87, s48, s87
    buffer_load_dwordx4 v9, s[4:7], s87 offen offset:0 lds
    v_mfma_f32_32x32x16_bf16 v[160:175], v[124:127], a[56:59], v[160:175]
    ds_read_b64_tr_b16 v[112:113], v6 offset:0
    ds_read_b64_tr_b16 v[114:115], v6 offset:512
    v_lshrrev_b32 v76, 3, v1
    s_lshl_b32 s93, s40, 4
    v_add_u32 v76, s93, v76
    v_and_b32 v77, 7, v1
    v_mfma_f32_32x32x16_bf16 v[176:191], v[124:127], a[184:187], v[176:191]
    ds_read_b64_tr_b16 v[116:117], v7 offset:0
    ds_read_b64_tr_b16 v[118:119], v7 offset:512
    buffer_load_dwordx4 v10, s[4:7], s87 offen offset:1024 lds
    s_lshl_b32 s94, s40, 1
    v_xor_b32 v78, s94, v77
    v_lshlrev_b32 v78, 4, v78
    v_mfma_f32_32x32x16_bf16 v[128:143], v[104:107], a[60:63], v[128:143]
    ds_read_b128 a[68:71], v3 offset:0
    ds_read_b128 a[196:199], v3 offset:4096
    v_mul_u32_u24 v79, 144, v76
    v_add_u32 v79, 147456, v79
    v_add_u32 v56, v79, v78
    v_xor_b32 v78, 16, v78
    v_mfma_f32_32x32x16_bf16 v[144:159], v[104:107], a[188:191], v[144:159]
    ds_read_b64_tr_b16 v[120:121], v6 offset:2048
    ds_read_b64_tr_b16 v[122:123], v6 offset:2560
    buffer_load_dwordx4 v11, s[4:7], s87 offen offset:2048 lds
    v_add_u32 v57, v79, v78
    ds_read_b128 v[48:51], v56
    ds_read_b128 v[52:55], v57 offset:1152
    v_mfma_f32_32x32x16_bf16 v[160:175], v[108:111], a[60:63], v[160:175]
    ds_read_b64_tr_b16 v[124:125], v7 offset:2048
    v_mul_u32_u24 v76, 8320, v76
    v_lshl_add_u32 v76, v77, 4, v76
    v_add_u32 v77, 66560, v76
    s_mul_i32 s93, s91, 532480
    s_lshl_b32 s94, s90, 7
    v_mfma_f32_32x32x16_bf16 v[176:191], v[108:111], a[188:191], v[176:191]
    ds_read_b64_tr_b16 v[126:127], v7 offset:2560
    buffer_load_dwordx4 v12, s[4:7], s87 offen offset:3072 lds
    s_add_u32 s93, s93, s94
    s_add_u32 s93, s93, 1048576
    s_waitcnt lgkmcnt(2)
    buffer_store_dwordx4 v[48:51], v76, s[20:23], s93 offen sc1
    v_mfma_f32_32x32x16_bf16 v[128:143], v[112:115], a[64:67], v[128:143]
    ds_read_b128 a[72:75], v4 offset:0
    ds_read_b128 a[200:203], v4 offset:4096
    buffer_store_dwordx4 v[52:55], v77, s[20:23], s93 offen sc1
    s_cmp_lg_u32 s40, 1
    s_cbranch_scc1 L_tw_A_1
    v_lshlrev_b32 v45, 7, v1
    s_lshr_b32 s96, s2, 3
    s_mul_i32 s96, s96, 57344
    s_add_u32 s96, s96, 8192
    buffer_load_dword v0, v45, s[16:19], s96 offen
L_tw_A_1:
    v_mfma_f32_32x32x16_bf16 v[144:159], v[112:115], a[192:195], v[144:159]
    ds_read_b64_tr_b16 v[104:105], v6 offset:4096
    ds_read_b64_tr_b16 v[106:107], v6 offset:4608
    s_mul_i32 s88, s101, 229376
    s_add_u32 m0, s55, 49152
    s_add_u32 s88, s49, s88
    buffer_load_dwordx4 v13, s[8:11], s88 offen offset:0 lds
    v_mfma_f32_32x32x16_bf16 v[160:175], v[116:119], a[64:67], v[160:175]
    ds_read_b64_tr_b16 v[108:109], v7 offset:4096
    v_mfma_f32_32x32x16_bf16 v[176:191], v[116:119], a[192:195], v[176:191]
    ds_read_b64_tr_b16 v[110:111], v7 offset:4608
    buffer_load_dwordx4 v14, s[8:11], s88 offen offset:1024 lds
    s_waitcnt lgkmcnt(6)
    v_mfma_f32_32x32x16_bf16 v[128:143], v[120:123], a[68:71], v[128:143]
    ds_read_b128 a[76:79], v5 offset:0
    ds_read_b128 a[204:207], v5 offset:4096
    s_cmp_lg_u32 s40, 2
    s_cbranch_scc1 L_tch_Ac
    v_lshlrev_b32 v45, 7, v1
    s_lshr_b32 s96, s2, 3
    s_min_u32 s96, s96, 1
    s_lshl_b32 s96, s96, 13
    s_getpc_b64 s[72:73]
L_tch_Apc:
    s_add_u32 s72, s72, L_common-L_tch_Apc
    s_addc_u32 s73, s73, 0
    s_mov_b32 s74, L_codeend-L_common
    s_mov_b32 s75, 0x20000
    buffer_load_dword v0, v45, s[72:75], s96 offen
L_tch_Ac:
    v_mfma_f32_32x32x16_bf16 v[144:159], v[120:123], a[196:199], v[144:159]
    ds_read_b64_tr_b16 v[112:113], v6 offset:6144
    ds_read_b64_tr_b16 v[114:115], v6 offset:6656
    s_add_u32 m0, s55, 57344
    s_nop 0
    buffer_load_dwordx4 v15, s[12:15], s88 offen offset:0 lds
    v_mfma_f32_32x32x16_bf16 v[160:175], v[124:127], a[68:71], v[160:175]
    ds_read_b64_tr_b16 v[116:117], v7 offset:6144
    v_mfma_f32_32x32x16_bf16 v[176:191], v[124:127], a[196:199], v[176:191]
    ds_read_b64_tr_b16 v[118:119], v7 offset:6656
    buffer_load_dwordx4 v16, s[12:15], s88 offen offset:1024 lds
    s_waitcnt lgkmcnt(6)
    v_mfma_f32_32x32x16_bf16 v[128:143], v[104:107], a[72:75], v[128:143]
    v_mfma_f32_32x32x16_bf16 v[144:159], v[104:107], a[200:203], v[144:159]
    s_waitcnt vmcnt(20) lgkmcnt(0)
    s_barrier
    ds_read_b128 a[80:83], v2 offset:16384
    ds_read_b128 a[208:211], v2 offset:20480
    s_add_u32 s101, s47, 0
    s_and_b32 s101, s101, 7
    s_mul_i32 s88, s101, 229376
    s_add_u32 m0, s55, 0
    s_add_u32 s88, s50, s88
    buffer_load_dwordx4 v13, s[8:11], s88 offen offset:0 lds
    v_mfma_f32_32x32x16_bf16 v[160:175], v[108:111], a[72:75], v[160:175]
    ds_read_b64_tr_b16 v[120:121], v6 offset:16384
    ds_read_b64_tr_b16 v[122:123], v6 offset:16896
    s_waitcnt vmcnt(17)
    v_cmp_ne_u32 vcc, s46, v65
    v_cmp_ne_u32 s[62:63], s46, v67
    s_nop 3
    s_or_b64 vcc, vcc, s[62:63]
    s_cmp_lg_u64 vcc, 0
    s_cbranch_scc1 L_slow_stA
L_back_stA:
    v_mfma_f32_32x32x16_bf16 v[176:191], v[108:111], a[200:203], v[176:191]
    ds_read_b64_tr_b16 v[124:125], v7 offset:16384
    ds_read_b64_tr_b16 v[126:127], v7 offset:16896
    v_and_b32 v65, 0xffff0000, v64
    v_and_b32 v64, 0xffff, v64
    v_xor_b32 v64, 0x8000, v64
    v_lshl_or_b32 v64, v64, 16, v64
    v_mfma_f32_32x32x16_bf16 v[128:143], v[112:115], a[76:79], v[128:143]
    ds_read_b128 a[84:87], v3 offset:16384
    ds_read_b128 a[212:215], v3 offset:20480
    v_mul_f32 v20, v65, v65
    v_rcp_f32 v65, v65
    v_cmp_gt_u32 vcc, 32, v1
    v_mfma_f32_32x32x16_bf16 v[144:159], v[112:115], a[204:207], v[144:159]
    ds_read_b64_tr_b16 v[104:105], v6 offset:18432
    ds_read_b64_tr_b16 v[106:107], v6 offset:18944
    buffer_load_dwordx4 v14, s[8:11], s88 offen offset:1024 lds
    s_nop 0
    v_mul_f32 v18, 0xbfb8aa3b, v65
    v_cndmask_b32 v24, 0, v64, vcc
    v_mfma_f32_32x32x16_bf16 v[160:175], v[116:119], a[76:79], v[160:175]
    ds_read_b64_tr_b16 v[108:109], v7 offset:18432
    v_and_b32 v67, 0xffff0000, v66
    v_and_b32 v66, 0xffff, v66
    v_xor_b32 v66, 0x8000, v66
    v_lshl_or_b32 v66, v66, 16, v66
    v_mul_f32 v21, v67, v67
    v_mfma_f32_32x32x16_bf16 v[176:191], v[116:119], a[204:207], v[176:191]
    ds_read_b64_tr_b16 v[110:111], v7 offset:18944
    v_rcp_f32 v67, v67
    v_cmp_gt_u32 vcc, 32, v1
    s_nop 0
    v_mul_f32 v19, 0xbfb8aa3b, v67
    s_waitcnt lgkmcnt(6)
    v_mfma_f32_32x32x16_bf16 v[128:143], v[120:123], a[80:83], v[128:143]
    ds_read_b128 a[88:91], v4 offset:16384
    ds_read_b128 a[216:219], v4 offset:20480
    v_cndmask_b32 v28, 0, v66, vcc
    v_and_b32 v76, 31, v1
    v_lshlrev_b32 v76, 3, v76
    v_lshrrev_b32 v77, 5, v1
    v_mfma_f32_32x32x16_bf16 v[144:159], v[120:123], a[208:211], v[144:159]
    ds_read_b64_tr_b16 v[112:113], v6 offset:20480
    ds_read_b64_tr_b16 v[114:115], v6 offset:20992
    s_add_u32 m0, s55, 8192
    s_nop 0
    buffer_load_dwordx4 v15, s[12:15], s88 offen offset:0 lds
    v_lshl_add_u32 v76, v77, 10, v76
    v_mfma_f32_32x32x16_bf16 v[160:175], v[124:127], a[80:83], v[160:175]
    ds_read_b64_tr_b16 v[116:117], v7 offset:20480
    s_lshl_b32 s93, s44, 3
    s_lshl_b32 s94, s42, 1
    s_add_u32 s93, s93, s94
    s_add_u32 s93, s93, s41
    s_add_u32 s93, s93, 0
    v_mfma_f32_32x32x16_bf16 v[176:191], v[124:127], a[208:211], v[176:191]
    ds_read_b64_tr_b16 v[118:119], v7 offset:20992
    s_lshl_b32 s93, s93, 11
    s_add_u32 s93, s93, 131072
    buffer_load_dwordx2 v[68:69], v76, s[20:23], s93 offen offset:0 sc1
    buffer_load_dwordx2 v[70:71], v76, s[20:23], s93 offen offset:256 sc1
    buffer_load_dwordx2 v[72:73], v76, s[20:23], s93 offen offset:512 sc1
    s_waitcnt lgkmcnt(6)
    v_mfma_f32_32x32x16_bf16 v[128:143], v[104:107], a[84:87], v[128:143]
    ds_read_b128 a[92:95], v5 offset:16384
    ds_read_b128 a[220:223], v5 offset:20480
    buffer_load_dwordx2 v[74:75], v76, s[20:23], s93 offen offset:768 sc1
    s_cmp_lg_u32 s40, 2
    s_cbranch_scc1 L_tw_A_2
    v_lshlrev_b32 v45, 7, v1
    s_lshr_b32 s96, s2, 3
    s_mul_i32 s96, s96, 57344
    s_add_u32 s96, s96, 16384
    buffer_load_dword v0, v45, s[16:19], s96 offen
L_tw_A_2:
    v_mfma_f32_32x32x16_bf16 v[144:159], v[104:107], a[212:215], v[144:159]
    ds_read_b64_tr_b16 v[120:121], v6 offset:22528
    ds_read_b64_tr_b16 v[122:123], v6 offset:23040
    buffer_load_dwordx4 v16, s[12:15], s88 offen offset:1024 lds
    v_lshlrev_b32 v43, 4, v1
    v_lshrrev_b32 v46, 3, v1
    v_lshlrev_b32 v44, 10, v46
    v_mfma_f32_32x32x16_bf16 v[160:175], v[108:111], a[84:87], v[160:175]
    ds_read_b64_tr_b16 v[124:125], v7 offset:22528
    v_bfe_u32 v46, v1, 4, 1
    v_bfe_u32 v47, v1, 2, 1
    v_xor_b32 v46, v46, v47
    v_lshl_add_u32 v44, v46, 6, v44
    v_and_b32 v46, 3, v1
    v_mfma_f32_32x32x16_bf16 v[176:191], v[108:111], a[212:215], v[176:191]
    ds_read_b64_tr_b16 v[126:127], v7 offset:23040
    v_lshl_add_u32 v44, v46, 4, v44
    v_add_u32 v46, 7168, v44
    v_add_u32 v47, 114688, v43
    s_mul_i32 s73, s40, 393216
    s_lshl_b32 s76, s86, 7
    s_waitcnt lgkmcnt(6)
    v_mfma_f32_32x32x16_bf16 v[128:143], v[112:115], a[88:91], v[128:143]
    s_add_u32 s73, s73, s76
    s_lshl_b32 s82, s40, 16
    s_add_u32 s82, s82, s76
    s_add_u32 s82, s82, 1572864
    s_lshl_b32 s75, s40, 11
    s_mul_i32 s77, s86, 11
    s_lshr_b32 s77, s77, 5
    s_mul_i32 s77, s77, 3
    s_sub_u32 s77, s86, s77
    v_mfma_f32_32x32x16_bf16 v[144:159], v[112:115], a[216:219], v[144:159]
    s_waitcnt vmcnt(18) lgkmcnt(0)
    s_barrier
    ds_read_b128 a[96:99], v2 offset:32768
    ds_read_b128 a[224:227], v2 offset:36864
    s_add_u32 s101, s47, 1
    s_and_b32 s101, s101, 7
    s_mul_i32 s88, s101, 229376
    s_add_u32 m0, s55, 16384
    s_add_u32 s88, s50, s88
    buffer_load_dwordx4 v13, s[8:11], s88 offen offset:0 lds
    v_mfma_f32_32x32x16_bf16 v[160:175], v[116:119], a[88:91], v[160:175]
    ds_read_b64_tr_b16 v[104:105], v6 offset:32768
    ds_read_b64_tr_b16 v[106:107], v6 offset:33280
    v_and_b32 v76, 31, v1
    v_lshlrev_b32 v76, 3, v76
    v_lshrrev_b32 v77, 5, v1
    v_lshl_add_u32 v76, v77, 10, v76
    v_mfma_f32_32x32x16_bf16 v[176:191], v[116:119], a[216:219], v[176:191]
    ds_read_b64_tr_b16 v[108:109], v7 offset:32768
    ds_read_b64_tr_b16 v[110:111], v7 offset:33280
    s_lshl_b32 s93, s44, 3
    s_lshl_b32 s94, s42, 1
    s_add_u32 s93, s93, s94
    s_add_u32 s93, s93, s41
    v_mfma_f32_32x32x16_bf16 v[128:143], v[120:123], a[92:95], v[128:143]
    ds_read_b128 a[100:103], v3 offset:32768
    ds_read_b128 a[228:231], v3 offset:36864
    s_add_u32 s93, s93, 4
    s_lshl_b32 s93, s93, 11
    s_add_u32 s93, s93, 131072
    buffer_load_dwordx2 v[80:81], v76, s[20:23], s93 offen offset:0 sc1
    v_mfma_f32_32x32x16_bf16 v[144:159], v[120:123], a[220:223], v[144:159]
    ds_read_b64_tr_b16 v[112:113], v6 offset:34816
    ds_read_b64_tr_b16 v[114:115], v6 offset:35328
    buffer_load_dwordx4 v14, s[8:11], s88 offen offset:1024 lds
    buffer_load_dwordx2 v[82:83], v76, s[20:23], s93 offen offset:256 sc1
    buffer_load_dwordx2 v[84:85], v76, s[20:23], s93 offen offset:512 sc1
    buffer_load_dwordx2 v[86:87], v76, s[20:23], s93 offen offset:768 sc1
    v_mfma_f32_32x32x16_bf16 v[160:175], v[124:127], a[92:95], v[160:175]
    ds_read_b64_tr_b16 v[116:117], v7 offset:34816
    s_cmp_lg_u32 s40, 3
    s_cbranch_scc1 L_tw_A_3
    v_lshlrev_b32 v45, 7, v1
    s_lshr_b32 s96, s2, 3
    s_mul_i32 s96, s96, 57344
    s_add_u32 s96, s96, 24576
    buffer_load_dword v0, v45, s[16:19], s96 offen
L_tw_A_3:
    v_mfma_f32_32x32x16_bf16 v[176:191], v[124:127], a[220:223], v[176:191]
    ds_read_b64_tr_b16 v[118:119], v7 offset:35328
    s_add_u32 s79, s77, 0
    s_sub_u32 s76, s79, 3
    s_min_u32 s79, s79, s76
    s_lshl_b32 s79, s79, 17
    s_add_u32 s32, s73, s79
    s_waitcnt lgkmcnt(6)
    v_mfma_f32_32x32x16_bf16 v[128:143], v[104:107], a[96:99], v[128:143]
    ds_read_b128 a[104:107], v4 offset:32768
    ds_read_b128 a[232:235], v4 offset:36864
    s_add_u32 s79, s77, 1
    s_sub_u32 s76, s79, 3
    s_min_u32 s79, s79, s76
    s_lshl_b32 s79, s79, 17
    s_add_u32 s33, s73, s79
    v_mfma_f32_32x32x16_bf16 v[144:159], v[104:107], a[224:227], v[144:159]
    ds_read_b64_tr_b16 v[120:121], v6 offset:36864
    ds_read_b64_tr_b16 v[122:123], v6 offset:37376
    s_add_u32 m0, s55, 24576
    s_nop 0
    buffer_load_dwordx4 v15, s[12:15], s88 offen offset:0 lds
    s_add_u32 s79, s77, 2
    s_sub_u32 s76, s79, 3
    s_min_u32 s79, s79, s76
    s_lshl_b32 s79, s79, 17
    s_add_u32 s34, s73, s79
    v_mfma_f32_32x32x16_bf16 v[160:175], v[108:111], a[96:99], v[160:175]
    ds_read_b64_tr_b16 v[124:125], v7 offset:36864
    s_add_u32 s79, s86, 0
    s_and_b32 s79, s79, 3
    s_lshl_b32 s76, s79, 17
    s_add_u32 s76, s76, 65536
    s_add_u32 s76, s76, s73
    s_cmp_eq_u32 s79, 3
    s_cselect_b32 s35, s82, s76
    v_mfma_f32_32x32x16_bf16 v[176:191], v[108:111], a[224:227], v[176:191]
    ds_read_b64_tr_b16 v[126:127], v7 offset:37376
    s_add_u32 s79, s86, 1
    s_and_b32 s79, s79, 3
    s_lshl_b32 s76, s79, 17
    s_add_u32 s76, s76, 65536
    s_add_u32 s76, s76, s73
    s_cmp_eq_u32 s79, 3
    s_cselect_b32 s36, s82, s76
    s_waitcnt lgkmcnt(6)
    v_mfma_f32_32x32x16_bf16 v[128:143], v[112:115], a[100:103], v[128:143]
    ds_read_b128 a[108:111], v5 offset:32768
    ds_read_b128 a[236:239], v5 offset:36864
    s_add_u32 s79, s86, 2
    s_and_b32 s79, s79, 3
    s_lshl_b32 s76, s79, 17
    s_add_u32 s76, s76, 65536
    s_add_u32 s76, s76, s73
    s_cmp_eq_u32 s79, 3
    s_cselect_b32 s37, s82, s76
    v_mfma_f32_32x32x16_bf16 v[144:159], v[112:115], a[228:231], v[144:159]
    ds_read_b64_tr_b16 v[104:105], v6 offset:38912
    ds_read_b64_tr_b16 v[106:107], v6 offset:39424
    buffer_load_dwordx4 v16, s[12:15], s88 offen offset:1024 lds
    s_add_u32 s79, s86, 3
    s_and_b32 s79, s79, 3
    s_lshl_b32 s76, s79, 17
    s_add_u32 s76, s76, 65536
    s_add_u32 s76, s76, s73
    s_cmp_eq_u32 s79, 3
    s_cselect_b32 s38, s82, s76
    v_mfma_f32_32x32x16_bf16 v[160:175], v[116:119], a[100:103], v[160:175]
    ds_read_b64_tr_b16 v[108:109], v7 offset:38912
    v_mfma_f32_32x32x16_bf16 v[176:191], v[116:119], a[228:231], v[176:191]
    ds_read_b64_tr_b16 v[110:111], v7 offset:39424
    s_waitcnt lgkmcnt(6)
    v_mfma_f32_32x32x16_bf16 v[128:143], v[120:123], a[104:107], v[128:143]
    v_mfma_f32_32x32x16_bf16 v[144:159], v[120:123], a[232:235], v[144:159]
    s_waitcnt vmcnt(16) lgkmcnt(0)
    s_barrier
    ds_read_b128 a[112:115], v2 offset:49152
    ds_read_b128 a[240:243], v2 offset:53248
    s_add_u32 s101, s47, 2
    s_and_b32 s101, s101, 7
    s_mul_i32 s88, s101, 229376
    s_add_u32 m0, s55, 32768
    s_add_u32 s88, s50, s88
    buffer_load_dwordx4 v13, s[8:11], s88 offen offset:0 lds
    v_mfma_f32_32x32x16_bf16 v[160:175], v[124:127], a[104:107], v[160:175]
    ds_read_b64_tr_b16 v[112:113], v6 offset:49152
    ds_read_b64_tr_b16 v[114:115], v6 offset:49664
    v_mfma_f32_32x32x16_bf16 v[176:191], v[124:127], a[232:235], v[176:191]
    ds_read_b64_tr_b16 v[116:117], v7 offset:49152
    ds_read_b64_tr_b16 v[118:119], v7 offset:49664
    v_mfma_f32_32x32x16_bf16 v[128:143], v[104:107], a[108:111], v[128:143]
    ds_read_b128 a[116:119], v3 offset:49152
    ds_read_b128 a[244:247], v3 offset:53248
    s_cmp_lg_u32 s40, 0
    s_cbranch_scc1 L_tw_A_4
    v_lshlrev_b32 v45, 7, v1
    s_lshr_b32 s96, s2, 3
    s_mul_i32 s96, s96, 57344
    s_add_u32 s96, s96, 32768
    buffer_load_dword v0, v45, s[16:19], s96 offen
L_tw_A_4:
    v_mfma_f32_32x32x16_bf16 v[144:159], v[104:107], a[236:239], v[144:159]
    ds_read_b64_tr_b16 v[120:121], v6 offset:51200
    ds_read_b64_tr_b16 v[122:123], v6 offset:51712
    buffer_load_dwordx4 v14, s[8:11], s88 offen offset:1024 lds
    v_mfma_f32_32x32x16_bf16 v[160:175], v[108:111], a[108:111], v[160:175]
    ds_read_b64_tr_b16 v[124:125], v7 offset:51200
    v_mfma_f32_32x32x16_bf16 v[176:191], v[108:111], a[236:239], v[176:191]
    ds_read_b64_tr_b16 v[126:127], v7 offset:51712
    s_waitcnt lgkmcnt(6)
    v_mfma_f32_32x32x16_bf16 v[128:143], v[112:115], a[112:115], v[128:143]
    ds_read_b128 a[120:123], v4 offset:49152
    ds_read_b128 a[248:251], v4 offset:53248
    v_mfma_f32_32x32x16_bf16 v[144:159], v[112:115], a[240:243], v[144:159]
    ds_read_b64_tr_b16 v[104:105], v6 offset:53248
    ds_read_b64_tr_b16 v[106:107], v6 offset:53760
    s_add_u32 m0, s55, 40960
    s_nop 0
    buffer_load_dwordx4 v15, s[12:15], s88 offen offset:0 lds
    v_mfma_f32_32x32x16_bf16 v[160:175], v[116:119], a[112:115], v[160:175]
    ds_read_b64_tr_b16 v[108:109], v7 offset:53248
    v_mfma_f32_32x32x16_bf16 v[176:191], v[116:119], a[240:243], v[176:191]
    ds_read_b64_tr_b16 v[110:111], v7 offset:53760
    s_waitcnt lgkmcnt(6)
    v_mfma_f32_32x32x16_bf16 v[128:143], v[120:123], a[116:119], v[128:143]
    ds_read_b128 a[124:127], v5 offset:49152
    ds_read_b128 a[252:255], v5 offset:53248
    v_mfma_f32_32x32x16_bf16 v[144:159], v[120:123], a[244:247], v[144:159]
    ds_read_b64_tr_b16 v[112:113], v6 offset:55296
    ds_read_b64_tr_b16 v[114:115], v6 offset:55808
    buffer_load_dwordx4 v16, s[12:15], s88 offen offset:1024 lds
    v_mfma_f32_32x32x16_bf16 v[160:175], v[124:127], a[116:119], v[160:175]
    ds_read_b64_tr_b16 v[116:117], v7 offset:55296
    v_mfma_f32_32x32x16_bf16 v[176:191], v[124:127], a[244:247], v[176:191]
    ds_read_b64_tr_b16 v[118:119], v7 offset:55808
    s_waitcnt lgkmcnt(6)
    v_mfma_f32_32x32x16_bf16 v[128:143], v[104:107], a[120:123], v[128:143]
    v_mfma_f32_32x32x16_bf16 v[144:159], v[104:107], a[248:251], v[144:159]
    s_waitcnt vmcnt(12) lgkmcnt(0)
    s_barrier
    s_cmp_lg_u32 s40, 0
    s_cbranch_scc1 L_fl_A_wt
    s_lshl_b32 s96, s91, 8
    s_lshl_b32 s97, s90, 2
    s_add_u32 s96, s96, s97
    s_add_u32 s96, s96, 12288
    v_mov_b32 v40, s46
    buffer_store_dword v40, v22, s[20:23], s96 offen sc1
L_fl_A_wt:
    ds_read_b64_tr_b16 v[120:121], v6 offset:0
    ds_read_b64_tr_b16 v[122:123], v6 offset:512
    s_add_u32 s101, s47, 3
    s_and_b32 s101, s101, 7
    s_mul_i32 s88, s101, 229376
    s_add_u32 m0, s55, 49152
    s_add_u32 s88, s50, s88
    buffer_load_dwordx4 v13, s[8:11], s88 offen offset:0 lds
    v_mfma_f32_32x32x16_bf16 v[160:175], v[108:111], a[120:123], v[160:175]
    ds_read_b64_tr_b16 v[124:125], v7 offset:0
    v_cmp_ne_u32 vcc, s46, v69
    v_cmp_ne_u32 s[62:63], s46, v71
    s_nop 3
    s_or_b64 vcc, vcc, s[62:63]
    v_cmp_ne_u32 s[62:63], s46, v73
    s_nop 3
    s_or_b64 vcc, vcc, s[62:63]
    v_cmp_ne_u32 s[62:63], s46, v75
    s_nop 3
    s_or_b64 vcc, vcc, s[62:63]
    s_cmp_lg_u64 vcc, 0
    s_cbranch_scc1 L_slow_csA0
L_back_csA0:
    v_mfma_f32_32x32x16_bf16 v[176:191], v[108:111], a[248:251], v[176:191]
    ds_read_b64_tr_b16 v[126:127], v7 offset:512
    v_add_f32 v68, v68, v70
    v_add_f32 v72, v72, v74
    v_add_f32 v68, v68, v72
    v_mov_b32 v69, v68
    s_nop 1
    v_mfma_f32_32x32x16_bf16 v[128:143], v[112:115], a[124:127], v[128:143]
    ds_read_b64_tr_b16 v[104:105], v6 offset:2048
    v_permlane32_swap_b32 v68, v69
    s_nop 0
    v_add_f32 v68, v68, v69
    v_cvt_pk_bf16_f32 v69, v68, v68
    v_and_b32 v69, 0xffff0000, v69
    v_mfma_f32_32x32x16_bf16 v[144:159], v[112:115], a[252:255], v[144:159]
    ds_read_b64_tr_b16 v[106:107], v6 offset:2560
    buffer_load_dwordx4 v14, s[8:11], s88 offen offset:1024 lds
    v_sub_f32 v70, v68, v69
    v_cvt_pk_bf16_f32 v72, v69, v70
    v_cmp_gt_u32 vcc, 32, v1
    v_mov_b32 v73, 0
    v_mfma_f32_32x32x16_bf16 v[160:175], v[116:119], a[124:127], v[160:175]
    ds_read_b64_tr_b16 v[108:109], v7 offset:2048
    v_mov_b32 v74, 0
    v_cndmask_b32 v72, 0, v72, vcc
    v_mov_b32 v75, 0
    s_lshl_b32 s94, s42, 1
    s_add_u32 s94, s94, s41
    v_mfma_f32_32x32x16_bf16 v[176:191], v[116:119], a[252:255], v[176:191]
    ds_read_b64_tr_b16 v[110:111], v7 offset:2560
    s_lshl_b32 s94, s94, 10
    s_add_u32 s94, s94, 156672
    v_lshl_add_u32 v76, v1, 4, s94
    ds_write_b128 v76, v[72:75]
    s_cmp_lg_u32 s40, 1
    s_cbranch_scc1 L_tw_A_5
    v_lshlrev_b32 v45, 7, v1
    s_lshr_b32 s96, s2, 3
    s_mul_i32 s96, s96, 57344
    s_add_u32 s96, s96, 40960
    buffer_load_dword v0, v45, s[16:19], s96 offen
L_tw_A_5:
    s_waitcnt lgkmcnt(5)
    v_mfma_f32_32x32x16_bf16 v[192:207], v[120:123], a[0:3], 0
    ds_read_b64_tr_b16 v[112:113], v6 offset:4096
    v_mfma_f32_32x32x16_bf16 v[208:223], v[120:123], a[128:131], 0
    ds_read_b64_tr_b16 v[114:115], v6 offset:4608
    s_add_u32 m0, s55, 57344
    s_nop 0
    buffer_load_dwordx4 v15, s[12:15], s88 offen offset:0 lds
    v_mfma_f32_32x32x16_bf16 v[224:239], v[124:127], a[0:3], 0
    ds_read_b64_tr_b16 v[116:117], v7 offset:4096
    v_mfma_f32_32x32x16_bf16 v[240:255], v[124:127], a[128:131], 0
    ds_read_b64_tr_b16 v[118:119], v7 offset:4608
    s_waitcnt lgkmcnt(5)
    v_mfma_f32_32x32x16_bf16 v[192:207], v[104:107], a[4:7], v[192:207]
    ds_read_b64_tr_b16 v[120:121], v6 offset:6144
    v_mfma_f32_32x32x16_bf16 v[208:223], v[104:107], a[132:135], v[208:223]
    ds_read_b64_tr_b16 v[122:123], v6 offset:6656
    buffer_load_dwordx4 v16, s[12:15], s88 offen offset:1024 lds
    v_mfma_f32_32x32x16_bf16 v[224:239], v[108:111], a[4:7], v[224:239]
    ds_read_b64_tr_b16 v[124:125], v7 offset:6144
    v_mfma_f32_32x32x16_bf16 v[240:255], v[108:111], a[132:135], v[240:255]
    ds_read_b64_tr_b16 v[126:127], v7 offset:6656
    s_waitcnt lgkmcnt(4)
    v_mfma_f32_32x32x16_bf16 v[192:207], v[112:115], a[8:11], v[192:207]
    v_mfma_f32_32x32x16_bf16 v[208:223], v[112:115], a[136:139], v[208:223]
    s_waitcnt vmcnt(8) lgkmcnt(0)
    s_barrier
    ds_read_b64_tr_b16 v[104:105], v6 offset:16384
    ds_read_b64_tr_b16 v[106:107], v6 offset:16896
    s_add_u32 s101, s47, 4
    s_and_b32 s101, s101, 7
    s_mul_i32 s88, s101, 229376
    s_add_u32 m0, s55, 0
    s_add_u32 s88, s50, s88
    buffer_load_dwordx4 v13, s[8:11], s88 offen offset:0 lds
    v_mfma_f32_32x32x16_bf16 v[224:239], v[116:119], a[8:11], v[224:239]
    ds_read_b64_tr_b16 v[108:109], v7 offset:16384
    s_lshl_b32 s94, s42, 11
    s_add_u32 s94, s94, 156672
    v_lshl_add_u32 v76, v1, 4, s94
    ds_read_b128 v[48:51], v76
    ds_read_b128 v[52:55], v76 offset:1024
    v_mfma_f32_32x32x16_bf16 v[240:255], v[116:119], a[136:139], v[240:255]
    ds_read_b64_tr_b16 v[110:111], v7 offset:16896
    v_cmp_ne_u32 vcc, s46, v81
    v_cmp_ne_u32 s[62:63], s46, v83
    s_nop 3
    s_or_b64 vcc, vcc, s[62:63]
    v_cmp_ne_u32 s[62:63], s46, v85
    s_nop 3
    s_or_b64 vcc, vcc, s[62:63]
    v_cmp_ne_u32 s[62:63], s46, v87
    s_nop 3
    s_or_b64 vcc, vcc, s[62:63]
    s_cmp_lg_u64 vcc, 0
    s_cbranch_scc1 L_slow_csA1
L_back_csA1:
    v_mfma_f32_32x32x16_bf16 v[192:207], v[120:123], a[12:15], v[192:207]
    ds_read_b64_tr_b16 v[112:113], v6 offset:18432
    v_add_f32 v80, v80, v82
    v_add_f32 v84, v84, v86
    v_add_f32 v80, v80, v84
    v_mov_b32 v81, v80
    s_nop 1
    v_mfma_f32_32x32x16_bf16 v[208:223], v[120:123], a[140:143], v[208:223]
    ds_read_b64_tr_b16 v[114:115], v6 offset:18944
    buffer_load_dwordx4 v14, s[8:11], s88 offen offset:1024 lds
    v_permlane32_swap_b32 v80, v81
    s_nop 0
    v_add_f32 v80, v80, v81
    v_cvt_pk_bf16_f32 v81, v80, v80
    v_mfma_f32_32x32x16_bf16 v[224:239], v[124:127], a[12:15], v[224:239]
    ds_read_b64_tr_b16 v[116:117], v7 offset:18432
    v_and_b32 v81, 0xffff0000, v81
    v_sub_f32 v82, v80, v81
    v_cvt_pk_bf16_f32 v84, v81, v82
    v_cmp_gt_u32 vcc, 32, v1
    v_mov_b32 v85, 0
    v_mfma_f32_32x32x16_bf16 v[240:255], v[124:127], a[140:143], v[240:255]
    ds_read_b64_tr_b16 v[118:119], v7 offset:18944
    v_mov_b32 v86, 0
    v_cndmask_b32 v84, 0, v84, vcc
    v_mov_b32 v87, 0
    s_lshl_b32 s94, s42, 1
    s_add_u32 s94, s94, s41
    s_waitcnt lgkmcnt(4)
    v_mfma_f32_32x32x16_bf16 v[192:207], v[104:107], a[16:19], v[192:207]
    ds_read_b64_tr_b16 v[120:121], v6 offset:20480
    s_lshl_b32 s94, s94, 10
    s_add_u32 s94, s94, 147456
    v_lshl_add_u32 v76, v1, 4, s94
    ds_write_b128 v76, v[84:87]
    s_cmp_lg_u32 s40, 2
    s_cbranch_scc1 L_tw_A_6
    v_lshlrev_b32 v45, 7, v1
    s_lshr_b32 s96, s2, 3
    s_mul_i32 s96, s96, 57344
    s_add_u32 s96, s96, 49152
    buffer_load_dword v0, v45, s[16:19], s96 offen
L_tw_A_6:
    v_mfma_f32_32x32x16_bf16 v[208:223], v[104:107], a[144:147], v[208:223]
    ds_read_b64_tr_b16 v[122:123], v6 offset:20992
    s_add_u32 m0, s55, 8192
    s_nop 0
    buffer_load_dwordx4 v15, s[12:15], s88 offen offset:0 lds
    v_mfma_f32_32x32x16_bf16 v[128:143], v[48:51], v[24:27], v[128:143]
    v_mfma_f32_32x32x16_bf16 v[224:239], v[108:111], a[16:19], v[224:239]
    ds_read_b64_tr_b16 v[124:125], v7 offset:20480
    v_mfma_f32_32x32x16_bf16 v[144:159], v[48:51], v[28:31], v[144:159]
    v_mfma_f32_32x32x16_bf16 v[160:175], v[52:55], v[24:27], v[160:175]
    v_mfma_f32_32x32x16_bf16 v[176:191], v[52:55], v[28:31], v[176:191]
    v_mfma_f32_32x32x16_bf16 v[240:255], v[108:111], a[144:147], v[240:255]
    ds_read_b64_tr_b16 v[126:127], v7 offset:20992
    s_waitcnt lgkmcnt(5)
    v_mfma_f32_32x32x16_bf16 v[192:207], v[112:115], a[20:23], v[192:207]
    ds_read_b64_tr_b16 v[104:105], v6 offset:22528
    v_mfma_f32_32x32x16_bf16 v[208:223], v[112:115], a[148:151], v[208:223]
    ds_read_b64_tr_b16 v[106:107], v6 offset:23040
    buffer_load_dwordx4 v16, s[12:15], s88 offen offset:1024 lds
    v_mfma_f32_32x32x16_bf16 v[224:239], v[116:119], a[20:23], v[224:239]
    ds_read_b64_tr_b16 v[108:109], v7 offset:22528
    v_mfma_f32_32x32x16_bf16 v[240:255], v[116:119], a[148:151], v[240:255]
    ds_read_b64_tr_b16 v[110:111], v7 offset:23040
    s_waitcnt lgkmcnt(4)
    v_mfma_f32_32x32x16_bf16 v[192:207], v[120:123], a[24:27], v[192:207]
    v_mfma_f32_32x32x16_bf16 v[208:223], v[120:123], a[152:155], v[208:223]
    s_waitcnt vmcnt(8) lgkmcnt(0)
    s_barrier
    ds_read_b64_tr_b16 v[112:113], v6 offset:32768
    ds_read_b64_tr_b16 v[114:115], v6 offset:33280
    s_add_u32 s101, s47, 5
    s_and_b32 s101, s101, 7
    s_mul_i32 s88, s101, 229376
    s_add_u32 m0, s55, 16384
    s_add_u32 s88, s50, s88
    buffer_load_dwordx4 v13, s[8:11], s88 offen offset:0 lds
    v_mfma_f32_32x32x16_bf16 v[224:239], v[124:127], a[24:27], v[224:239]
    ds_read_b64_tr_b16 v[116:117], v7 offset:32768
    v_mfma_f32_32x32x16_bf16 v[240:255], v[124:127], a[152:155], v[240:255]
    ds_read_b64_tr_b16 v[118:119], v7 offset:33280
    v_mfma_f32_32x32x16_bf16 v[192:207], v[104:107], a[28:31], v[192:207]
    ds_read_b64_tr_b16 v[120:121], v6 offset:34816
    v_mul_f32 v80, v128, v18
    v_mul_f32 v81, v129, v18
    v_exp_f32 v80, v80
    v_mul_f32 v82, v130, v18
    v_mfma_f32_32x32x16_bf16 v[208:223], v[104:107], a[156:159], v[208:223]
    ds_read_b64_tr_b16 v[122:123], v6 offset:35328
    buffer_load_dwordx4 v14, s[8:11], s88 offen offset:1024 lds
    v_exp_f32 v81, v81
    v_mul_f32 v83, v131, v18
    v_mfma_f32_32x32x16_bf16 v[224:239], v[108:111], a[28:31], v[224:239]
    ds_read_b64_tr_b16 v[124:125], v7 offset:34816
    v_exp_f32 v82, v82
    v_mul_f32 v128, v128, v136
    v_exp_f32 v83, v83
    v_mfma_f32_32x32x16_bf16 v[240:255], v[108:111], a[156:159], v[240:255]
    ds_read_b64_tr_b16 v[126:127], v7 offset:35328
    v_mul_f32 v129, v129, v137
    v_fma_f32 v80, v80, v20, v20
    v_mul_f32 v130, v130, v138
    v_fma_f32 v81, v81, v20, v20
    s_waitcnt lgkmcnt(4)
    v_mfma_f32_32x32x16_bf16 v[192:207], v[112:115], a[32:35], v[192:207]
    ds_read_b64_tr_b16 v[104:105], v6 offset:36864
    v_rcp_f32 v80, v80
    v_fma_f32 v82, v82, v20, v20
    v_rcp_f32 v81, v81
    v_mfma_f32_32x32x16_bf16 v[208:223], v[112:115], a[160:163], v[208:223]
    ds_read_b64_tr_b16 v[106:107], v6 offset:37376
    s_add_u32 m0, s55, 24576
    s_nop 0
    buffer_load_dwordx4 v15, s[12:15], s88 offen offset:0 lds
    v_fma_f32 v83, v83, v20, v20
    v_mfma_f32_32x32x16_bf16 v[224:239], v[116:119], a[32:35], v[224:239]
    ds_read_b64_tr_b16 v[108:109], v7 offset:36864
    v_rcp_f32 v82, v82
    v_mul_f32 v131, v131, v139
    v_rcp_f32 v83, v83
    v_mfma_f32_32x32x16_bf16 v[240:255], v[116:119], a[160:163], v[240:255]
    ds_read_b64_tr_b16 v[110:111], v7 offset:37376
    v_mul_f32 v128, v128, v80
    v_mul_f32 v129, v129, v81
    v_mul_f32 v130, v130, v82
    v_mul_f32 v131, v131, v83
    v_cvt_pk_bf16_f32 v84, v128, v129
    s_waitcnt lgkmcnt(4)
    v_mfma_f32_32x32x16_bf16 v[192:207], v[120:123], a[36:39], v[192:207]
    ds_read_b64_tr_b16 v[112:113], v6 offset:38912
    v_cvt_pk_bf16_f32 v85, v130, v131
    v_mul_f32 v80, v132, v18
    v_mul_f32 v81, v133, v18
    v_exp_f32 v80, v80
    v_mfma_f32_32x32x16_bf16 v[208:223], v[120:123], a[164:167], v[208:223]
    ds_read_b64_tr_b16 v[114:115], v6 offset:39424
    buffer_load_dwordx4 v16, s[12:15], s88 offen offset:1024 lds
    v_mul_f32 v82, v134, v18
    v_exp_f32 v81, v81
    v_mul_f32 v83, v135, v18
    v_mfma_f32_32x32x16_bf16 v[224:239], v[124:127], a[36:39], v[224:239]
    ds_read_b64_tr_b16 v[116:117], v7 offset:38912
    v_exp_f32 v82, v82
    v_mul_f32 v132, v132, v140
    v_exp_f32 v83, v83
    v_mfma_f32_32x32x16_bf16 v[240:255], v[124:127], a[164:167], v[240:255]
    ds_read_b64_tr_b16 v[118:119], v7 offset:39424
    v_mul_f32 v133, v133, v141
    v_fma_f32 v80, v80, v20, v20
    v_mul_f32 v134, v134, v142
    v_fma_f32 v81, v81, v20, v20
    s_waitcnt lgkmcnt(4)
    v_mfma_f32_32x32x16_bf16 v[192:207], v[104:107], a[40:43], v[192:207]
    v_rcp_f32 v80, v80
    v_fma_f32 v82, v82, v20, v20
    v_rcp_f32 v81, v81
    v_fma_f32 v83, v83, v20, v20
    v_mfma_f32_32x32x16_bf16 v[208:223], v[104:107], a[168:171], v[208:223]
    s_waitcnt vmcnt(8) lgkmcnt(0)
    s_barrier
    ds_read_b64_tr_b16 v[120:121], v6 offset:49152
    ds_read_b64_tr_b16 v[122:123], v6 offset:49664
    s_add_u32 s101, s47, 6
    s_and_b32 s101, s101, 7
    s_mul_i32 s88, s101, 229376
    s_add_u32 m0, s55, 32768
    s_add_u32 s88, s50, s88
    buffer_load_dwordx4 v13, s[8:11], s88 offen offset:0 lds
    v_mfma_f32_32x32x16_bf16 v[224:239], v[108:111], a[40:43], v[224:239]
    ds_read_b64_tr_b16 v[124:125], v7 offset:49152
    v_rcp_f32 v82, v82
    v_mul_f32 v135, v135, v143
    v_rcp_f32 v83, v83
    v_mfma_f32_32x32x16_bf16 v[240:255], v[108:111], a[168:171], v[240:255]
    ds_read_b64_tr_b16 v[126:127], v7 offset:49664
    v_mul_f32 v132, v132, v80
    s_add_u32 s98, s52, 0
    v_mul_f32 v133, v133, v81
    v_mul_f32 v134, v134, v82
    v_mul_f32 v135, v135, v83
    v_mfma_f32_32x32x16_bf16 v[192:207], v[112:115], a[44:47], v[192:207]
    ds_read_b64_tr_b16 v[104:105], v6 offset:51200
    v_cvt_pk_bf16_f32 v86, v132, v133
    v_cvt_pk_bf16_f32 v87, v134, v135
    buffer_store_dwordx4 v[84:87], v32, s[20:23], s98 offen sc1
    v_mul_f32 v80, v144, v19
    v_mul_f32 v81, v145, v19
    v_mfma_f32_32x32x16_bf16 v[208:223], v[112:115], a[172:175], v[208:223]
    ds_read_b64_tr_b16 v[106:107], v6 offset:51712
    buffer_load_dwordx4 v14, s[8:11], s88 offen offset:1024 lds
    v_exp_f32 v80, v80
    v_mul_f32 v82, v146, v19
    v_mfma_f32_32x32x16_bf16 v[224:239], v[116:119], a[44:47], v[224:239]
    ds_read_b64_tr_b16 v[108:109], v7 offset:51200
    v_exp_f32 v81, v81
    v_mul_f32 v83, v147, v19
    v_exp_f32 v82, v82
    v_mfma_f32_32x32x16_bf16 v[240:255], v[116:119], a[172:175], v[240:255]
    ds_read_b64_tr_b16 v[110:111], v7 offset:51712
    v_mul_f32 v144, v144, v152
    v_exp_f32 v83, v83
    v_mul_f32 v145, v145, v153
    v_fma_f32 v80, v80, v21, v21
    s_waitcnt lgkmcnt(4)
    v_mfma_f32_32x32x16_bf16 v[192:207], v[120:123], a[48:51], v[192:207]
    ds_read_b64_tr_b16 v[112:113], v6 offset:53248
    v_mul_f32 v146, v146, v154
    v_fma_f32 v81, v81, v21, v21
    v_rcp_f32 v80, v80
    v_fma_f32 v82, v82, v21, v21
    v_mfma_f32_32x32x16_bf16 v[208:223], v[120:123], a[176:179], v[208:223]
    ds_read_b64_tr_b16 v[114:115], v6 offset:53760
    s_add_u32 m0, s55, 40960
    s_nop 0
    buffer_load_dwordx4 v15, s[12:15], s88 offen offset:0 lds
    v_rcp_f32 v81, v81
    v_mfma_f32_32x32x16_bf16 v[224:239], v[124:127], a[48:51], v[224:239]
    ds_read_b64_tr_b16 v[116:117], v7 offset:53248
    v_fma_f32 v83, v83, v21, v21
    v_rcp_f32 v82, v82
    v_mul_f32 v147, v147, v155
    v_mfma_f32_32x32x16_bf16 v[240:255], v[124:127], a[176:179], v[240:255]
    ds_read_b64_tr_b16 v[118:119], v7 offset:53760
    v_rcp_f32 v83, v83
    v_mul_f32 v144, v144, v80
    v_mul_f32 v145, v145, v81
    v_mul_f32 v146, v146, v82
    s_waitcnt lgkmcnt(4)
    v_mfma_f32_32x32x16_bf16 v[192:207], v[104:107], a[52:55], v[192:207]
    ds_read_b64_tr_b16 v[120:121], v6 offset:55296
    v_mul_f32 v147, v147, v83
    v_cvt_pk_bf16_f32 v84, v144, v145
    v_cvt_pk_bf16_f32 v85, v146, v147
    v_mul_f32 v80, v148, v19
    v_mul_f32 v81, v149, v19
    v_mfma_f32_32x32x16_bf16 v[208:223], v[104:107], a[180:183], v[208:223]
    ds_read_b64_tr_b16 v[122:123], v6 offset:55808
    buffer_load_dwordx4 v16, s[12:15], s88 offen offset:1024 lds
    v_exp_f32 v80, v80
    v_mul_f32 v82, v150, v19
    v_mfma_f32_32x32x16_bf16 v[224:239], v[108:111], a[52:55], v[224:239]
    ds_read_b64_tr_b16 v[124:125], v7 offset:55296
    v_exp_f32 v81, v81
    v_mul_f32 v83, v151, v19
    v_exp_f32 v82, v82
    v_mfma_f32_32x32x16_bf16 v[240:255], v[108:111], a[180:183], v[240:255]
    ds_read_b64_tr_b16 v[126:127], v7 offset:55808
    v_mul_f32 v148, v148, v156
    v_exp_f32 v83, v83
    v_mul_f32 v149, v149, v157
    v_fma_f32 v80, v80, v21, v21
    s_waitcnt lgkmcnt(4)
    v_mfma_f32_32x32x16_bf16 v[192:207], v[112:115], a[56:59], v[192:207]
    v_mul_f32 v150, v150, v158
    v_fma_f32 v81, v81, v21, v21
    v_rcp_f32 v80, v80
    v_fma_f32 v82, v82, v21, v21
    v_mfma_f32_32x32x16_bf16 v[208:223], v[112:115], a[184:187], v[208:223]
    s_waitcnt vmcnt(9) lgkmcnt(0)
    s_barrier
    ds_read_b64_tr_b16 v[104:105], v6 offset:0
    ds_read_b64_tr_b16 v[106:107], v6 offset:512
    s_add_u32 s101, s47, 7
    s_and_b32 s101, s101, 7
    s_mul_i32 s88, s101, 229376
    s_add_u32 m0, s55, 49152
    s_add_u32 s88, s50, s88
    buffer_load_dwordx4 v13, s[8:11], s88 offen offset:0 lds
    v_mfma_f32_32x32x16_bf16 v[224:239], v[116:119], a[56:59], v[224:239]
    ds_read_b64_tr_b16 v[108:109], v7 offset:0
    v_rcp_f32 v81, v81
    v_fma_f32 v83, v83, v21, v21
    v_rcp_f32 v82, v82
    v_mfma_f32_32x32x16_bf16 v[240:255], v[116:119], a[184:187], v[240:255]
    ds_read_b64_tr_b16 v[110:111], v7 offset:512
    v_mul_f32 v151, v151, v159
    v_rcp_f32 v83, v83
    v_mul_f32 v148, v148, v80
    s_add_u32 s98, s52, 114688
    v_mfma_f32_32x32x16_bf16 v[192:207], v[120:123], a[60:63], v[192:207]
    ds_read_b64_tr_b16 v[112:113], v6 offset:2048
    v_mul_f32 v149, v149, v81
    v_mul_f32 v150, v150, v82
    v_mul_f32 v151, v151, v83
    v_cvt_pk_bf16_f32 v86, v148, v149
    v_cvt_pk_bf16_f32 v87, v150, v151
    v_mfma_f32_32x32x16_bf16 v[208:223], v[120:123], a[188:191], v[208:223]
    ds_read_b64_tr_b16 v[114:115], v6 offset:2560
    buffer_load_dwordx4 v14, s[8:11], s88 offen offset:1024 lds
    buffer_store_dwordx4 v[84:87], v32, s[20:23], s98 offen sc1
    v_mul_f32 v80, v160, v18
    v_mul_f32 v81, v161, v18
    v_mfma_f32_32x32x16_bf16 v[224:239], v[124:127], a[60:63], v[224:239]
    ds_read_b64_tr_b16 v[116:117], v7 offset:2048
    v_exp_f32 v80, v80
    v_mul_f32 v82, v162, v18
    v_exp_f32 v81, v81
    v_mfma_f32_32x32x16_bf16 v[240:255], v[124:127], a[188:191], v[240:255]
    ds_read_b64_tr_b16 v[118:119], v7 offset:2560
    v_mul_f32 v83, v163, v18
    v_exp_f32 v82, v82
    v_mul_f32 v160, v160, v168
    s_waitcnt lgkmcnt(4)
    v_mfma_f32_32x32x16_bf16 v[192:207], v[104:107], a[64:67], v[192:207]
    ds_read_b64_tr_b16 v[120:121], v6 offset:4096
    v_exp_f32 v83, v83
    v_mul_f32 v161, v161, v169
    v_fma_f32 v80, v80, v20, v20
    v_mul_f32 v162, v162, v170
    v_mfma_f32_32x32x16_bf16 v[208:223], v[104:107], a[192:195], v[208:223]
    ds_read_b64_tr_b16 v[122:123], v6 offset:4608
    s_add_u32 m0, s55, 57344
    s_nop 0
    buffer_load_dwordx4 v15, s[12:15], s88 offen offset:0 lds
    v_fma_f32 v81, v81, v20, v20
    v_mfma_f32_32x32x16_bf16 v[224:239], v[108:111], a[64:67], v[224:239]
    ds_read_b64_tr_b16 v[124:125], v7 offset:4096
    v_rcp_f32 v80, v80
    v_fma_f32 v82, v82, v20, v20
    v_rcp_f32 v81, v81
    v_mfma_f32_32x32x16_bf16 v[240:255], v[108:111], a[192:195], v[240:255]
    ds_read_b64_tr_b16 v[126:127], v7 offset:4608
    v_fma_f32 v83, v83, v20, v20
    v_rcp_f32 v82, v82
    v_mul_f32 v163, v163, v171
    s_waitcnt lgkmcnt(4)
    v_mfma_f32_32x32x16_bf16 v[192:207], v[112:115], a[68:71], v[192:207]
    ds_read_b64_tr_b16 v[104:105], v6 offset:6144
    v_rcp_f32 v83, v83
    v_mul_f32 v160, v160, v80
    v_mul_f32 v161, v161, v81
    v_mul_f32 v162, v162, v82
    v_mfma_f32_32x32x16_bf16 v[208:223], v[112:115], a[196:199], v[208:223]
    ds_read_b64_tr_b16 v[106:107], v6 offset:6656
    buffer_load_dwordx4 v16, s[12:15], s88 offen offset:1024 lds
    v_mul_f32 v163, v163, v83
    v_cvt_pk_bf16_f32 v84, v160, v161
    v_cvt_pk_bf16_f32 v85, v162, v163
    v_mul_f32 v80, v164, v18
    v_mfma_f32_32x32x16_bf16 v[224:239], v[116:119], a[68:71], v[224:239]
    ds_read_b64_tr_b16 v[108:109], v7 offset:6144
    v_mul_f32 v81, v165, v18
    v_exp_f32 v80, v80
    v_mul_f32 v82, v166, v18
    v_mfma_f32_32x32x16_bf16 v[240:255], v[116:119], a[196:199], v[240:255]
    ds_read_b64_tr_b16 v[110:111], v7 offset:6656
    s_lshl_b32 s77, s40, 13
    s_add_u32 s77, s77, 524288
    buffer_load_dwordx4 a[0:3], v43, s[28:31], s77 offen offset:0
    v_exp_f32 v81, v81
    s_waitcnt lgkmcnt(4)
    v_mfma_f32_32x32x16_bf16 v[192:207], v[120:123], a[72:75], v[192:207]
    v_mul_f32 v83, v167, v18
    v_exp_f32 v82, v82
    v_mul_f32 v164, v164, v172
    v_exp_f32 v83, v83
    v_mfma_f32_32x32x16_bf16 v[208:223], v[120:123], a[200:203], v[208:223]
    s_waitcnt vmcnt(11) lgkmcnt(0)
    s_barrier
    ds_read_b64_tr_b16 v[112:113], v6 offset:16384
    ds_read_b64_tr_b16 v[114:115], v6 offset:16896
    buffer_load_dwordx4 a[4:7], v43, s[28:31], s77 offen offset:1024
    v_mfma_f32_32x32x16_bf16 v[224:239], v[124:127], a[72:75], v[224:239]
    ds_read_b64_tr_b16 v[116:117], v7 offset:16384
    s_lshl_b32 s94, s42, 11
    s_add_u32 s94, s94, 147456
    v_lshl_add_u32 v76, v1, 4, s94
    ds_read_b128 v[48:51], v76
    ds_read_b128 v[52:55], v76 offset:1024
    v_mfma_f32_32x32x16_bf16 v[240:255], v[124:127], a[200:203], v[240:255]
    ds_read_b64_tr_b16 v[118:119], v7 offset:16896
    buffer_load_dwordx4 a[8:11], v43, s[28:31], s77 offen offset:2048
    v_mul_f32 v165, v165, v173
    v_fma_f32 v80, v80, v20, v20
    v_mul_f32 v166, v166, v174
    v_fma_f32 v81, v81, v20, v20
    v_mfma_f32_32x32x16_bf16 v[192:207], v[104:107], a[76:79], v[192:207]
    ds_read_b64_tr_b16 v[120:121], v6 offset:18432
    v_rcp_f32 v80, v80
    v_fma_f32 v82, v82, v20, v20
    v_rcp_f32 v81, v81
    v_mfma_f32_32x32x16_bf16 v[208:223], v[104:107], a[204:207], v[208:223]
    ds_read_b64_tr_b16 v[122:123], v6 offset:18944
    buffer_load_dwordx4 a[12:15], v43, s[28:31], s77 offen offset:3072
    v_fma_f32 v83, v83, v20, v20
    v_rcp_f32 v82, v82
    v_mul_f32 v167, v167, v175
    v_mfma_f32_32x32x16_bf16 v[224:239], v[108:111], a[76:79], v[224:239]
    ds_read_b64_tr_b16 v[124:125], v7 offset:18432
    v_rcp_f32 v83, v83
    v_mul_f32 v164, v164, v80
    s_add_u32 s98, s52, 1024
    v_mul_f32 v165, v165, v81
    v_mfma_f32_32x32x16_bf16 v[240:255], v[108:111], a[204:207], v[240:255]
    ds_read_b64_tr_b16 v[126:127], v7 offset:18944
    s_add_u32 s77, s77, 4096
    buffer_load_dwordx4 a[16:19], v43, s[28:31], s77 offen offset:0
    v_mul_f32 v166, v166, v82
    v_mul_f32 v167, v167, v83
    v_cvt_pk_bf16_f32 v86, v164, v165
    s_waitcnt lgkmcnt(4)
    v_mfma_f32_32x32x16_bf16 v[192:207], v[112:115], a[80:83], v[192:207]
    ds_read_b64_tr_b16 v[104:105], v6 offset:20480
    v_mfma_f32_32x32x16_bf16 v[192:207], v[48:51], v[24:27], v[192:207]
    v_mfma_f32_32x32x16_bf16 v[208:223], v[48:51], v[28:31], v[208:223]
    v_mfma_f32_32x32x16_bf16 v[224:239], v[52:55], v[24:27], v[224:239]
    v_mfma_f32_32x32x16_bf16 v[240:255], v[52:55], v[28:31], v[240:255]
    v_mfma_f32_32x32x16_bf16 v[208:223], v[112:115], a[208:211], v[208:223]
    ds_read_b64_tr_b16 v[106:107], v6 offset:20992
    buffer_load_dwordx4 a[20:23], v43, s[28:31], s77 offen offset:1024
    v_cvt_pk_bf16_f32 v87, v166, v167
    buffer_store_dwordx4 v[84:87], v32, s[20:23], s98 offen sc1
    v_mul_f32 v80, v176, v19
    v_mul_f32 v81, v177, v19
    v_mfma_f32_32x32x16_bf16 v[224:239], v[116:119], a[80:83], v[224:239]
    ds_read_b64_tr_b16 v[108:109], v7 offset:20480
    v_exp_f32 v80, v80
    v_mul_f32 v82, v178, v19
    v_exp_f32 v81, v81
    v_mfma_f32_32x32x16_bf16 v[240:255], v[116:119], a[208:211], v[240:255]
    ds_read_b64_tr_b16 v[110:111], v7 offset:20992
    buffer_load_dwordx4 a[24:27], v43, s[28:31], s77 offen offset:2048
    v_mul_f32 v83, v179, v19
    v_exp_f32 v82, v82
    v_mul_f32 v176, v176, v184
    s_waitcnt lgkmcnt(4)
    v_mfma_f32_32x32x16_bf16 v[192:207], v[120:123], a[84:87], v[192:207]
    ds_read_b64_tr_b16 v[112:113], v6 offset:22528
    v_exp_f32 v83, v83
    v_mul_f32 v177, v177, v185
    v_fma_f32 v80, v80, v21, v21
    v_mul_f32 v178, v178, v186
    v_mfma_f32_32x32x16_bf16 v[208:223], v[120:123], a[212:215], v[208:223]
    ds_read_b64_tr_b16 v[114:115], v6 offset:23040
    buffer_load_dwordx4 a[28:31], v43, s[28:31], s77 offen offset:3072
    v_fma_f32 v81, v81, v21, v21
    v_rcp_f32 v80, v80
    v_fma_f32 v82, v82, v21, v21
    v_mfma_f32_32x32x16_bf16 v[224:239], v[124:127], a[84:87], v[224:239]
    ds_read_b64_tr_b16 v[116:117], v7 offset:22528
    v_rcp_f32 v81, v81
    v_fma_f32 v83, v83, v21, v21
    v_rcp_f32 v82, v82
    v_mfma_f32_32x32x16_bf16 v[240:255], v[124:127], a[212:215], v[240:255]
    ds_read_b64_tr_b16 v[118:119], v7 offset:23040
    s_mov_b32 s77, 557056
    buffer_load_dwordx4 a[32:35], v43, s[28:31], s77 offen offset:0
    v_mul_f32 v179, v179, v187
    v_rcp_f32 v83, v83
    s_waitcnt lgkmcnt(4)
    v_mfma_f32_32x32x16_bf16 v[192:207], v[104:107], a[88:91], v[192:207]
    v_mul_f32 v176, v176, v80
    v_mul_f32 v177, v177, v81
    v_mul_f32 v178, v178, v82
    v_mul_f32 v179, v179, v83
    v_cvt_pk_bf16_f32 v84, v176, v177
    v_cvt_pk_bf16_f32 v85, v178, v179
    v_mfma_f32_32x32x16_bf16 v[208:223], v[104:107], a[216:219], v[208:223]
    s_waitcnt vmcnt(15) lgkmcnt(0)
    s_barrier
    ds_read_b64_tr_b16 v[120:121], v6 offset:32768
    ds_read_b64_tr_b16 v[122:123], v6 offset:33280
    buffer_load_dwordx4 a[36:39], v43, s[28:31], s77 offen offset:1024
    v_mfma_f32_32x32x16_bf16 v[224:239], v[108:111], a[88:91], v[224:239]
    ds_read_b64_tr_b16 v[124:125], v7 offset:32768
    v_mul_f32 v80, v180, v19
    v_mul_f32 v81, v181, v19
    v_exp_f32 v80, v80
    v_mul_f32 v82, v182, v19
    v_mfma_f32_32x32x16_bf16 v[240:255], v[108:111], a[216:219], v[240:255]
    ds_read_b64_tr_b16 v[126:127], v7 offset:33280
    buffer_load_dwordx4 a[40:43], v43, s[28:31], s77 offen offset:2048
    v_exp_f32 v81, v81
    v_mul_f32 v83, v183, v19
    v_mfma_f32_32x32x16_bf16 v[192:207], v[112:115], a[92:95], v[192:207]
    ds_read_b64_tr_b16 v[104:105], v6 offset:34816
    v_exp_f32 v82, v82
    v_mul_f32 v180, v180, v188
    v_exp_f32 v83, v83
    v_mfma_f32_32x32x16_bf16 v[208:223], v[112:115], a[220:223], v[208:223]
    ds_read_b64_tr_b16 v[106:107], v6 offset:35328
    buffer_load_dwordx4 a[44:47], v43, s[28:31], s77 offen offset:3072
    v_mul_f32 v181, v181, v189
    v_fma_f32 v80, v80, v21, v21
    v_mul_f32 v182, v182, v190
    v_fma_f32 v81, v81, v21, v21
    v_mfma_f32_32x32x16_bf16 v[224:239], v[116:119], a[92:95], v[224:239]
    ds_read_b64_tr_b16 v[108:109], v7 offset:34816
    v_rcp_f32 v80, v80
    v_fma_f32 v82, v82, v21, v21
    v_rcp_f32 v81, v81
    v_mfma_f32_32x32x16_bf16 v[240:255], v[116:119], a[220:223], v[240:255]
    ds_read_b64_tr_b16 v[110:111], v7 offset:35328
    s_mov_b32 s77, 561152
    buffer_load_dwordx4 a[48:51], v43, s[28:31], s77 offen offset:0
    v_fma_f32 v83, v83, v21, v21
    v_rcp_f32 v82, v82
    s_waitcnt lgkmcnt(4)
    v_mfma_f32_32x32x16_bf16 v[192:207], v[120:123], a[96:99], v[192:207]
    ds_read_b64_tr_b16 v[112:113], v6 offset:36864
    v_mul_f32 v183, v183, v191
    v_rcp_f32 v83, v83
    v_mul_f32 v180, v180, v80
    s_add_u32 s98, s52, 115712
    v_mfma_f32_32x32x16_bf16 v[208:223], v[120:123], a[224:227], v[208:223]
    ds_read_b64_tr_b16 v[114:115], v6 offset:37376
    buffer_load_dwordx4 a[52:55], v43, s[28:31], s77 offen offset:1024
    v_mul_f32 v181, v181, v81
    v_mul_f32 v182, v182, v82
    v_mul_f32 v183, v183, v83
    v_cvt_pk_bf16_f32 v86, v180, v181
    v_mfma_f32_32x32x16_bf16 v[224:239], v[124:127], a[96:99], v[224:239]
    ds_read_b64_tr_b16 v[116:117], v7 offset:36864
    v_cvt_pk_bf16_f32 v87, v182, v183
    buffer_store_dwordx4 v[84:87], v32, s[20:23], s98 offen sc1
    v_mfma_f32_32x32x16_bf16 v[240:255], v[124:127], a[224:227], v[240:255]
    ds_read_b64_tr_b16 v[118:119], v7 offset:37376
    s_add_u32 m0, s75, 131072
    s_add_u32 s81, s32, 0
    buffer_load_dwordx4 v44, s[16:19], s81 offen lds
    s_waitcnt lgkmcnt(4)
    v_mfma_f32_32x32x16_bf16 v[192:207], v[104:107], a[100:103], v[192:207]
    ds_read_b64_tr_b16 v[120:121], v6 offset:38912
    v_mfma_f32_32x32x16_bf16 v[208:223], v[104:107], a[228:231], v[208:223]
    ds_read_b64_tr_b16 v[122:123], v6 offset:39424
    buffer_load_dwordx4 v46, s[16:19], s81 offen offset:1024 lds
    v_mfma_f32_32x32x16_bf16 v[224:239], v[108:111], a[100:103], v[224:239]
    ds_read_b64_tr_b16 v[124:125], v7 offset:38912
    v_mfma_f32_32x32x16_bf16 v[240:255], v[108:111], a[228:231], v[240:255]
    ds_read_b64_tr_b16 v[126:127], v7 offset:39424
    s_add_u32 m0, s75, 139264
    s_add_u32 s81, s32, 16384
    buffer_load_dwordx4 v44, s[16:19], s81 offen lds
    s_waitcnt lgkmcnt(4)
    v_mfma_f32_32x32x16_bf16 v[192:207], v[112:115], a[104:107], v[192:207]
    v_mfma_f32_32x32x16_bf16 v[208:223], v[112:115], a[232:235], v[208:223]
    s_waitcnt vmcnt(19) lgkmcnt(0)
    s_barrier
    ds_read_b64_tr_b16 v[104:105], v6 offset:49152
    ds_read_b64_tr_b16 v[106:107], v6 offset:49664
    buffer_load_dwordx4 v46, s[16:19], s81 offen offset:1024 lds
    v_mfma_f32_32x32x16_bf16 v[224:239], v[116:119], a[104:107], v[224:239]
    ds_read_b64_tr_b16 v[108:109], v7 offset:49152
    v_mfma_f32_32x32x16_bf16 v[240:255], v[116:119], a[232:235], v[240:255]
    ds_read_b64_tr_b16 v[110:111], v7 offset:49664
    s_add_u32 m0, s75, 40960
    s_add_u32 s81, s32, 32768
    buffer_load_dwordx4 v44, s[16:19], s81 offen lds
    v_mfma_f32_32x32x16_bf16 v[192:207], v[120:123], a[108:111], v[192:207]
    ds_read_b64_tr_b16 v[112:113], v6 offset:51200
    v_mfma_f32_32x32x16_bf16 v[208:223], v[120:123], a[236:239], v[208:223]
    ds_read_b64_tr_b16 v[114:115], v6 offset:51712
    buffer_load_dwordx4 v46, s[16:19], s81 offen offset:1024 lds
    v_mfma_f32_32x32x16_bf16 v[224:239], v[124:127], a[108:111], v[224:239]
    ds_read_b64_tr_b16 v[116:117], v7 offset:51200
    v_mfma_f32_32x32x16_bf16 v[240:255], v[124:127], a[236:239], v[240:255]
    ds_read_b64_tr_b16 v[118:119], v7 offset:51712
    s_add_u32 m0, s75, 49152
    s_add_u32 s81, s32, 49152
    buffer_load_dwordx4 v44, s[16:19], s81 offen lds
    s_waitcnt lgkmcnt(4)
    v_mfma_f32_32x32x16_bf16 v[192:207], v[104:107], a[112:115], v[192:207]
    ds_read_b64_tr_b16 v[120:121], v6 offset:53248
    v_mfma_f32_32x32x16_bf16 v[208:223], v[104:107], a[240:243], v[208:223]
    ds_read_b64_tr_b16 v[122:123], v6 offset:53760
    buffer_load_dwordx4 v46, s[16:19], s81 offen offset:1024 lds
    v_mfma_f32_32x32x16_bf16 v[224:239], v[108:111], a[112:115], v[224:239]
    ds_read_b64_tr_b16 v[124:125], v7 offset:53248
    v_mfma_f32_32x32x16_bf16 v[240:255], v[108:111], a[240:243], v[240:255]
    ds_read_b64_tr_b16 v[126:127], v7 offset:53760
    s_add_u32 m0, s75, 57344
    s_add_u32 s81, s33, 0
    buffer_load_dwordx4 v44, s[16:19], s81 offen lds
    s_waitcnt lgkmcnt(4)
    v_mfma_f32_32x32x16_bf16 v[192:207], v[112:115], a[116:119], v[192:207]
    ds_read_b64_tr_b16 v[104:105], v6 offset:55296
    v_mfma_f32_32x32x16_bf16 v[208:223], v[112:115], a[244:247], v[208:223]
    ds_read_b64_tr_b16 v[106:107], v6 offset:55808
    buffer_load_dwordx4 v46, s[16:19], s81 offen offset:1024 lds
    v_mfma_f32_32x32x16_bf16 v[224:239], v[116:119], a[116:119], v[224:239]
    ds_read_b64_tr_b16 v[108:109], v7 offset:55296
    v_mfma_f32_32x32x16_bf16 v[240:255], v[116:119], a[244:247], v[240:255]
    ds_read_b64_tr_b16 v[110:111], v7 offset:55808
    s_lshl_b32 s77, s40, 12
    s_add_u32 s77, s77, 565248
    buffer_load_dwordx4 v[48:51], v43, s[28:31], s77 offen offset:0
    s_waitcnt lgkmcnt(4)
    v_mfma_f32_32x32x16_bf16 v[192:207], v[120:123], a[120:123], v[192:207]
    v_mfma_f32_32x32x16_bf16 v[208:223], v[120:123], a[248:251], v[208:223]
    s_waitcnt vmcnt(11) lgkmcnt(0)
    s_barrier
    s_cmp_lg_u32 s40, 0
    s_cbranch_scc1 L_fl_A_h0
    s_lshl_b32 s96, s43, 7
    s_lshl_b32 s97, s44, 2
    s_add_u32 s96, s96, s97
    s_add_u32 s96, s96, 4096
    v_mov_b32 v40, s46
    buffer_store_dword v40, v22, s[20:23], s96 offen sc1
L_fl_A_h0:
    buffer_load_dwordx4 v[52:55], v43, s[28:31], s77 offen offset:1024
    v_mfma_f32_32x32x16_bf16 v[224:239], v[124:127], a[120:123], v[224:239]
    v_mfma_f32_32x32x16_bf16 v[240:255], v[124:127], a[248:251], v[240:255]
    buffer_load_dwordx4 v[56:59], v43, s[28:31], s77 offen offset:2048
    v_mfma_f32_32x32x16_bf16 v[192:207], v[104:107], a[124:127], v[192:207]
    v_mfma_f32_32x32x16_bf16 v[208:223], v[104:107], a[252:255], v[208:223]
    buffer_load_dwordx4 v[60:63], v43, s[28:31], s77 offen offset:3072
    v_mfma_f32_32x32x16_bf16 v[224:239], v[108:111], a[124:127], v[224:239]
    v_mfma_f32_32x32x16_bf16 v[240:255], v[108:111], a[252:255], v[240:255]
    s_waitcnt lgkmcnt(0)
    s_branch L_common
L_typeB:
    s_mov_b32 s32, s66
    s_mov_b32 s33, s67
    s_mov_b32 s34, 1052672
    s_mov_b32 s35, 0x20000
    s_mov_b32 s36, s68
    s_mov_b32 s37, s69
    s_mov_b32 s38, 1052672
    s_mov_b32 s39, 0x20000
    s_lshl_b32 s56, s43, 7
    s_lshl_b32 s57, s44, 3
    s_add_u32 s56, s56, s57
    s_lshl_b32 s57, s40, 1
    s_add_u32 s92, s56, s57
    s_lshl_b32 s56, s92, 10
    v_lshlrev_b32 v76, 4, v1
    buffer_load_dwordx4 v[40:43], v76, s[4:7], s56 offen offset:0
    buffer_load_dwordx4 v[44:47], v76, s[4:7], s56 offen offset:1024
    s_add_u32 s101, s47, 0
    s_and_b32 s101, s101, 7
    s_lshl_b32 s87, s101, 7
    s_add_u32 m0, s54, 0
    s_add_u32 s87, s48, s87
    buffer_load_dwordx4 v9, s[4:7], s87 offen offset:0 lds
    buffer_load_dwordx4 v10, s[4:7], s87 offen offset:1024 lds
    buffer_load_dwordx4 v11, s[4:7], s87 offen offset:2048 lds
    buffer_load_dwordx4 v12, s[4:7], s87 offen offset:3072 lds
    s_lshl_b32 s88, s101, 14
    s_add_u32 m0, s54, 65536
    s_add_u32 s88, s51, s88
    buffer_load_dwordx4 v17, s[28:31], s88 offen offset:0 lds
    buffer_load_dwordx4 v17, s[28:31], s88 offen offset:1024 lds
    buffer_load_dwordx4 v17, s[28:31], s88 offen offset:2048 lds
    buffer_load_dwordx4 v17, s[28:31], s88 offen offset:3072 lds
    s_mov_b32 s16, s76
    s_mov_b32 s17, s77
    s_mov_b32 s18, 1835008
    s_mov_b32 s19, 0x20000
    s_mov_b32 s24, s78
    s_mov_b32 s25, s79
    s_mov_b32 s26, 2097152
    s_mov_b32 s27, 0x20000
    s_mov_b32 s20, s82
    s_mov_b32 s21, s83
    s_mov_b32 s22, 20971520
    s_mov_b32 s23, 0x20000
    s_mov_b32 s68, s80
    s_mov_b32 s69, s81
    s_mov_b32 s70, 256
    s_mov_b32 s71, 0x20000
    s_mov_b32 s100, 100000
    v_and_b32 v76, 31, v1
    v_lshrrev_b32 v77, 5, v1
    v_bfe_u32 v78, v76, 1, 3
    v_xor_b32 v77, v77, v78
    v_lshlrev_b32 v77, 4, v77
    s_lshl_b32 s56, s41, 13
    v_lshl_add_u32 v76, v76, 7, s56
    v_xor_b32 v2, 0, v77
    v_add_u32 v2, v2, v76
    v_xor_b32 v3, 32, v77
    v_add_u32 v3, v3, v76
    v_xor_b32 v4, 64, v77
    v_add_u32 v4, v4, v76
    v_xor_b32 v5, 96, v77
    v_add_u32 v5, v5, v76
    v_bfe_u32 v76, v1, 4, 1
    v_bfe_u32 v77, v1, 2, 2
    v_lshrrev_b32 v78, 1, v77
    v_lshl_or_b32 v78, v76, 1, v78
    v_lshlrev_b32 v76, 13, v76
    v_lshl_add_u32 v76, v77, 7, v76
    v_lshrrev_b32 v77, 5, v1
    v_lshl_add_u32 v76, v77, 10, v76
    v_and_b32 v77, 3, v1
    v_lshl_add_u32 v76, v77, 3, v76
    v_add_u32 v76, 65536, v76
    s_lshl_b32 s56, s42, 1
    s_add_u32 s57, s56, 0
    v_xor_b32 v77, s57, v78
    v_lshl_add_u32 v6, v77, 5, v76
    s_add_u32 s57, s56, 1
    v_xor_b32 v77, s57, v78
    v_lshl_add_u32 v7, v77, 5, v76
    s_lshl_b32 s56, s42, 11
    s_add_u32 s56, s56, 65536
    v_lshl_add_u32 v8, v1, 4, s56
    s_mul_i32 s56, s41, 229376
    v_lshl_add_u32 v32, v1, 4, s56
    s_mul_i32 s52, s43, 458752
    s_add_u32 s52, s52, 8388608
    s_mul_i32 s56, s45, 28
    s_lshr_b32 s57, s2, 6
    s_lshl_b32 s57, s57, 2
    s_add_u32 s56, s56, s57
    s_lshl_b32 s57, s42, 1
    s_add_u32 s56, s56, s57
    s_lshl_b32 s56, s56, 10
    s_add_u32 s52, s52, s56
    v_and_b32 v76, 15, v1
    v_mul_u32_u24 v76, 528, v76
    v_bfe_u32 v77, v1, 4, 1
    v_lshl_add_u32 v76, v77, 3, v76
    v_lshrrev_b32 v77, 5, v1
    v_lshl_add_u32 v76, v77, 4, v76
    s_mul_i32 s56, s42, 16896
    s_lshl_b32 s57, s41, 8
    s_add_u32 s56, s56, s57
    v_add_u32 v33, s56, v76
    v_lshrrev_b32 v76, 5, v1
    v_mul_u32_u24 v76, 528, v76
    v_and_b32 v77, 31, v1
    v_lshl_add_u32 v76, v77, 4, v76
    s_mul_i32 s56, s40, 8448
    v_add_u32 v34, s56, v76
    v_lshrrev_b32 v76, 5, v1
    v_mul_u32_u24 v76, 8704, v76
    v_lshl_add_u32 v76, v77, 4, v76
    s_mul_i32 s56, s40, 139264
    v_add_u32 v35, s56, v76
    s_mul_i32 s53, s45, 557056
    s_lshl_b32 s56, s43, 9
    s_add_u32 s53, s53, s56
    s_add_u32 s53, s53, 3407872
    v_cmp_eq_u32 vcc, 0, v1
    v_mov_b32 v76, 0x7fffffff
    s_nop 0
    v_cndmask_b32 v22, v76, 0, vcc
    v_mov_b32 v36, 0x3f803f80
    v_mov_b32 v37, 0x3f803f80
    v_mov_b32 v38, 0x3f803f80
    v_mov_b32 v39, 0x3f803f80
    v_mov_b32 v25, 0
    v_mov_b32 v26, 0
    v_mov_b32 v27, 0
    v_mov_b32 v29, 0
    v_mov_b32 v30, 0
    v_mov_b32 v31, 0
    s_waitcnt lgkmcnt(0)
    s_mul_i32 s46, s46, 0x19660D
    s_add_u32 s46, s46, 0x3C6EF35F
    s_add_u32 s101, s47, 1
    s_and_b32 s101, s101, 7
    s_lshl_b32 s87, s101, 7
    s_add_u32 m0, s54, 16384
    s_add_u32 s87, s48, s87
    buffer_load_dwordx4 v9, s[4:7], s87 offen offset:0 lds
    buffer_load_dwordx4 v10, s[4:7], s87 offen offset:1024 lds
    buffer_load_dwordx4 v11, s[4:7], s87 offen offset:2048 lds
    buffer_load_dwordx4 v12, s[4:7], s87 offen offset:3072 lds
    s_lshl_b32 s88, s101, 14
    s_add_u32 m0, s54, 81920
    s_add_u32 s88, s51, s88
    buffer_load_dwordx4 v17, s[28:31], s88 offen offset:0 lds
    buffer_load_dwordx4 v17, s[28:31], s88 offen offset:1024 lds
    buffer_load_dwordx4 v17, s[28:31], s88 offen offset:2048 lds
    buffer_load_dwordx4 v17, s[28:31], s88 offen offset:3072 lds
    s_waitcnt vmcnt(16)
    v_lshlrev_b32 v192, 16, v40
    v_and_b32 v193, 0xffff0000, v40
    v_lshlrev_b32 v200, 16, v44
    v_and_b32 v201, 0xffff0000, v44
    v_lshlrev_b32 v194, 16, v41
    v_and_b32 v195, 0xffff0000, v41
    v_lshlrev_b32 v202, 16, v45
    v_and_b32 v203, 0xffff0000, v45
    v_lshlrev_b32 v196, 16, v42
    v_and_b32 v197, 0xffff0000, v42
    v_lshlrev_b32 v204, 16, v46
    v_and_b32 v205, 0xffff0000, v46
    v_lshlrev_b32 v198, 16, v43
    v_and_b32 v199, 0xffff0000, v43
    v_lshlrev_b32 v206, 16, v47
    v_and_b32 v207, 0xffff0000, v47
    v_add_f32 v208, v192, v193
    v_mul_f32 v210, v192, v192
    v_add_f32 v209, v200, v201
    v_mul_f32 v211, v200, v200
    v_fma_f32 v210, v193, v193, v210
    v_fma_f32 v211, v201, v201, v211
    v_add_f32 v208, v208, v194
    v_fma_f32 v210, v194, v194, v210
    v_add_f32 v209, v209, v202
    v_fma_f32 v211, v202, v202, v211
    v_add_f32 v208, v208, v195
    v_fma_f32 v210, v195, v195, v210
    v_add_f32 v209, v209, v203
    v_fma_f32 v211, v203, v203, v211
    v_add_f32 v208, v208, v196
    v_fma_f32 v210, v196, v196, v210
    v_add_f32 v209, v209, v204
    v_fma_f32 v211, v204, v204, v211
    v_add_f32 v208, v208, v197
    v_fma_f32 v210, v197, v197, v210
    v_add_f32 v209, v209, v205
    v_fma_f32 v211, v205, v205, v211
    v_add_f32 v208, v208, v198
    v_fma_f32 v210, v198, v198, v210
    v_add_f32 v209, v209, v206
    v_fma_f32 v211, v206, v206, v211
    v_add_f32 v208, v208, v199
    v_fma_f32 v210, v199, v199, v210
    v_add_f32 v209, v209, v207
    v_fma_f32 v211, v207, v207, v211
    s_nop 1
    v_permlane32_swap_b32 v208, v209
    v_permlane32_swap_b32 v210, v211
    s_nop 0
    v_add_f32 v208, v208, v209
    v_add_f32 v210, v210, v211
    s_nop 1
    v_permlane16_swap_b32 v208, v210
    s_nop 1
    v_add_f32 v208, v208, v210
    s_nop 1
    v_add_f32_dpp v208, v208, v208 row_ror:8 row_mask:0xf bank_mask:0xf
    s_nop 1
    v_add_f32_dpp v208, v208, v208 row_ror:4 row_mask:0xf bank_mask:0xf
    s_nop 1
    v_add_f32_dpp v208, v208, v208 row_ror:2 row_mask:0xf bank_mask:0xf
    s_nop 1
    v_add_f32_dpp v208, v208, v208 row_ror:1 row_mask:0xf bank_mask:0xf
    v_mov_b32 v210, v208
    s_nop 1
    v_permlane16_swap_b32 v208, v210
    s_nop 1
    v_mul_f32 v208, 0x3b000000, v208
    v_mul_f32 v210, 0x3b000000, v210
    v_fma_f32 v210, -v208, v208, v210
    v_max_f32 v210, 0, v210
    v_cvt_pk_bf16_f32 v208, v208, v210
    v_and_b32 v210, 0xffff0000, v208
    v_add_f32 v210, 0x3727c5ac, v210
    v_cvt_pk_bf16_f32 v210, v210, v210
    v_and_b32 v210, 0xffff0000, v210
    v_sqrt_f32 v210, v210
    v_mov_b32 v212, 0xffff
    v_cvt_pk_bf16_f32 v210, v210, v210
    v_bfi_b32 v209, v212, v208, v210
    v_mov_b32 v210, s46
    v_and_b32 v212, 31, v1
    v_cmp_eq_u32 vcc, 0, v212
    v_lshrrev_b32 v212, 2, v1
    v_mov_b32 v213, 0x7fffffff
    s_lshl_b32 s93, s92, 3
    v_cndmask_b32 v212, v213, v212, vcc
    s_add_u32 s93, s93, 65536
    v_mov_b32 v208, v209
    v_mov_b32 v209, v210
    buffer_store_dwordx2 v[208:209], v212, s[20:23], s93 offen sc1
    s_waitcnt vmcnt(9)
    s_barrier
    ds_read_b128 a[0:3], v2 offset:0
    ds_read_b128 a[128:131], v2 offset:4096
    ds_read_b128 v[104:107], v8 offset:0
    ds_read_b128 v[108:111], v8 offset:1024
    ds_read_b128 a[4:7], v3 offset:0
    ds_read_b128 a[132:135], v3 offset:4096
    ds_read_b128 v[112:115], v8 offset:4096
    ds_read_b128 v[116:119], v8 offset:5120
    s_waitcnt lgkmcnt(4)
    v_mfma_f32_32x32x16_bf16 v[128:143], a[0:3], v[104:107], 0
    ds_read_b128 a[8:11], v4 offset:0
    s_cmp_eq_u32 s89, 0
    s_cbranch_scc1 L_cs1d_B
    s_cmp_eq_u32 s89, 0
    s_cselect_b32 s94, s49, s50
    s_mul_i32 s93, s3, 229376
    s_add_u32 s93, s93, s94
    s_lshl_b32 s94, s40, 11
    s_add_u32 m0, s94, 131072
    s_nop 0
    buffer_load_dwordx4 v13, s[8:11], s93 offen offset:0 lds
    buffer_load_dwordx4 v14, s[8:11], s93 offen offset:1024 lds
    s_add_u32 m0, s94, 139264
    s_nop 0
    buffer_load_dwordx4 v15, s[12:15], s93 offen offset:0 lds
    buffer_load_dwordx4 v16, s[12:15], s93 offen offset:1024 lds
L_cs1d_B:
    v_mfma_f32_32x32x16_bf16 v[144:159], a[128:131], v[104:107], 0
    ds_read_b128 a[136:139], v4 offset:4096
    s_lshl_b32 s56, s40, 9
    s_add_u32 s56, s56, s90
    s_mul_i32 s56, s56, 514
    s_lshl_b32 s57, s91, 7
    s_add_u32 s56, s56, s57
    s_add_u32 s56, s56, 2
    v_lshrrev_b32 v77, 3, v1
    v_mul_u32_u24 v77, 32896, v77
    v_and_b32 v78, 7, v1
    v_lshl_add_u32 v77, v78, 4, v77
    buffer_load_dwordx4 v[48:51], v77, s[32:35], s56 offen
    buffer_load_dwordx4 v[52:55], v77, s[36:39], s56 offen
    v_mfma_f32_32x32x16_bf16 v[160:175], a[0:3], v[108:111], 0
    ds_read_b128 v[120:123], v8 offset:8192
    s_add_u32 s101, s47, 2
    s_and_b32 s101, s101, 7
    s_lshl_b32 s87, s101, 7
    s_add_u32 m0, s54, 32768
    s_add_u32 s87, s48, s87
    buffer_load_dwordx4 v9, s[4:7], s87 offen offset:0 lds
    v_mfma_f32_32x32x16_bf16 v[176:191], a[128:131], v[108:111], 0
    ds_read_b128 v[124:127], v8 offset:9216
    buffer_load_dwordx4 v10, s[4:7], s87 offen offset:1024 lds
    s_waitcnt lgkmcnt(4)
    v_mfma_f32_32x32x16_bf16 v[128:143], a[4:7], v[112:115], v[128:143]
    ds_read_b128 a[12:15], v5 offset:0
    buffer_load_dwordx4 v11, s[4:7], s87 offen offset:2048 lds
    v_mfma_f32_32x32x16_bf16 v[144:159], a[132:135], v[112:115], v[144:159]
    ds_read_b128 a[140:143], v5 offset:4096
    buffer_load_dwordx4 v12, s[4:7], s87 offen offset:3072 lds
    v_mfma_f32_32x32x16_bf16 v[160:175], a[4:7], v[116:119], v[160:175]
    ds_read_b128 v[104:107], v8 offset:12288
    s_lshl_b32 s88, s101, 14
    s_add_u32 m0, s54, 98304
    s_add_u32 s88, s51, s88
    buffer_load_dwordx4 v17, s[28:31], s88 offen offset:0 lds
    v_mfma_f32_32x32x16_bf16 v[176:191], a[132:135], v[116:119], v[176:191]
    ds_read_b128 v[108:111], v8 offset:13312
    buffer_load_dwordx4 v17, s[28:31], s88 offen offset:1024 lds
    s_waitcnt lgkmcnt(4)
    v_mfma_f32_32x32x16_bf16 v[128:143], a[8:11], v[120:123], v[128:143]
    buffer_load_dwordx4 v17, s[28:31], s88 offen offset:2048 lds
    v_mfma_f32_32x32x16_bf16 v[144:159], a[136:139], v[120:123], v[144:159]
    s_waitcnt vmcnt(10) lgkmcnt(0)
    s_barrier
    ds_read_b128 a[16:19], v2 offset:16384
    ds_read_b128 a[144:147], v2 offset:20480
    buffer_load_dwordx4 v17, s[28:31], s88 offen offset:3072 lds
    v_mfma_f32_32x32x16_bf16 v[160:175], a[8:11], v[124:127], v[160:175]
    ds_read_b128 v[112:115], v8 offset:16384
    s_add_u32 s101, s47, 3
    s_and_b32 s101, s101, 7
    s_lshl_b32 s87, s101, 7
    s_add_u32 m0, s54, 49152
    s_add_u32 s87, s48, s87
    buffer_load_dwordx4 v9, s[4:7], s87 offen offset:0 lds
    v_mfma_f32_32x32x16_bf16 v[176:191], a[136:139], v[124:127], v[176:191]
    ds_read_b128 v[116:119], v8 offset:17408
    buffer_load_dwordx4 v10, s[4:7], s87 offen offset:1024 lds
    v_mfma_f32_32x32x16_bf16 v[128:143], a[12:15], v[104:107], v[128:143]
    ds_read_b128 a[20:23], v3 offset:16384
    buffer_load_dwordx4 v11, s[4:7], s87 offen offset:2048 lds
    v_mfma_f32_32x32x16_bf16 v[144:159], a[140:143], v[104:107], v[144:159]
    ds_read_b128 a[148:151], v3 offset:20480
    buffer_load_dwordx4 v12, s[4:7], s87 offen offset:3072 lds
    v_mfma_f32_32x32x16_bf16 v[160:175], a[12:15], v[108:111], v[160:175]
    ds_read_b128 v[120:123], v8 offset:20480
    s_lshl_b32 s88, s101, 14
    s_add_u32 m0, s54, 114688
    s_add_u32 s88, s51, s88
    buffer_load_dwordx4 v17, s[28:31], s88 offen offset:0 lds
    v_mfma_f32_32x32x16_bf16 v[176:191], a[140:143], v[108:111], v[176:191]
    ds_read_b128 v[124:127], v8 offset:21504
    buffer_load_dwordx4 v17, s[28:31], s88 offen offset:1024 lds
    s_waitcnt lgkmcnt(4)
    v_mfma_f32_32x32x16_bf16 v[128:143], a[16:19], v[112:115], v[128:143]
    ds_read_b128 a[24:27], v4 offset:16384
    buffer_load_dwordx4 v17, s[28:31], s88 offen offset:2048 lds
    v_mfma_f32_32x32x16_bf16 v[144:159], a[144:147], v[112:115], v[144:159]
    ds_read_b128 a[152:155], v4 offset:20480
    buffer_load_dwordx4 v17, s[28:31], s88 offen offset:3072 lds
    v_mfma_f32_32x32x16_bf16 v[160:175], a[16:19], v[116:119], v[160:175]
    ds_read_b128 v[104:107], v8 offset:24576
    s_add_u32 s101, s47, 4
    s_and_b32 s101, s101, 7
    s_lshl_b32 s87, s101, 7
    s_add_u32 m0, s54, 0
    s_add_u32 s87, s48, s87
    buffer_load_dwordx4 v9, s[4:7], s87 offen offset:0 lds
    v_mfma_f32_32x32x16_bf16 v[176:191], a[144:147], v[116:119], v[176:191]
    ds_read_b128 v[108:111], v8 offset:25600
    buffer_load_dwordx4 v10, s[4:7], s87 offen offset:1024 lds
    s_waitcnt lgkmcnt(4)
    v_mfma_f32_32x32x16_bf16 v[128:143], a[20:23], v[120:123], v[128:143]
    ds_read_b128 a[28:31], v5 offset:16384
    buffer_load_dwordx4 v11, s[4:7], s87 offen offset:2048 lds
    v_mfma_f32_32x32x16_bf16 v[144:159], a[148:151], v[120:123], v[144:159]
    ds_read_b128 a[156:159], v5 offset:20480
    buffer_load_dwordx4 v12, s[4:7], s87 offen offset:3072 lds
    v_mfma_f32_32x32x16_bf16 v[160:175], a[20:23], v[124:127], v[160:175]
    ds_read_b128 v[112:115], v8 offset:28672
    s_lshl_b32 s88, s101, 14
    s_add_u32 m0, s54, 65536
    s_add_u32 s88, s51, s88
    buffer_load_dwordx4 v17, s[28:31], s88 offen offset:0 lds
    v_mfma_f32_32x32x16_bf16 v[176:191], a[148:151], v[124:127], v[176:191]
    ds_read_b128 v[116:119], v8 offset:29696
    buffer_load_dwordx4 v17, s[28:31], s88 offen offset:1024 lds
    s_waitcnt lgkmcnt(4)
    v_mfma_f32_32x32x16_bf16 v[128:143], a[24:27], v[104:107], v[128:143]
    buffer_load_dwordx4 v17, s[28:31], s88 offen offset:2048 lds
    v_mfma_f32_32x32x16_bf16 v[144:159], a[152:155], v[104:107], v[144:159]
    s_waitcnt vmcnt(15) lgkmcnt(0)
    s_barrier
    ds_read_b128 a[32:35], v2 offset:32768
    ds_read_b128 a[160:163], v2 offset:36864
    buffer_load_dwordx4 v17, s[28:31], s88 offen offset:3072 lds
    v_mfma_f32_32x32x16_bf16 v[160:175], a[24:27], v[108:111], v[160:175]
    ds_read_b128 v[120:123], v8 offset:32768
    s_add_u32 s101, s47, 5
    s_and_b32 s101, s101, 7
    s_lshl_b32 s87, s101, 7
    s_add_u32 m0, s54, 16384
    s_add_u32 s87, s48, s87
    buffer_load_dwordx4 v9, s[4:7], s87 offen offset:0 lds
    v_mfma_f32_32x32x16_bf16 v[176:191], a[152:155], v[108:111], v[176:191]
    ds_read_b128 v[124:127], v8 offset:33792
    buffer_load_dwordx4 v10, s[4:7], s87 offen offset:1024 lds
    s_cmp_eq_u32 s89, 0
    s_cselect_b32 s95, 0, 1
    s_cbranch_scc1 L_cs1c_B
    v_mov_b32 v76, v6
    s_cmp_eq_u32 s41, 0
    s_cbranch_scc1 L_cs1c_Ba
    v_mov_b32 v76, v7
L_cs1c_Ba:
    v_add_u32 v76, 65536, v76
    ds_read_b64_tr_b16 v[68:69], v76 offset:0
    ds_read_b64_tr_b16 v[70:71], v76 offset:512
    ds_read_b64_tr_b16 v[72:73], v76 offset:2048
    ds_read_b64_tr_b16 v[74:75], v76 offset:2560
    s_waitcnt lgkmcnt(0)
    v_mfma_f32_32x32x16_bf16 v[88:103], v[36:39], v[68:71], 0
    v_mfma_f32_32x32x16_bf16 v[88:103], v[36:39], v[72:75], v[88:103]
    ds_read_b64_tr_b16 v[68:69], v76 offset:4096
    ds_read_b64_tr_b16 v[70:71], v76 offset:4608
    ds_read_b64_tr_b16 v[72:73], v76 offset:6144
    ds_read_b64_tr_b16 v[74:75], v76 offset:6656
    s_waitcnt lgkmcnt(0)
    v_mfma_f32_32x32x16_bf16 v[88:103], v[36:39], v[68:71], v[88:103]
    v_mfma_f32_32x32x16_bf16 v[88:103], v[36:39], v[72:75], v[88:103]
L_cs1c_B:
    v_mfma_f32_32x32x16_bf16 v[128:143], a[28:31], v[112:115], v[128:143]
    ds_read_b128 a[36:39], v3 offset:32768
    buffer_load_dwordx4 v11, s[4:7], s87 offen offset:2048 lds
    s_cmp_eq_u32 s95, 0
    s_cbranch_scc1 L_csst_B_1
    s_lshl_b32 s93, s44, 3
    s_lshl_b32 s94, s42, 1
    s_add_u32 s93, s93, s94
    s_add_u32 s93, s93, s41
    s_lshl_b32 s94, s89, 2
    s_add_u32 s93, s93, s94
    s_lshl_b32 s93, s93, 3
    s_add_u32 s93, s93, s3
    s_lshl_b32 s93, s93, 8
    s_add_u32 s93, s93, 131072
    v_mov_b32 v89, s46
    v_lshlrev_b32 v76, 3, v1
    v_cmp_gt_u32 vcc, 32, v1
    v_mov_b32 v77, 0x7fffffff
    s_nop 0
    v_cndmask_b32 v76, v77, v76, vcc
    buffer_store_dwordx2 v[88:89], v76, s[20:23], s93 offen sc1
L_csst_B_1:
    v_mfma_f32_32x32x16_bf16 v[144:159], a[156:159], v[112:115], v[144:159]
    ds_read_b128 a[164:167], v3 offset:36864
    buffer_load_dwordx4 v12, s[4:7], s87 offen offset:3072 lds
    s_cmp_lg_u32 s40, 0
    s_cbranch_scc1 L_tp_B_0
    s_and_b32 s96, s43, 7
    s_lshl_b32 s96, s96, 6
    v_add_u32 v45, s96, v1
    v_mul_u32_u24 v45, 3584, v45
    buffer_load_dword v0, v45, s[8:11], s50 offen
L_tp_B_0:
    v_mfma_f32_32x32x16_bf16 v[160:175], a[28:31], v[116:119], v[160:175]
    ds_read_b128 v[104:107], v8 offset:36864
    s_lshl_b32 s88, s101, 14
    s_add_u32 m0, s54, 81920
    s_add_u32 s88, s51, s88
    buffer_load_dwordx4 v17, s[28:31], s88 offen offset:0 lds
    v_mfma_f32_32x32x16_bf16 v[176:191], a[156:159], v[116:119], v[176:191]
    ds_read_b128 v[108:111], v8 offset:37888
    buffer_load_dwordx4 v17, s[28:31], s88 offen offset:1024 lds
    s_waitcnt lgkmcnt(4)
    v_mfma_f32_32x32x16_bf16 v[128:143], a[32:35], v[120:123], v[128:143]
    ds_read_b128 a[40:43], v4 offset:32768
    buffer_load_dwordx4 v17, s[28:31], s88 offen offset:2048 lds
    v_and_b32 v76, 7, v1
    v_lshrrev_b32 v77, 3, v1
    s_lshl_b32 s93, s40, 1
    v_lshrrev_b32 v78, 2, v77
    v_mfma_f32_32x32x16_bf16 v[144:159], a[160:163], v[120:123], v[144:159]
    ds_read_b128 a[168:171], v4 offset:36864
    buffer_load_dwordx4 v17, s[28:31], s88 offen offset:3072 lds
    v_add_u32 v78, s93, v78
    v_xor_b32 v78, v78, v76
    v_lshlrev_b32 v78, 4, v78
    v_and_b32 v77, 3, v77
    v_mfma_f32_32x32x16_bf16 v[160:175], a[32:35], v[124:127], v[160:175]
    ds_read_b128 v[112:115], v8 offset:40960
    v_lshl_add_u32 v78, v77, 2, v78
    v_mul_u32_u24 v76, 1152, v76
    v_add_u32 v78, v78, v76
    v_add_u32 v78, 147456, v78
    s_mov_b32 s93, 0x05040100
    v_mfma_f32_32x32x16_bf16 v[176:191], a[160:163], v[124:127], v[176:191]
    ds_read_b128 v[116:119], v8 offset:41984
    s_mov_b32 s94, 0x07060302
    v_perm_b32 v56, v52, v48, s93
    v_perm_b32 v57, v52, v48, s94
    v_perm_b32 v58, v53, v49, s93
    s_waitcnt lgkmcnt(4)
    v_mfma_f32_32x32x16_bf16 v[128:143], a[36:39], v[104:107], v[128:143]
    ds_read_b128 a[44:47], v5 offset:32768
    v_perm_b32 v59, v53, v49, s94
    v_perm_b32 v60, v54, v50, s93
    v_perm_b32 v61, v54, v50, s94
    v_perm_b32 v62, v55, v51, s93
    v_perm_b32 v63, v55, v51, s94
    v_mfma_f32_32x32x16_bf16 v[144:159], a[164:167], v[104:107], v[144:159]
    ds_read_b128 a[172:175], v5 offset:36864
    ds_write_b32 v78, v56 offset:0
    ds_write_b32 v78, v57 offset:144
    ds_write_b32 v78, v58 offset:288
    ds_write_b32 v78, v59 offset:432
    ds_write_b32 v78, v60 offset:576
    v_mfma_f32_32x32x16_bf16 v[160:175], a[36:39], v[108:111], v[160:175]
    ds_read_b128 v[120:123], v8 offset:45056
    ds_write_b32 v78, v61 offset:720
    ds_write_b32 v78, v62 offset:864
    ds_write_b32 v78, v63 offset:1008
    s_cmp_lg_u32 s40, 1
    s_cbranch_scc1 L_tp_B_1
    s_and_b32 s96, s43, 7
    s_lshl_b32 s96, s96, 6
    v_add_u32 v45, s96, v1
    v_mul_u32_u24 v45, 3584, v45
    buffer_load_dword v0, v45, s[12:15], s50 offen
L_tp_B_1:
    v_mfma_f32_32x32x16_bf16 v[176:191], a[164:167], v[108:111], v[176:191]
    ds_read_b128 v[124:127], v8 offset:46080
    v_and_b32 v76, 31, v1
    v_and_b32 v77, 3, v76
    v_lshlrev_b32 v78, 8, v77
    v_lshrrev_b32 v77, 3, v76
    v_lshl_add_u32 v78, v77, 4, v78
    s_waitcnt lgkmcnt(12)
    v_mfma_f32_32x32x16_bf16 v[128:143], a[40:43], v[112:115], v[128:143]
    v_bfe_u32 v77, v76, 2, 1
    v_lshl_add_u32 v78, v77, 3, v78
    s_lshl_b32 s94, s41, 7
    v_add_u32 v78, s94, v78
    v_add_u32 v79, 64, v78
    s_lshl_b32 s94, s43, 10
    v_mfma_f32_32x32x16_bf16 v[144:159], a[168:171], v[112:115], v[144:159]
    s_waitcnt vmcnt(16) lgkmcnt(0)
    s_barrier
    ds_read_b128 a[48:51], v2 offset:49152
    ds_read_b128 a[176:179], v2 offset:53248
    s_add_u32 s101, s47, 6
    s_and_b32 s101, s101, 7
    s_lshl_b32 s87, s101, 7
    s_add_u32 m0, s54, 32768
    s_add_u32 s87, s48, s87
    buffer_load_dwordx4 v9, s[4:7], s87 offen offset:0 lds
    v_mfma_f32_32x32x16_bf16 v[160:175], a[40:43], v[116:119], v[160:175]
    ds_read_b128 v[104:107], v8 offset:49152
    s_add_u32 s94, s94, 65536
    buffer_load_dwordx2 v[64:65], v78, s[20:23], s94 offen sc1
    buffer_load_dwordx2 v[66:67], v79, s[20:23], s94 offen sc1
    v_mfma_f32_32x32x16_bf16 v[176:191], a[168:171], v[116:119], v[176:191]
    ds_read_b128 v[108:111], v8 offset:50176
    buffer_load_dwordx4 v10, s[4:7], s87 offen offset:1024 lds
    v_mfma_f32_32x32x16_bf16 v[128:143], a[44:47], v[120:123], v[128:143]
    ds_read_b128 a[52:55], v3 offset:49152
    s_cmp_lg_u32 s40, 0
    s_cbranch_scc1 L_tw_B_0
    v_lshlrev_b32 v45, 7, v1
    s_lshr_b32 s96, s2, 3
    s_mul_i32 s96, s96, 57344
    s_add_u32 s96, s96, 0
    buffer_load_dword v0, v45, s[16:19], s96 offen
L_tw_B_0:
    v_mfma_f32_32x32x16_bf16 v[144:159], a[172:175], v[120:123], v[144:159]
    ds_read_b128 a[180:183], v3 offset:53248
    buffer_load_dwordx4 v11, s[4:7], s87 offen offset:2048 lds
    v_mfma_f32_32x32x16_bf16 v[160:175], a[44:47], v[124:127], v[160:175]
    ds_read_b128 v[112:115], v8 offset:53248
    v_mfma_f32_32x32x16_bf16 v[176:191], a[172:175], v[124:127], v[176:191]
    ds_read_b128 v[116:119], v8 offset:54272
    buffer_load_dwordx4 v12, s[4:7], s87 offen offset:3072 lds
    s_waitcnt lgkmcnt(4)
    v_mfma_f32_32x32x16_bf16 v[128:143], a[48:51], v[104:107], v[128:143]
    ds_read_b128 a[56:59], v4 offset:49152
    v_mfma_f32_32x32x16_bf16 v[144:159], a[176:179], v[104:107], v[144:159]
    ds_read_b128 a[184:187], v4 offset:53248
    s_lshl_b32 s88, s101, 14
    s_add_u32 m0, s54, 98304
    s_add_u32 s88, s51, s88
    buffer_load_dwordx4 v17, s[28:31], s88 offen offset:0 lds
    v_mfma_f32_32x32x16_bf16 v[160:175], a[48:51], v[108:111], v[160:175]
    ds_read_b128 v[120:123], v8 offset:57344
    v_mfma_f32_32x32x16_bf16 v[176:191], a[176:179], v[108:111], v[176:191]
    ds_read_b128 v[124:127], v8 offset:58368
    buffer_load_dwordx4 v17, s[28:31], s88 offen offset:1024 lds
    s_waitcnt lgkmcnt(4)
    v_mfma_f32_32x32x16_bf16 v[128:143], a[52:55], v[112:115], v[128:143]
    ds_read_b128 a[60:63], v5 offset:49152
    s_cmp_lg_u32 s40, 3
    s_cbranch_scc1 L_tch_Bb
    v_lshlrev_b32 v45, 7, v1
    s_lshr_b32 s96, s2, 3
    s_min_u32 s96, s96, 6
    s_lshl_b32 s96, s96, 13
    s_add_u32 s97, s96, 524288
    buffer_load_dword v0, v45, s[28:31], s97 offen
L_tch_Bb:
    v_mfma_f32_32x32x16_bf16 v[144:159], a[180:183], v[112:115], v[144:159]
    ds_read_b128 a[188:191], v5 offset:53248
    buffer_load_dwordx4 v17, s[28:31], s88 offen offset:2048 lds
    v_mfma_f32_32x32x16_bf16 v[160:175], a[52:55], v[116:119], v[160:175]
    ds_read_b128 v[104:107], v8 offset:61440
    v_mfma_f32_32x32x16_bf16 v[176:191], a[180:183], v[116:119], v[176:191]
    ds_read_b128 v[108:111], v8 offset:62464
    buffer_load_dwordx4 v17, s[28:31], s88 offen offset:3072 lds
    s_waitcnt lgkmcnt(4)
    v_mfma_f32_32x32x16_bf16 v[128:143], a[56:59], v[120:123], v[128:143]
    v_mfma_f32_32x32x16_bf16 v[144:159], a[184:187], v[120:123], v[144:159]
    s_waitcnt vmcnt(18) lgkmcnt(0)
    s_barrier
    ds_read_b128 a[64:67], v2 offset:0
    ds_read_b128 a[192:195], v2 offset:4096
    s_add_u32 s101, s47, 7
    s_and_b32 s101, s101, 7
    s_lshl_b32 s87, s101, 7
    s_add_u32 m0, s54, 49152
    s_add_u32 s87, s48, s87
    buffer_load_dwordx4 v9, s[4:7], s87 offen offset:0 lds
    v_mfma_f32_32x32x16_bf16 v[160:175], a[56:59], v[124:127], v[160:175]
    ds_read_b128 v[112:115], v8 offset:0
    v_lshrrev_b32 v76, 3, v1
    s_lshl_b32 s93, s40, 4
    v_add_u32 v76, s93, v76
    v_and_b32 v77, 7, v1
    s_lshl_b32 s94, s40, 1
    v_mfma_f32_32x32x16_bf16 v[176:191], a[184:187], v[124:127], v[176:191]
    ds_read_b128 v[116:119], v8 offset:1024
    buffer_load_dwordx4 v10, s[4:7], s87 offen offset:1024 lds
    v_xor_b32 v78, s94, v77
    v_lshlrev_b32 v78, 4, v78
    v_mul_u32_u24 v79, 144, v76
    v_add_u32 v79, 147456, v79
    v_mfma_f32_32x32x16_bf16 v[128:143], a[60:63], v[104:107], v[128:143]
    ds_read_b128 a[68:71], v3 offset:0
    v_add_u32 v56, v79, v78
    v_xor_b32 v78, 16, v78
    v_add_u32 v57, v79, v78
    ds_read_b128 v[48:51], v56
    ds_read_b128 v[52:55], v57 offset:1152
    v_mfma_f32_32x32x16_bf16 v[144:159], a[188:191], v[104:107], v[144:159]
    ds_read_b128 a[196:199], v3 offset:4096
    buffer_load_dwordx4 v11, s[4:7], s87 offen offset:2048 lds
    v_mul_u32_u24 v76, 8320, v76
    v_lshl_add_u32 v76, v77, 4, v76
    v_add_u32 v77, 66560, v76
    s_mul_i32 s93, s91, 532480
    v_mfma_f32_32x32x16_bf16 v[160:175], a[60:63], v[108:111], v[160:175]
    ds_read_b128 v[120:123], v8 offset:4096
    s_lshl_b32 s94, s90, 7
    s_add_u32 s93, s93, s94
    s_add_u32 s93, s93, 1048576
    s_waitcnt lgkmcnt(2)
    buffer_store_dwordx4 v[48:51], v76, s[20:23], s93 offen sc1
    v_mfma_f32_32x32x16_bf16 v[176:191], a[188:191], v[108:111], v[176:191]
    ds_read_b128 v[124:127], v8 offset:5120
    buffer_load_dwordx4 v12, s[4:7], s87 offen offset:3072 lds
    buffer_store_dwordx4 v[52:55], v77, s[20:23], s93 offen sc1
    s_cmp_lg_u32 s40, 1
    s_cbranch_scc1 L_tw_B_1
    v_lshlrev_b32 v45, 7, v1
    s_lshr_b32 s96, s2, 3
    s_mul_i32 s96, s96, 57344
    s_add_u32 s96, s96, 8192
    buffer_load_dword v0, v45, s[16:19], s96 offen
L_tw_B_1:
    v_mfma_f32_32x32x16_bf16 v[128:143], a[64:67], v[112:115], v[128:143]
    ds_read_b128 a[72:75], v4 offset:0
    v_mfma_f32_32x32x16_bf16 v[144:159], a[192:195], v[112:115], v[144:159]
    ds_read_b128 a[200:203], v4 offset:4096
    s_lshl_b32 s88, s101, 14
    s_add_u32 m0, s54, 114688
    s_add_u32 s88, s51, s88
    buffer_load_dwordx4 v17, s[28:31], s88 offen offset:0 lds
    v_mfma_f32_32x32x16_bf16 v[160:175], a[64:67], v[116:119], v[160:175]
    ds_read_b128 v[104:107], v8 offset:8192
    v_mfma_f32_32x32x16_bf16 v[176:191], a[192:195], v[116:119], v[176:191]
    ds_read_b128 v[108:111], v8 offset:9216
    buffer_load_dwordx4 v17, s[28:31], s88 offen offset:1024 lds
    s_waitcnt lgkmcnt(4)
    v_mfma_f32_32x32x16_bf16 v[128:143], a[68:71], v[120:123], v[128:143]
    ds_read_b128 a[76:79], v5 offset:0
    s_cmp_lg_u32 s40, 2
    s_cbranch_scc1 L_tch_Bc
    v_lshlrev_b32 v45, 7, v1
    s_lshr_b32 s96, s2, 3
    s_min_u32 s96, s96, 1
    s_lshl_b32 s96, s96, 13
    s_getpc_b64 s[72:73]
L_tch_Bpc:
    s_add_u32 s72, s72, L_common-L_tch_Bpc
    s_addc_u32 s73, s73, 0
    s_mov_b32 s74, L_codeend-L_common
    s_mov_b32 s75, 0x20000
    buffer_load_dword v0, v45, s[72:75], s96 offen
L_tch_Bc:
    v_mfma_f32_32x32x16_bf16 v[144:159], a[196:199], v[120:123], v[144:159]
    ds_read_b128 a[204:207], v5 offset:4096
    buffer_load_dwordx4 v17, s[28:31], s88 offen offset:2048 lds
    v_mfma_f32_32x32x16_bf16 v[160:175], a[68:71], v[124:127], v[160:175]
    ds_read_b128 v[112:115], v8 offset:12288
    v_mfma_f32_32x32x16_bf16 v[176:191], a[196:199], v[124:127], v[176:191]
    ds_read_b128 v[116:119], v8 offset:13312
    buffer_load_dwordx4 v17, s[28:31], s88 offen offset:3072 lds
    s_waitcnt lgkmcnt(4)
    v_mfma_f32_32x32x16_bf16 v[128:143], a[72:75], v[104:107], v[128:143]
    v_mfma_f32_32x32x16_bf16 v[144:159], a[200:203], v[104:107], v[144:159]
    s_waitcnt vmcnt(20) lgkmcnt(0)
    s_barrier
    ds_read_b128 a[80:83], v2 offset:16384
    ds_read_b128 a[208:211], v2 offset:20480
    s_add_u32 s101, s47, 0
    s_and_b32 s101, s101, 7
    s_mul_i32 s88, s101, 229376
    s_add_u32 m0, s55, 0
    s_add_u32 s88, s50, s88
    buffer_load_dwordx4 v13, s[8:11], s88 offen offset:0 lds
    v_mfma_f32_32x32x16_bf16 v[160:175], a[72:75], v[108:111], v[160:175]
    ds_read_b128 v[120:123], v8 offset:16384
    s_waitcnt vmcnt(18)
    v_cmp_ne_u32 vcc, s46, v65
    v_cmp_ne_u32 s[62:63], s46, v67
    s_nop 3
    s_or_b64 vcc, vcc, s[62:63]
    s_cmp_lg_u64 vcc, 0
    s_cbranch_scc1 L_slow_stB
L_back_stB:
    v_mfma_f32_32x32x16_bf16 v[176:191], a[200:203], v[108:111], v[176:191]
    ds_read_b128 v[124:127], v8 offset:17408
    v_and_b32 v65, 0xffff0000, v64
    v_and_b32 v64, 0xffff, v64
    v_xor_b32 v64, 0x8000, v64
    v_lshl_or_b32 v64, v64, 16, v64
    v_mul_f32 v20, v65, v65
    v_mfma_f32_32x32x16_bf16 v[128:143], a[76:79], v[112:115], v[128:143]
    ds_read_b128 a[84:87], v3 offset:16384
    v_rcp_f32 v65, v65
    v_cmp_gt_u32 vcc, 32, v1
    s_nop 0
    v_mul_f32 v18, 0xbfb8aa3b, v65
    v_mfma_f32_32x32x16_bf16 v[144:159], a[204:207], v[112:115], v[144:159]
    ds_read_b128 a[212:215], v3 offset:20480
    buffer_load_dwordx4 v14, s[8:11], s88 offen offset:1024 lds
    v_cndmask_b32 v24, 0, v64, vcc
    v_and_b32 v76, 31, v1
    v_lshlrev_b32 v76, 2, v76
    s_lshl_b32 s94, s41, 8
    v_mfma_f32_32x32x16_bf16 v[160:175], a[76:79], v[116:119], v[160:175]
    ds_read_b128 v[104:107], v8 offset:20480
    s_add_u32 s94, s94, 160768
    v_add_u32 v76, s94, v76
    ds_write_b32 v76, v65
    v_and_b32 v67, 0xffff0000, v66
    v_and_b32 v66, 0xffff, v66
    v_mfma_f32_32x32x16_bf16 v[176:191], a[204:207], v[116:119], v[176:191]
    ds_read_b128 v[108:111], v8 offset:21504
    v_xor_b32 v66, 0x8000, v66
    v_lshl_or_b32 v66, v66, 16, v66
    v_mul_f32 v21, v67, v67
    v_rcp_f32 v67, v67
    s_waitcnt lgkmcnt(5)
    v_mfma_f32_32x32x16_bf16 v[128:143], a[80:83], v[120:123], v[128:143]
    ds_read_b128 a[88:91], v4 offset:16384
    v_cmp_gt_u32 vcc, 32, v1
    s_nop 0
    v_mul_f32 v19, 0xbfb8aa3b, v67
    v_cndmask_b32 v28, 0, v66, vcc
    v_and_b32 v76, 31, v1
    v_mfma_f32_32x32x16_bf16 v[144:159], a[208:211], v[120:123], v[144:159]
    ds_read_b128 a[216:219], v4 offset:20480
    s_add_u32 m0, s55, 8192
    s_nop 0
    buffer_load_dwordx4 v15, s[12:15], s88 offen offset:0 lds
    v_lshlrev_b32 v76, 2, v76
    s_lshl_b32 s94, s41, 8
    v_mfma_f32_32x32x16_bf16 v[160:175], a[80:83], v[124:127], v[160:175]
    ds_read_b128 v[112:115], v8 offset:24576
    s_add_u32 s94, s94, 160896
    v_add_u32 v76, s94, v76
    ds_write_b32 v76, v67
    s_cmp_lg_u32 s40, 2
    s_cbranch_scc1 L_tw_B_2
    v_lshlrev_b32 v45, 7, v1
    s_lshr_b32 s96, s2, 3
    s_mul_i32 s96, s96, 57344
    s_add_u32 s96, s96, 16384
    buffer_load_dword v0, v45, s[16:19], s96 offen
L_tw_B_2:
    v_mfma_f32_32x32x16_bf16 v[176:191], a[208:211], v[124:127], v[176:191]
    ds_read_b128 v[116:119], v8 offset:25600
    v_lshlrev_b32 v43, 4, v1
    v_lshrrev_b32 v46, 3, v1
    v_lshlrev_b32 v44, 10, v46
    v_bfe_u32 v46, v1, 4, 1
    v_bfe_u32 v47, v1, 2, 1
    s_waitcnt lgkmcnt(5)
    v_mfma_f32_32x32x16_bf16 v[128:143], a[84:87], v[104:107], v[128:143]
    ds_read_b128 a[92:95], v5 offset:16384
    v_xor_b32 v46, v46, v47
    v_lshl_add_u32 v44, v46, 6, v44
    v_and_b32 v46, 3, v1
    v_lshl_add_u32 v44, v46, 4, v44
    v_add_u32 v46, 7168, v44
    v_mfma_f32_32x32x16_bf16 v[144:159], a[212:215], v[104:107], v[144:159]
    ds_read_b128 a[220:223], v5 offset:20480
    buffer_load_dwordx4 v16, s[12:15], s88 offen offset:1024 lds
    v_add_u32 v47, 114688, v43
    s_mul_i32 s73, s40, 393216
    s_lshl_b32 s76, s86, 7
    s_add_u32 s73, s73, s76
    v_mfma_f32_32x32x16_bf16 v[160:175], a[84:87], v[108:111], v[160:175]
    ds_read_b128 v[120:123], v8 offset:28672
    s_lshl_b32 s82, s40, 16
    s_add_u32 s82, s82, s76
    s_add_u32 s82, s82, 1572864
    s_lshl_b32 s75, s40, 11
    s_mul_i32 s77, s86, 11
    s_lshr_b32 s77, s77, 5
    s_mul_i32 s77, s77, 3
    s_sub_u32 s77, s86, s77
    v_mfma_f32_32x32x16_bf16 v[176:191], a[212:215], v[108:111], v[176:191]
    ds_read_b128 v[124:127], v8 offset:29696
    s_add_u32 s79, s77, 0
    s_sub_u32 s76, s79, 3
    s_min_u32 s79, s79, s76
    s_lshl_b32 s79, s79, 17
    s_add_u32 s32, s73, s79
    s_waitcnt lgkmcnt(4)
    v_mfma_f32_32x32x16_bf16 v[128:143], a[88:91], v[112:115], v[128:143]
    s_add_u32 s79, s77, 1
    s_sub_u32 s76, s79, 3
    s_min_u32 s79, s79, s76
    s_lshl_b32 s79, s79, 17
    s_add_u32 s33, s73, s79
    s_add_u32 s79, s77, 2
    s_sub_u32 s76, s79, 3
    s_min_u32 s79, s79, s76
    s_lshl_b32 s79, s79, 17
    s_add_u32 s34, s73, s79
    v_mfma_f32_32x32x16_bf16 v[144:159], a[216:219], v[112:115], v[144:159]
    s_waitcnt vmcnt(14) lgkmcnt(0)
    s_barrier
    ds_read_b128 a[96:99], v2 offset:32768
    ds_read_b128 a[224:227], v2 offset:36864
    s_add_u32 s101, s47, 1
    s_and_b32 s101, s101, 7
    s_mul_i32 s88, s101, 229376
    s_add_u32 m0, s55, 16384
    s_add_u32 s88, s50, s88
    buffer_load_dwordx4 v13, s[8:11], s88 offen offset:0 lds
    v_mfma_f32_32x32x16_bf16 v[160:175], a[88:91], v[116:119], v[160:175]
    ds_read_b128 v[104:107], v8 offset:32768
    s_add_u32 s79, s86, 0
    s_and_b32 s79, s79, 3
    s_lshl_b32 s76, s79, 17
    s_add_u32 s76, s76, 65536
    s_add_u32 s76, s76, s73
    s_cmp_eq_u32 s79, 3
    s_cselect_b32 s35, s82, s76
    v_mfma_f32_32x32x16_bf16 v[176:191], a[216:219], v[116:119], v[176:191]
    ds_read_b128 v[108:111], v8 offset:33792
    s_add_u32 s79, s86, 1
    s_and_b32 s79, s79, 3
    s_lshl_b32 s76, s79, 17
    s_add_u32 s76, s76, 65536
    s_add_u32 s76, s76, s73
    s_cmp_eq_u32 s79, 3
    s_cselect_b32 s36, s82, s76
    v_mfma_f32_32x32x16_bf16 v[128:143], a[92:95], v[120:123], v[128:143]
    ds_read_b128 a[100:103], v3 offset:32768
    s_cmp_lg_u32 s40, 3
    s_cbranch_scc1 L_tw_B_3
    v_lshlrev_b32 v45, 7, v1
    s_lshr_b32 s96, s2, 3
    s_mul_i32 s96, s96, 57344
    s_add_u32 s96, s96, 24576
    buffer_load_dword v0, v45, s[16:19], s96 offen
L_tw_B_3:
    v_mfma_f32_32x32x16_bf16 v[144:159], a[220:223], v[120:123], v[144:159]
    ds_read_b128 a[228:231], v3 offset:36864
    buffer_load_dwordx4 v14, s[8:11], s88 offen offset:1024 lds
    s_add_u32 s79, s86, 2
    s_and_b32 s79, s79, 3
    s_lshl_b32 s76, s79, 17
    s_add_u32 s76, s76, 65536
    s_add_u32 s76, s76, s73
    s_cmp_eq_u32 s79, 3
    s_cselect_b32 s37, s82, s76
    v_mfma_f32_32x32x16_bf16 v[160:175], a[92:95], v[124:127], v[160:175]
    ds_read_b128 v[112:115], v8 offset:36864
    s_add_u32 s79, s86, 3
    s_and_b32 s79, s79, 3
    s_lshl_b32 s76, s79, 17
    s_add_u32 s76, s76, 65536
    s_add_u32 s76, s76, s73
    s_cmp_eq_u32 s79, 3
    s_cselect_b32 s38, s82, s76
    v_mfma_f32_32x32x16_bf16 v[176:191], a[220:223], v[124:127], v[176:191]
    ds_read_b128 v[116:119], v8 offset:37888
    s_waitcnt lgkmcnt(4)
    v_mfma_f32_32x32x16_bf16 v[128:143], a[96:99], v[104:107], v[128:143]
    ds_read_b128 a[104:107], v4 offset:32768
    v_mfma_f32_32x32x16_bf16 v[144:159], a[224:227], v[104:107], v[144:159]
    ds_read_b128 a[232:235], v4 offset:36864
    s_add_u32 m0, s55, 24576
    s_nop 0
    buffer_load_dwordx4 v15, s[12:15], s88 offen offset:0 lds
    v_mfma_f32_32x32x16_bf16 v[160:175], a[96:99], v[108:111], v[160:175]
    ds_read_b128 v[120:123], v8 offset:40960
    v_mfma_f32_32x32x16_bf16 v[176:191], a[224:227], v[108:111], v[176:191]
    ds_read_b128 v[124:127], v8 offset:41984
    s_waitcnt lgkmcnt(4)
    v_mfma_f32_32x32x16_bf16 v[128:143], a[100:103], v[112:115], v[128:143]
    ds_read_b128 a[108:111], v5 offset:32768
    v_mfma_f32_32x32x16_bf16 v[144:159], a[228:231], v[112:115], v[144:159]
    ds_read_b128 a[236:239], v5 offset:36864
    buffer_load_dwordx4 v16, s[12:15], s88 offen offset:1024 lds
    v_mfma_f32_32x32x16_bf16 v[160:175], a[100:103], v[116:119], v[160:175]
    ds_read_b128 v[104:107], v8 offset:45056
    v_mfma_f32_32x32x16_bf16 v[176:191], a[228:231], v[116:119], v[176:191]
    ds_read_b128 v[108:111], v8 offset:46080
    s_waitcnt lgkmcnt(4)
    v_mfma_f32_32x32x16_bf16 v[128:143], a[104:107], v[120:123], v[128:143]
    v_mfma_f32_32x32x16_bf16 v[144:159], a[232:235], v[120:123], v[144:159]
    s_waitcnt vmcnt(8) lgkmcnt(0)
    s_barrier
    ds_read_b128 a[112:115], v2 offset:49152
    ds_read_b128 a[240:243], v2 offset:53248
    s_add_u32 s101, s47, 2
    s_and_b32 s101, s101, 7
    s_mul_i32 s88, s101, 229376
    s_add_u32 m0, s55, 32768
    s_add_u32 s88, s50, s88
    buffer_load_dwordx4 v13, s[8:11], s88 offen offset:0 lds
    v_mfma_f32_32x32x16_bf16 v[160:175], a[104:107], v[124:127], v[160:175]
    ds_read_b128 v[112:115], v8 offset:49152
    v_mfma_f32_32x32x16_bf16 v[176:191], a[232:235], v[124:127], v[176:191]
    ds_read_b128 v[116:119], v8 offset:50176
    v_mfma_f32_32x32x16_bf16 v[128:143], a[108:111], v[104:107], v[128:143]
    ds_read_b128 a[116:119], v3 offset:49152
    s_cmp_lg_u32 s40, 0
    s_cbranch_scc1 L_tw_B_4
    v_lshlrev_b32 v45, 7, v1
    s_lshr_b32 s96, s2, 3
    s_mul_i32 s96, s96, 57344
    s_add_u32 s96, s96, 32768
    buffer_load_dword v0, v45, s[16:19], s96 offen
L_tw_B_4:
    v_mfma_f32_32x32x16_bf16 v[144:159], a[236:239], v[104:107], v[144:159]
    ds_read_b128 a[244:247], v3 offset:53248
    buffer_load_dwordx4 v14, s[8:11], s88 offen offset:1024 lds
    v_mfma_f32_32x32x16_bf16 v[160:175], a[108:111], v[108:111], v[160:175]
    ds_read_b128 v[120:123], v8 offset:53248
    v_mfma_f32_32x32x16_bf16 v[176:191], a[236:239], v[108:111], v[176:191]
    ds_read_b128 v[124:127], v8 offset:54272
    s_waitcnt lgkmcnt(4)
    v_mfma_f32_32x32x16_bf16 v[128:143], a[112:115], v[112:115], v[128:143]
    ds_read_b128 a[120:123], v4 offset:49152
    v_mfma_f32_32x32x16_bf16 v[144:159], a[240:243], v[112:115], v[144:159]
    ds_read_b128 a[248:251], v4 offset:53248
    s_add_u32 m0, s55, 40960
    s_nop 0
    buffer_load_dwordx4 v15, s[12:15], s88 offen offset:0 lds
    v_mfma_f32_32x32x16_bf16 v[160:175], a[112:115], v[116:119], v[160:175]
    ds_read_b128 v[104:107], v8 offset:57344
    v_mfma_f32_32x32x16_bf16 v[176:191], a[240:243], v[116:119], v[176:191]
    ds_read_b128 v[108:111], v8 offset:58368
    s_waitcnt lgkmcnt(4)
    v_mfma_f32_32x32x16_bf16 v[128:143], a[116:119], v[120:123], v[128:143]
    ds_read_b128 a[124:127], v5 offset:49152
    v_mfma_f32_32x32x16_bf16 v[144:159], a[244:247], v[120:123], v[144:159]
    ds_read_b128 a[252:255], v5 offset:53248
    buffer_load_dwordx4 v16, s[12:15], s88 offen offset:1024 lds
    v_mfma_f32_32x32x16_bf16 v[160:175], a[116:119], v[124:127], v[160:175]
    ds_read_b128 v[112:115], v8 offset:61440
    v_mfma_f32_32x32x16_bf16 v[176:191], a[244:247], v[124:127], v[176:191]
    ds_read_b128 v[116:119], v8 offset:62464
    s_waitcnt lgkmcnt(4)
    v_mfma_f32_32x32x16_bf16 v[128:143], a[120:123], v[104:107], v[128:143]
    v_mfma_f32_32x32x16_bf16 v[144:159], a[248:251], v[104:107], v[144:159]
    s_waitcnt vmcnt(8) lgkmcnt(0)
    s_barrier
    s_cmp_lg_u32 s40, 0
    s_cbranch_scc1 L_fl_B_wt
    s_lshl_b32 s96, s91, 8
    s_lshl_b32 s97, s90, 2
    s_add_u32 s96, s96, s97
    s_add_u32 s96, s96, 12288
    v_mov_b32 v40, s46
    buffer_store_dword v40, v22, s[20:23], s96 offen sc1
L_fl_B_wt:
    ds_read_b64_tr_b16 v[120:121], v6 offset:0
    ds_read_b64_tr_b16 v[122:123], v6 offset:512
    s_add_u32 s101, s47, 3
    s_and_b32 s101, s101, 7
    s_mul_i32 s88, s101, 229376
    s_add_u32 m0, s55, 49152
    s_add_u32 s88, s50, s88
    buffer_load_dwordx4 v13, s[8:11], s88 offen offset:0 lds
    v_mfma_f32_32x32x16_bf16 v[160:175], a[120:123], v[108:111], v[160:175]
    ds_read_b64_tr_b16 v[124:125], v7 offset:0
    v_mfma_f32_32x32x16_bf16 v[176:191], a[248:251], v[108:111], v[176:191]
    ds_read_b64_tr_b16 v[126:127], v7 offset:512
    v_mfma_f32_32x32x16_bf16 v[128:143], a[124:127], v[112:115], v[128:143]
    ds_read_b64_tr_b16 v[104:105], v6 offset:2048
    s_cmp_lg_u32 s40, 1
    s_cbranch_scc1 L_tw_B_5
    v_lshlrev_b32 v45, 7, v1
    s_lshr_b32 s96, s2, 3
    s_mul_i32 s96, s96, 57344
    s_add_u32 s96, s96, 40960
    buffer_load_dword v0, v45, s[16:19], s96 offen
L_tw_B_5:
    v_mfma_f32_32x32x16_bf16 v[144:159], a[252:255], v[112:115], v[144:159]
    ds_read_b64_tr_b16 v[106:107], v6 offset:2560
    buffer_load_dwordx4 v14, s[8:11], s88 offen offset:1024 lds
    v_mfma_f32_32x32x16_bf16 v[160:175], a[124:127], v[116:119], v[160:175]
    ds_read_b64_tr_b16 v[108:109], v7 offset:2048
    v_mfma_f32_32x32x16_bf16 v[176:191], a[252:255], v[116:119], v[176:191]
    ds_read_b64_tr_b16 v[110:111], v7 offset:2560
    s_waitcnt lgkmcnt(4)
    v_mfma_f32_32x32x16_bf16 v[192:207], v[120:123], a[0:3], 0
    ds_read_b64_tr_b16 v[112:113], v6 offset:4096
    v_mfma_f32_32x32x16_bf16 v[208:223], v[120:123], a[128:131], 0
    ds_read_b64_tr_b16 v[114:115], v6 offset:4608
    s_add_u32 m0, s55, 57344
    s_nop 0
    buffer_load_dwordx4 v15, s[12:15], s88 offen offset:0 lds
    v_mfma_f32_32x32x16_bf16 v[224:239], v[124:127], a[0:3], 0
    ds_read_b64_tr_b16 v[116:117], v7 offset:4096
    v_mfma_f32_32x32x16_bf16 v[240:255], v[124:127], a[128:131], 0
    ds_read_b64_tr_b16 v[118:119], v7 offset:4608
    s_waitcnt lgkmcnt(4)
    v_mfma_f32_32x32x16_bf16 v[192:207], v[104:107], a[4:7], v[192:207]
    ds_read_b64_tr_b16 v[120:121], v6 offset:6144
    v_lshrrev_b32 v41, 5, v1
    v_lshlrev_b32 v41, 4, v41
    s_lshl_b32 s98, s41, 8
    s_add_u32 s98, s98, 160768
    v_add_u32 v41, s98, v41
    ds_read_b128 v[48:51], v41 offset:0
    v_mfma_f32_32x32x16_bf16 v[208:223], v[104:107], a[132:135], v[208:223]
    ds_read_b64_tr_b16 v[122:123], v6 offset:6656
    buffer_load_dwordx4 v16, s[12:15], s88 offen offset:1024 lds
    ds_read_b128 v[52:55], v41 offset:32
    ds_read_b128 v[56:59], v41 offset:64
    ds_read_b128 v[60:63], v41 offset:96
    s_waitcnt lgkmcnt(0)
    v_mul_f32 v128, v128, v48
    v_mfma_f32_32x32x16_bf16 v[224:239], v[108:111], a[4:7], v[224:239]
    ds_read_b64_tr_b16 v[124:125], v7 offset:6144
    v_mul_f32 v129, v129, v49
    v_mul_f32 v130, v130, v50
    v_mul_f32 v131, v131, v51
    v_cvt_pk_bf16_f32 v80, v128, v129
    v_cvt_pk_bf16_f32 v81, v130, v131
    ds_write_b64 v33, v[80:81] offset:0
    v_mfma_f32_32x32x16_bf16 v[240:255], v[108:111], a[132:135], v[240:255]
    ds_read_b64_tr_b16 v[126:127], v7 offset:6656
    v_mul_f32 v132, v132, v52
    v_mul_f32 v133, v133, v53
    v_mul_f32 v134, v134, v54
    v_mul_f32 v135, v135, v55
    v_cvt_pk_bf16_f32 v82, v132, v133
    v_cvt_pk_bf16_f32 v83, v134, v135
    v_mfma_f32_32x32x16_bf16 v[192:207], v[112:115], a[8:11], v[192:207]
    ds_write_b64 v33, v[82:83] offset:32
    v_mul_f32 v136, v136, v56
    v_mul_f32 v137, v137, v57
    v_mul_f32 v138, v138, v58
    v_mul_f32 v139, v139, v59
    v_cvt_pk_bf16_f32 v84, v136, v137
    v_cvt_pk_bf16_f32 v85, v138, v139
    v_mfma_f32_32x32x16_bf16 v[208:223], v[112:115], a[136:139], v[208:223]
    s_waitcnt vmcnt(8) lgkmcnt(1)
    s_barrier
    ds_read_b64_tr_b16 v[104:105], v6 offset:16384
    ds_read_b64_tr_b16 v[106:107], v6 offset:16896
    s_add_u32 s101, s47, 4
    s_and_b32 s101, s101, 7
    s_mul_i32 s88, s101, 229376
    s_add_u32 m0, s55, 0
    s_add_u32 s88, s50, s88
    buffer_load_dwordx4 v13, s[8:11], s88 offen offset:0 lds
    v_mfma_f32_32x32x16_bf16 v[224:239], v[116:119], a[8:11], v[224:239]
    ds_read_b64_tr_b16 v[108:109], v7 offset:16384
    v_and_b32 v76, 31, v1
    v_lshlrev_b32 v76, 3, v76
    v_lshrrev_b32 v77, 5, v1
    v_lshl_add_u32 v76, v77, 10, v76
    s_lshl_b32 s93, s44, 3
    s_lshl_b32 s94, s42, 1
    v_mfma_f32_32x32x16_bf16 v[240:255], v[116:119], a[136:139], v[240:255]
    ds_read_b64_tr_b16 v[110:111], v7 offset:16896
    s_add_u32 s93, s93, s94
    s_add_u32 s93, s93, s41
    s_add_u32 s93, s93, 4
    s_lshl_b32 s93, s93, 11
    s_add_u32 s93, s93, 131072
    buffer_load_dwordx2 v[68:69], v76, s[20:23], s93 offen offset:0 sc1
    v_mfma_f32_32x32x16_bf16 v[192:207], v[120:123], a[12:15], v[192:207]
    ds_read_b64_tr_b16 v[112:113], v6 offset:18432
    buffer_load_dwordx2 v[70:71], v76, s[20:23], s93 offen offset:256 sc1
    buffer_load_dwordx2 v[72:73], v76, s[20:23], s93 offen offset:512 sc1
    buffer_load_dwordx2 v[74:75], v76, s[20:23], s93 offen offset:768 sc1
    s_cmp_lg_u32 s40, 2
    s_cbranch_scc1 L_tw_B_6
    v_lshlrev_b32 v45, 7, v1
    s_lshr_b32 s96, s2, 3
    s_mul_i32 s96, s96, 57344
    s_add_u32 s96, s96, 49152
    buffer_load_dword v0, v45, s[16:19], s96 offen
L_tw_B_6:
    v_mfma_f32_32x32x16_bf16 v[208:223], v[120:123], a[140:143], v[208:223]
    ds_read_b64_tr_b16 v[114:115], v6 offset:18944
    buffer_load_dwordx4 v14, s[8:11], s88 offen offset:1024 lds
    ds_write_b64 v33, v[84:85] offset:64
    v_mul_f32 v140, v140, v60
    v_mul_f32 v141, v141, v61
    v_mul_f32 v142, v142, v62
    v_mul_f32 v143, v143, v63
    v_mfma_f32_32x32x16_bf16 v[224:239], v[124:127], a[12:15], v[224:239]
    ds_read_b64_tr_b16 v[116:117], v7 offset:18432
    v_cvt_pk_bf16_f32 v86, v140, v141
    v_cvt_pk_bf16_f32 v87, v142, v143
    ds_write_b64 v33, v[86:87] offset:96
    v_mul_f32 v160, v160, v48
    v_mul_f32 v161, v161, v49
    v_mul_f32 v162, v162, v50
    v_mfma_f32_32x32x16_bf16 v[240:255], v[124:127], a[140:143], v[240:255]
    ds_read_b64_tr_b16 v[118:119], v7 offset:18944
    v_mul_f32 v163, v163, v51
    v_cvt_pk_bf16_f32 v80, v160, v161
    v_cvt_pk_bf16_f32 v81, v162, v163
    ds_write_b64 v33, v[80:81] offset:8448
    v_mul_f32 v164, v164, v52
    v_mul_f32 v165, v165, v53
    s_waitcnt lgkmcnt(7)
    v_mfma_f32_32x32x16_bf16 v[192:207], v[104:107], a[16:19], v[192:207]
    ds_read_b64_tr_b16 v[120:121], v6 offset:20480
    v_mul_f32 v166, v166, v54
    v_mul_f32 v167, v167, v55
    v_cvt_pk_bf16_f32 v82, v164, v165
    v_cvt_pk_bf16_f32 v83, v166, v167
    ds_write_b64 v33, v[82:83] offset:8480
    v_mul_f32 v168, v168, v56
    v_mfma_f32_32x32x16_bf16 v[208:223], v[104:107], a[144:147], v[208:223]
    ds_read_b64_tr_b16 v[122:123], v6 offset:20992
    s_add_u32 m0, s55, 8192
    s_nop 0
    buffer_load_dwordx4 v15, s[12:15], s88 offen offset:0 lds
    v_mul_f32 v169, v169, v57
    v_mul_f32 v170, v170, v58
    v_mul_f32 v171, v171, v59
    v_mfma_f32_32x32x16_bf16 v[224:239], v[108:111], a[16:19], v[224:239]
    ds_read_b64_tr_b16 v[124:125], v7 offset:20480
    v_cvt_pk_bf16_f32 v84, v168, v169
    v_cvt_pk_bf16_f32 v85, v170, v171
    ds_write_b64 v33, v[84:85] offset:8512
    v_mul_f32 v172, v172, v60
    v_mul_f32 v173, v173, v61
    v_mul_f32 v174, v174, v62
    v_mfma_f32_32x32x16_bf16 v[240:255], v[108:111], a[144:147], v[240:255]
    ds_read_b64_tr_b16 v[126:127], v7 offset:20992
    v_mul_f32 v175, v175, v63
    v_cvt_pk_bf16_f32 v86, v172, v173
    v_cvt_pk_bf16_f32 v87, v174, v175
    ds_write_b64 v33, v[86:87] offset:8544
    v_lshrrev_b32 v41, 5, v1
    v_lshlrev_b32 v41, 4, v41
    s_waitcnt lgkmcnt(8)
    v_mfma_f32_32x32x16_bf16 v[192:207], v[112:115], a[20:23], v[192:207]
    ds_read_b64_tr_b16 v[104:105], v6 offset:22528
    s_lshl_b32 s98, s41, 8
    s_add_u32 s98, s98, 160896
    v_add_u32 v41, s98, v41
    ds_read_b128 v[48:51], v41 offset:0
    ds_read_b128 v[52:55], v41 offset:32
    ds_read_b128 v[56:59], v41 offset:64
    v_mfma_f32_32x32x16_bf16 v[208:223], v[112:115], a[148:151], v[208:223]
    ds_read_b64_tr_b16 v[106:107], v6 offset:23040
    buffer_load_dwordx4 v16, s[12:15], s88 offen offset:1024 lds
    ds_read_b128 v[60:63], v41 offset:96
    s_waitcnt lgkmcnt(0)
    v_mul_f32 v144, v144, v48
    v_mul_f32 v145, v145, v49
    v_mul_f32 v146, v146, v50
    v_mfma_f32_32x32x16_bf16 v[224:239], v[116:119], a[20:23], v[224:239]
    ds_read_b64_tr_b16 v[108:109], v7 offset:22528
    v_mul_f32 v147, v147, v51
    v_cvt_pk_bf16_f32 v80, v144, v145
    v_cvt_pk_bf16_f32 v81, v146, v147
    ds_write_b64 v33, v[80:81] offset:128
    v_mul_f32 v148, v148, v52
    v_mul_f32 v149, v149, v53
    v_mfma_f32_32x32x16_bf16 v[240:255], v[116:119], a[148:151], v[240:255]
    ds_read_b64_tr_b16 v[110:111], v7 offset:23040
    v_mul_f32 v150, v150, v54
    v_mul_f32 v151, v151, v55
    v_cvt_pk_bf16_f32 v82, v148, v149
    v_cvt_pk_bf16_f32 v83, v150, v151
    ds_write_b64 v33, v[82:83] offset:160
    v_mul_f32 v152, v152, v56
    v_mfma_f32_32x32x16_bf16 v[192:207], v[120:123], a[24:27], v[192:207]
    v_mul_f32 v153, v153, v57
    v_mul_f32 v154, v154, v58
    v_mul_f32 v155, v155, v59
    v_cvt_pk_bf16_f32 v84, v152, v153
    v_cvt_pk_bf16_f32 v85, v154, v155
    ds_write_b64 v33, v[84:85] offset:192
    v_mul_f32 v156, v156, v60
    v_mfma_f32_32x32x16_bf16 v[208:223], v[120:123], a[152:155], v[208:223]
    s_waitcnt vmcnt(12) lgkmcnt(2)
    s_barrier
    ds_read_b64_tr_b16 v[112:113], v6 offset:32768
    ds_read_b64_tr_b16 v[114:115], v6 offset:33280
    s_add_u32 s101, s47, 5
    s_and_b32 s101, s101, 7
    s_mul_i32 s88, s101, 229376
    s_add_u32 m0, s55, 16384
    s_add_u32 s88, s50, s88
    buffer_load_dwordx4 v13, s[8:11], s88 offen offset:0 lds
    v_mfma_f32_32x32x16_bf16 v[224:239], v[124:127], a[24:27], v[224:239]
    ds_read_b64_tr_b16 v[116:117], v7 offset:32768
    v_mul_f32 v157, v157, v61
    v_mul_f32 v158, v158, v62
    v_mul_f32 v159, v159, v63
    v_cvt_pk_bf16_f32 v86, v156, v157
    v_cvt_pk_bf16_f32 v87, v158, v159
    ds_write_b64 v33, v[86:87] offset:224
    v_mfma_f32_32x32x16_bf16 v[240:255], v[124:127], a[152:155], v[240:255]
    ds_read_b64_tr_b16 v[118:119], v7 offset:33280
    v_mul_f32 v176, v176, v48
    v_mul_f32 v177, v177, v49
    v_mul_f32 v178, v178, v50
    v_mul_f32 v179, v179, v51
    v_cvt_pk_bf16_f32 v80, v176, v177
    v_cvt_pk_bf16_f32 v81, v178, v179
    v_mfma_f32_32x32x16_bf16 v[192:207], v[104:107], a[28:31], v[192:207]
    ds_read_b64_tr_b16 v[120:121], v6 offset:34816
    ds_write_b64 v33, v[80:81] offset:8576
    v_mul_f32 v180, v180, v52
    v_mul_f32 v181, v181, v53
    v_mul_f32 v182, v182, v54
    v_mul_f32 v183, v183, v55
    v_cvt_pk_bf16_f32 v82, v180, v181
    v_mfma_f32_32x32x16_bf16 v[208:223], v[104:107], a[156:159], v[208:223]
    ds_read_b64_tr_b16 v[122:123], v6 offset:35328
    buffer_load_dwordx4 v14, s[8:11], s88 offen offset:1024 lds
    v_cvt_pk_bf16_f32 v83, v182, v183
    ds_write_b64 v33, v[82:83] offset:8608
    v_mul_f32 v184, v184, v56
    v_mul_f32 v185, v185, v57
    v_mul_f32 v186, v186, v58
    v_mfma_f32_32x32x16_bf16 v[224:239], v[108:111], a[28:31], v[224:239]
    ds_read_b64_tr_b16 v[124:125], v7 offset:34816
    v_mul_f32 v187, v187, v59
    v_cvt_pk_bf16_f32 v84, v184, v185
    v_cvt_pk_bf16_f32 v85, v186, v187
    ds_write_b64 v33, v[84:85] offset:8640
    v_mul_f32 v188, v188, v60
    v_mul_f32 v189, v189, v61
    v_mfma_f32_32x32x16_bf16 v[240:255], v[108:111], a[156:159], v[240:255]
    ds_read_b64_tr_b16 v[126:127], v7 offset:35328
    v_mul_f32 v190, v190, v62
    v_mul_f32 v191, v191, v63
    v_cvt_pk_bf16_f32 v86, v188, v189
    v_cvt_pk_bf16_f32 v87, v190, v191
    ds_write_b64 v33, v[86:87] offset:8672
    s_waitcnt lgkmcnt(8)
    v_mfma_f32_32x32x16_bf16 v[192:207], v[112:115], a[32:35], v[192:207]
    ds_read_b64_tr_b16 v[104:105], v6 offset:36864
    v_mfma_f32_32x32x16_bf16 v[208:223], v[112:115], a[160:163], v[208:223]
    ds_read_b64_tr_b16 v[106:107], v6 offset:37376
    s_add_u32 m0, s55, 24576
    s_nop 0
    buffer_load_dwordx4 v15, s[12:15], s88 offen offset:0 lds
    v_mfma_f32_32x32x16_bf16 v[224:239], v[116:119], a[32:35], v[224:239]
    ds_read_b64_tr_b16 v[108:109], v7 offset:36864
    v_mfma_f32_32x32x16_bf16 v[240:255], v[116:119], a[160:163], v[240:255]
    ds_read_b64_tr_b16 v[110:111], v7 offset:37376
    s_waitcnt lgkmcnt(5)
    v_mfma_f32_32x32x16_bf16 v[192:207], v[120:123], a[36:39], v[192:207]
    ds_read_b64_tr_b16 v[112:113], v6 offset:38912
    v_mfma_f32_32x32x16_bf16 v[208:223], v[120:123], a[164:167], v[208:223]
    ds_read_b64_tr_b16 v[114:115], v6 offset:39424
    buffer_load_dwordx4 v16, s[12:15], s88 offen offset:1024 lds
    v_mfma_f32_32x32x16_bf16 v[224:239], v[124:127], a[36:39], v[224:239]
    ds_read_b64_tr_b16 v[116:117], v7 offset:38912
    v_mfma_f32_32x32x16_bf16 v[240:255], v[124:127], a[164:167], v[240:255]
    ds_read_b64_tr_b16 v[118:119], v7 offset:39424
    s_waitcnt lgkmcnt(4)
    v_mfma_f32_32x32x16_bf16 v[192:207], v[104:107], a[40:43], v[192:207]
    v_mfma_f32_32x32x16_bf16 v[208:223], v[104:107], a[168:171], v[208:223]
    s_waitcnt vmcnt(12) lgkmcnt(0)
    s_barrier
    ds_read_b64_tr_b16 v[120:121], v6 offset:49152
    ds_read_b64_tr_b16 v[122:123], v6 offset:49664
    s_add_u32 s101, s47, 6
    s_and_b32 s101, s101, 7
    s_mul_i32 s88, s101, 229376
    s_add_u32 m0, s55, 32768
    s_add_u32 s88, s50, s88
    buffer_load_dwordx4 v13, s[8:11], s88 offen offset:0 lds
    v_mfma_f32_32x32x16_bf16 v[224:239], v[108:111], a[40:43], v[224:239]
    ds_read_b64_tr_b16 v[124:125], v7 offset:49152
    ds_read_b128 v[80:83], v34 offset:0
    ds_read_b128 v[84:87], v34 offset:1056
    ds_read_b128 v[88:91], v34 offset:2112
    ds_read_b128 v[92:95], v34 offset:3168
    s_waitcnt lgkmcnt(0)
    v_mfma_f32_32x32x16_bf16 v[240:255], v[108:111], a[168:171], v[240:255]
    ds_read_b64_tr_b16 v[126:127], v7 offset:49664
    s_add_u32 s98, s53, 0
    buffer_store_dwordx4 v[80:83], v35, s[20:23], s98 offen sc1
    s_add_u32 s98, s53, 17408
    buffer_store_dwordx4 v[84:87], v35, s[20:23], s98 offen sc1
    s_add_u32 s98, s53, 34816
    v_mfma_f32_32x32x16_bf16 v[192:207], v[112:115], a[44:47], v[192:207]
    ds_read_b64_tr_b16 v[104:105], v6 offset:51200
    buffer_store_dwordx4 v[88:91], v35, s[20:23], s98 offen sc1
    s_add_u32 s98, s53, 52224
    buffer_store_dwordx4 v[92:95], v35, s[20:23], s98 offen sc1
    s_nop 0
    s_nop 0
    v_mfma_f32_32x32x16_bf16 v[208:223], v[112:115], a[172:175], v[208:223]
    ds_read_b64_tr_b16 v[106:107], v6 offset:51712
    buffer_load_dwordx4 v14, s[8:11], s88 offen offset:1024 lds
    ds_read_b128 v[80:83], v34 offset:4224
    ds_read_b128 v[84:87], v34 offset:5280
    ds_read_b128 v[88:91], v34 offset:6336
    ds_read_b128 v[92:95], v34 offset:7392
    v_mfma_f32_32x32x16_bf16 v[224:239], v[116:119], a[44:47], v[224:239]
    ds_read_b64_tr_b16 v[108:109], v7 offset:51200
    s_waitcnt lgkmcnt(1)
    s_add_u32 s98, s53, 69632
    buffer_store_dwordx4 v[80:83], v35, s[20:23], s98 offen sc1
    s_add_u32 s98, s53, 87040
    buffer_store_dwordx4 v[84:87], v35, s[20:23], s98 offen sc1
    v_mfma_f32_32x32x16_bf16 v[240:255], v[116:119], a[172:175], v[240:255]
    ds_read_b64_tr_b16 v[110:111], v7 offset:51712
    s_add_u32 s98, s53, 104448
    buffer_store_dwordx4 v[88:91], v35, s[20:23], s98 offen sc1
    s_add_u32 s98, s53, 121856
    buffer_store_dwordx4 v[92:95], v35, s[20:23], s98 offen sc1
    s_nop 0
    v_mfma_f32_32x32x16_bf16 v[192:207], v[120:123], a[48:51], v[192:207]
    ds_read_b64_tr_b16 v[112:113], v6 offset:53248
    s_nop 0
    v_mfma_f32_32x32x16_bf16 v[208:223], v[120:123], a[176:179], v[208:223]
    ds_read_b64_tr_b16 v[114:115], v6 offset:53760
    s_add_u32 m0, s55, 40960
    s_nop 0
    buffer_load_dwordx4 v15, s[12:15], s88 offen offset:0 lds
    v_mfma_f32_32x32x16_bf16 v[224:239], v[124:127], a[48:51], v[224:239]
    ds_read_b64_tr_b16 v[116:117], v7 offset:53248
    v_mfma_f32_32x32x16_bf16 v[240:255], v[124:127], a[176:179], v[240:255]
    ds_read_b64_tr_b16 v[118:119], v7 offset:53760
    s_waitcnt lgkmcnt(4)
    v_mfma_f32_32x32x16_bf16 v[192:207], v[104:107], a[52:55], v[192:207]
    ds_read_b64_tr_b16 v[120:121], v6 offset:55296
    v_mfma_f32_32x32x16_bf16 v[208:223], v[104:107], a[180:183], v[208:223]
    ds_read_b64_tr_b16 v[122:123], v6 offset:55808
    buffer_load_dwordx4 v16, s[12:15], s88 offen offset:1024 lds
    v_mfma_f32_32x32x16_bf16 v[224:239], v[108:111], a[52:55], v[224:239]
    ds_read_b64_tr_b16 v[124:125], v7 offset:55296
    v_mfma_f32_32x32x16_bf16 v[240:255], v[108:111], a[180:183], v[240:255]
    ds_read_b64_tr_b16 v[126:127], v7 offset:55808
    s_waitcnt lgkmcnt(4)
    v_mfma_f32_32x32x16_bf16 v[192:207], v[112:115], a[56:59], v[192:207]
    v_mfma_f32_32x32x16_bf16 v[208:223], v[112:115], a[184:187], v[208:223]
    s_waitcnt vmcnt(16) lgkmcnt(0)
    s_barrier
    ds_read_b64_tr_b16 v[104:105], v6 offset:0
    ds_read_b64_tr_b16 v[106:107], v6 offset:512
    s_add_u32 s101, s47, 7
    s_and_b32 s101, s101, 7
    s_mul_i32 s88, s101, 229376
    s_add_u32 m0, s55, 49152
    s_add_u32 s88, s50, s88
    buffer_load_dwordx4 v13, s[8:11], s88 offen offset:0 lds
    v_mfma_f32_32x32x16_bf16 v[224:239], v[116:119], a[56:59], v[224:239]
    ds_read_b64_tr_b16 v[108:109], v7 offset:0
    v_cmp_ne_u32 vcc, s46, v69
    v_cmp_ne_u32 s[62:63], s46, v71
    s_nop 3
    s_or_b64 vcc, vcc, s[62:63]
    v_cmp_ne_u32 s[62:63], s46, v73
    s_nop 3
    s_or_b64 vcc, vcc, s[62:63]
    v_cmp_ne_u32 s[62:63], s46, v75
    s_nop 3
    s_or_b64 vcc, vcc, s[62:63]
    s_cmp_lg_u64 vcc, 0
    s_cbranch_scc1 L_slow_csB1
L_back_csB1:
    v_mfma_f32_32x32x16_bf16 v[240:255], v[116:119], a[184:187], v[240:255]
    ds_read_b64_tr_b16 v[110:111], v7 offset:512
    v_add_f32 v68, v68, v70
    v_add_f32 v72, v72, v74
    v_add_f32 v68, v68, v72
    v_mov_b32 v69, v68
    s_nop 1
    v_mfma_f32_32x32x16_bf16 v[192:207], v[120:123], a[60:63], v[192:207]
    ds_read_b64_tr_b16 v[112:113], v6 offset:2048
    v_permlane32_swap_b32 v68, v69
    s_nop 0
    v_add_f32 v68, v68, v69
    v_cvt_pk_bf16_f32 v69, v68, v68
    v_and_b32 v69, 0xffff0000, v69
    v_mfma_f32_32x32x16_bf16 v[208:223], v[120:123], a[188:191], v[208:223]
    ds_read_b64_tr_b16 v[114:115], v6 offset:2560
    buffer_load_dwordx4 v14, s[8:11], s88 offen offset:1024 lds
    v_sub_f32 v70, v68, v69
    v_cvt_pk_bf16_f32 v72, v69, v70
    v_cmp_gt_u32 vcc, 32, v1
    v_mov_b32 v73, 0
    v_mfma_f32_32x32x16_bf16 v[224:239], v[124:127], a[60:63], v[224:239]
    ds_read_b64_tr_b16 v[116:117], v7 offset:2048
    v_mov_b32 v74, 0
    v_cndmask_b32 v72, 0, v72, vcc
    v_mov_b32 v75, 0
    s_lshl_b32 s94, s42, 1
    s_add_u32 s94, s94, s41
    v_mfma_f32_32x32x16_bf16 v[240:255], v[124:127], a[188:191], v[240:255]
    ds_read_b64_tr_b16 v[118:119], v7 offset:2560
    s_lshl_b32 s94, s94, 10
    s_add_u32 s94, s94, 156672
    v_lshl_add_u32 v76, v1, 4, s94
    ds_write_b128 v76, v[72:75]
    s_waitcnt lgkmcnt(5)
    v_mfma_f32_32x32x16_bf16 v[192:207], v[104:107], a[64:67], v[192:207]
    ds_read_b64_tr_b16 v[120:121], v6 offset:4096
    v_mfma_f32_32x32x16_bf16 v[208:223], v[104:107], a[192:195], v[208:223]
    ds_read_b64_tr_b16 v[122:123], v6 offset:4608
    s_add_u32 m0, s55, 57344
    s_nop 0
    buffer_load_dwordx4 v15, s[12:15], s88 offen offset:0 lds
    v_mfma_f32_32x32x16_bf16 v[224:239], v[108:111], a[64:67], v[224:239]
    ds_read_b64_tr_b16 v[124:125], v7 offset:4096
    v_mfma_f32_32x32x16_bf16 v[240:255], v[108:111], a[192:195], v[240:255]
    ds_read_b64_tr_b16 v[126:127], v7 offset:4608
    s_waitcnt lgkmcnt(5)
    v_mfma_f32_32x32x16_bf16 v[192:207], v[112:115], a[68:71], v[192:207]
    ds_read_b64_tr_b16 v[104:105], v6 offset:6144
    v_mfma_f32_32x32x16_bf16 v[208:223], v[112:115], a[196:199], v[208:223]
    ds_read_b64_tr_b16 v[106:107], v6 offset:6656
    buffer_load_dwordx4 v16, s[12:15], s88 offen offset:1024 lds
    v_mfma_f32_32x32x16_bf16 v[224:239], v[116:119], a[68:71], v[224:239]
    ds_read_b64_tr_b16 v[108:109], v7 offset:6144
    v_mfma_f32_32x32x16_bf16 v[240:255], v[116:119], a[196:199], v[240:255]
    ds_read_b64_tr_b16 v[110:111], v7 offset:6656
    s_waitcnt lgkmcnt(4)
    v_mfma_f32_32x32x16_bf16 v[192:207], v[120:123], a[72:75], v[192:207]
    v_mfma_f32_32x32x16_bf16 v[208:223], v[120:123], a[200:203], v[208:223]
    s_waitcnt vmcnt(6) lgkmcnt(0)
    s_barrier
    s_cmp_lg_u32 s40, 0
    s_cbranch_scc1 L_fl_B_u
    s_lshl_b32 s96, s45, 7
    s_lshl_b32 s97, s43, 2
    s_add_u32 s96, s96, s97
    s_add_u32 s96, s96, 8192
    v_mov_b32 v40, s46
    buffer_store_dword v40, v22, s[20:23], s96 offen sc1
L_fl_B_u:
    ds_read_b64_tr_b16 v[112:113], v6 offset:16384
    ds_read_b64_tr_b16 v[114:115], v6 offset:16896
    s_lshl_b32 s77, s40, 13
    s_add_u32 s77, s77, 524288
    buffer_load_dwordx4 a[0:3], v43, s[28:31], s77 offen offset:0
    v_mfma_f32_32x32x16_bf16 v[224:239], v[124:127], a[72:75], v[224:239]
    ds_read_b64_tr_b16 v[116:117], v7 offset:16384
    s_lshl_b32 s94, s42, 11
    s_add_u32 s94, s94, 156672
    v_lshl_add_u32 v76, v1, 4, s94
    ds_read_b128 v[48:51], v76
    ds_read_b128 v[52:55], v76 offset:1024
    v_mfma_f32_32x32x16_bf16 v[240:255], v[124:127], a[200:203], v[240:255]
    ds_read_b64_tr_b16 v[118:119], v7 offset:16896
    buffer_load_dwordx4 a[4:7], v43, s[28:31], s77 offen offset:1024
    v_mfma_f32_32x32x16_bf16 v[192:207], v[104:107], a[76:79], v[192:207]
    ds_read_b64_tr_b16 v[120:121], v6 offset:18432
    v_mfma_f32_32x32x16_bf16 v[208:223], v[104:107], a[204:207], v[208:223]
    ds_read_b64_tr_b16 v[122:123], v6 offset:18944
    buffer_load_dwordx4 a[8:11], v43, s[28:31], s77 offen offset:2048
    v_mfma_f32_32x32x16_bf16 v[224:239], v[108:111], a[76:79], v[224:239]
    ds_read_b64_tr_b16 v[124:125], v7 offset:18432
    v_mfma_f32_32x32x16_bf16 v[240:255], v[108:111], a[204:207], v[240:255]
    ds_read_b64_tr_b16 v[126:127], v7 offset:18944
    buffer_load_dwordx4 a[12:15], v43, s[28:31], s77 offen offset:3072
    s_waitcnt lgkmcnt(4)
    v_mfma_f32_32x32x16_bf16 v[192:207], v[112:115], a[80:83], v[192:207]
    ds_read_b64_tr_b16 v[104:105], v6 offset:20480
    v_mfma_f32_32x32x16_bf16 v[192:207], v[48:51], v[24:27], v[192:207]
    v_mfma_f32_32x32x16_bf16 v[208:223], v[48:51], v[28:31], v[208:223]
    v_mfma_f32_32x32x16_bf16 v[224:239], v[52:55], v[24:27], v[224:239]
    v_mfma_f32_32x32x16_bf16 v[240:255], v[52:55], v[28:31], v[240:255]
    v_mfma_f32_32x32x16_bf16 v[208:223], v[112:115], a[208:211], v[208:223]
    ds_read_b64_tr_b16 v[106:107], v6 offset:20992
    s_add_u32 s77, s77, 4096
    buffer_load_dwordx4 a[16:19], v43, s[28:31], s77 offen offset:0
    v_mfma_f32_32x32x16_bf16 v[224:239], v[116:119], a[80:83], v[224:239]
    ds_read_b64_tr_b16 v[108:109], v7 offset:20480
    v_mfma_f32_32x32x16_bf16 v[240:255], v[116:119], a[208:211], v[240:255]
    ds_read_b64_tr_b16 v[110:111], v7 offset:20992
    buffer_load_dwordx4 a[20:23], v43, s[28:31], s77 offen offset:1024
    s_waitcnt lgkmcnt(4)
    v_mfma_f32_32x32x16_bf16 v[192:207], v[120:123], a[84:87], v[192:207]
    ds_read_b64_tr_b16 v[112:113], v6 offset:22528
    v_mfma_f32_32x32x16_bf16 v[208:223], v[120:123], a[212:215], v[208:223]
    ds_read_b64_tr_b16 v[114:115], v6 offset:23040
    buffer_load_dwordx4 a[24:27], v43, s[28:31], s77 offen offset:2048
    v_mfma_f32_32x32x16_bf16 v[224:239], v[124:127], a[84:87], v[224:239]
    ds_read_b64_tr_b16 v[116:117], v7 offset:22528
    v_mfma_f32_32x32x16_bf16 v[240:255], v[124:127], a[212:215], v[240:255]
    ds_read_b64_tr_b16 v[118:119], v7 offset:23040
    buffer_load_dwordx4 a[28:31], v43, s[28:31], s77 offen offset:3072
    s_waitcnt lgkmcnt(4)
    v_mfma_f32_32x32x16_bf16 v[192:207], v[104:107], a[88:91], v[192:207]
    v_mfma_f32_32x32x16_bf16 v[208:223], v[104:107], a[216:219], v[208:223]
    s_waitcnt vmcnt(12) lgkmcnt(0)
    s_barrier
    ds_read_b64_tr_b16 v[120:121], v6 offset:32768
    ds_read_b64_tr_b16 v[122:123], v6 offset:33280
    s_mov_b32 s77, 557056
    buffer_load_dwordx4 a[32:35], v43, s[28:31], s77 offen offset:0
    v_mfma_f32_32x32x16_bf16 v[224:239], v[108:111], a[88:91], v[224:239]
    ds_read_b64_tr_b16 v[124:125], v7 offset:32768
    v_mfma_f32_32x32x16_bf16 v[240:255], v[108:111], a[216:219], v[240:255]
    ds_read_b64_tr_b16 v[126:127], v7 offset:33280
    buffer_load_dwordx4 a[36:39], v43, s[28:31], s77 offen offset:1024
    v_mfma_f32_32x32x16_bf16 v[192:207], v[112:115], a[92:95], v[192:207]
    ds_read_b64_tr_b16 v[104:105], v6 offset:34816
    v_mfma_f32_32x32x16_bf16 v[208:223], v[112:115], a[220:223], v[208:223]
    ds_read_b64_tr_b16 v[106:107], v6 offset:35328
    buffer_load_dwordx4 a[40:43], v43, s[28:31], s77 offen offset:2048
    v_mfma_f32_32x32x16_bf16 v[224:239], v[116:119], a[92:95], v[224:239]
    ds_read_b64_tr_b16 v[108:109], v7 offset:34816
    v_mfma_f32_32x32x16_bf16 v[240:255], v[116:119], a[220:223], v[240:255]
    ds_read_b64_tr_b16 v[110:111], v7 offset:35328
    buffer_load_dwordx4 a[44:47], v43, s[28:31], s77 offen offset:3072
    s_waitcnt lgkmcnt(4)
    v_mfma_f32_32x32x16_bf16 v[192:207], v[120:123], a[96:99], v[192:207]
    ds_read_b64_tr_b16 v[112:113], v6 offset:36864
    v_mfma_f32_32x32x16_bf16 v[208:223], v[120:123], a[224:227], v[208:223]
    ds_read_b64_tr_b16 v[114:115], v6 offset:37376
    s_mov_b32 s77, 561152
    buffer_load_dwordx4 a[48:51], v43, s[28:31], s77 offen offset:0
    v_mfma_f32_32x32x16_bf16 v[224:239], v[124:127], a[96:99], v[224:239]
    ds_read_b64_tr_b16 v[116:117], v7 offset:36864
    v_mfma_f32_32x32x16_bf16 v[240:255], v[124:127], a[224:227], v[240:255]
    ds_read_b64_tr_b16 v[118:119], v7 offset:37376
    buffer_load_dwordx4 a[52:55], v43, s[28:31], s77 offen offset:1024
    s_waitcnt lgkmcnt(4)
    v_mfma_f32_32x32x16_bf16 v[192:207], v[104:107], a[100:103], v[192:207]
    ds_read_b64_tr_b16 v[120:121], v6 offset:38912
    v_mfma_f32_32x32x16_bf16 v[208:223], v[104:107], a[228:231], v[208:223]
    ds_read_b64_tr_b16 v[122:123], v6 offset:39424
    s_add_u32 m0, s75, 131072
    s_add_u32 s81, s32, 0
    buffer_load_dwordx4 v44, s[16:19], s81 offen lds
    v_mfma_f32_32x32x16_bf16 v[224:239], v[108:111], a[100:103], v[224:239]
    ds_read_b64_tr_b16 v[124:125], v7 offset:38912
    v_mfma_f32_32x32x16_bf16 v[240:255], v[108:111], a[228:231], v[240:255]
    ds_read_b64_tr_b16 v[126:127], v7 offset:39424
    buffer_load_dwordx4 v46, s[16:19], s81 offen offset:1024 lds
    s_waitcnt lgkmcnt(4)
    v_mfma_f32_32x32x16_bf16 v[192:207], v[112:115], a[104:107], v[192:207]
    v_mfma_f32_32x32x16_bf16 v[208:223], v[112:115], a[232:235], v[208:223]
    s_waitcnt vmcnt(16) lgkmcnt(0)
    s_barrier
    ds_read_b64_tr_b16 v[104:105], v6 offset:49152
    ds_read_b64_tr_b16 v[106:107], v6 offset:49664
    s_add_u32 m0, s75, 139264
    s_add_u32 s81, s32, 16384
    buffer_load_dwordx4 v44, s[16:19], s81 offen lds
    v_mfma_f32_32x32x16_bf16 v[224:239], v[116:119], a[104:107], v[224:239]
    ds_read_b64_tr_b16 v[108:109], v7 offset:49152
    v_mfma_f32_32x32x16_bf16 v[240:255], v[116:119], a[232:235], v[240:255]
    ds_read_b64_tr_b16 v[110:111], v7 offset:49664
    buffer_load_dwordx4 v46, s[16:19], s81 offen offset:1024 lds
    v_mfma_f32_32x32x16_bf16 v[192:207], v[120:123], a[108:111], v[192:207]
    ds_read_b64_tr_b16 v[112:113], v6 offset:51200
    v_mfma_f32_32x32x16_bf16 v[208:223], v[120:123], a[236:239], v[208:223]
    ds_read_b64_tr_b16 v[114:115], v6 offset:51712
    s_add_u32 m0, s75, 40960
    s_add_u32 s81, s32, 32768
    buffer_load_dwordx4 v44, s[16:19], s81 offen lds
    v_mfma_f32_32x32x16_bf16 v[224:239], v[124:127], a[108:111], v[224:239]
    ds_read_b64_tr_b16 v[116:117], v7 offset:51200
    v_mfma_f32_32x32x16_bf16 v[240:255], v[124:127], a[236:239], v[240:255]
    ds_read_b64_tr_b16 v[118:119], v7 offset:51712
    buffer_load_dwordx4 v46, s[16:19], s81 offen offset:1024 lds
    s_waitcnt lgkmcnt(4)
    v_mfma_f32_32x32x16_bf16 v[192:207], v[104:107], a[112:115], v[192:207]
    ds_read_b64_tr_b16 v[120:121], v6 offset:53248
    v_mfma_f32_32x32x16_bf16 v[208:223], v[104:107], a[240:243], v[208:223]
    ds_read_b64_tr_b16 v[122:123], v6 offset:53760
    s_add_u32 m0, s75, 49152
    s_add_u32 s81, s32, 49152
    buffer_load_dwordx4 v44, s[16:19], s81 offen lds
    v_mfma_f32_32x32x16_bf16 v[224:239], v[108:111], a[112:115], v[224:239]
    ds_read_b64_tr_b16 v[124:125], v7 offset:53248
    v_mfma_f32_32x32x16_bf16 v[240:255], v[108:111], a[240:243], v[240:255]
    ds_read_b64_tr_b16 v[126:127], v7 offset:53760
    buffer_load_dwordx4 v46, s[16:19], s81 offen offset:1024 lds
    s_waitcnt lgkmcnt(4)
    v_mfma_f32_32x32x16_bf16 v[192:207], v[112:115], a[116:119], v[192:207]
    ds_read_b64_tr_b16 v[104:105], v6 offset:55296
    v_mfma_f32_32x32x16_bf16 v[208:223], v[112:115], a[244:247], v[208:223]
    ds_read_b64_tr_b16 v[106:107], v6 offset:55808
    s_add_u32 m0, s75, 57344
    s_add_u32 s81, s33, 0
    buffer_load_dwordx4 v44, s[16:19], s81 offen lds
    v_mfma_f32_32x32x16_bf16 v[224:239], v[116:119], a[116:119], v[224:239]
    ds_read_b64_tr_b16 v[108:109], v7 offset:55296
    v_mfma_f32_32x32x16_bf16 v[240:255], v[116:119], a[244:247], v[240:255]
    ds_read_b64_tr_b16 v[110:111], v7 offset:55808
    buffer_load_dwordx4 v46, s[16:19], s81 offen offset:1024 lds
    s_waitcnt lgkmcnt(4)
    v_mfma_f32_32x32x16_bf16 v[192:207], v[120:123], a[120:123], v[192:207]
    v_mfma_f32_32x32x16_bf16 v[208:223], v[120:123], a[248:251], v[208:223]
    s_waitcnt lgkmcnt(0)
    s_barrier
    s_lshl_b32 s77, s40, 12
    s_add_u32 s77, s77, 565248
    buffer_load_dwordx4 v[48:51], v43, s[28:31], s77 offen offset:0
    v_mfma_f32_32x32x16_bf16 v[224:239], v[124:127], a[120:123], v[224:239]
    v_mfma_f32_32x32x16_bf16 v[240:255], v[124:127], a[248:251], v[240:255]
    buffer_load_dwordx4 v[52:55], v43, s[28:31], s77 offen offset:1024
    v_mfma_f32_32x32x16_bf16 v[192:207], v[104:107], a[124:127], v[192:207]
    v_mfma_f32_32x32x16_bf16 v[208:223], v[104:107], a[252:255], v[208:223]
    buffer_load_dwordx4 v[56:59], v43, s[28:31], s77 offen offset:2048
    v_mfma_f32_32x32x16_bf16 v[224:239], v[108:111], a[124:127], v[224:239]
    v_mfma_f32_32x32x16_bf16 v[240:255], v[108:111], a[252:255], v[240:255]
    buffer_load_dwordx4 v[60:63], v43, s[28:31], s77 offen offset:3072
    s_waitcnt lgkmcnt(0)
L_common:
    v_mov_b32 v96, v18
    v_mov_b32 v100, v20
    v_mov_b32 v97, v18
    v_mov_b32 v101, v20
    v_mov_b32 v98, v19
    v_mov_b32 v102, v21
    v_mov_b32 v99, v19
    v_mov_b32 v103, v21
    s_lshr_b32 s93, s2, 6
    s_lshl_b32 s94, s93, 7
    s_add_u32 s94, s94, 8192
    s_lshl_b32 s93, s93, 8
    s_add_u32 s93, s93, 12288
    v_lshlrev_b32 v30, 2, v1
    v_and_b32 v31, 60, v30
    buffer_load_dword v28, v31, s[20:23], s94 offen sc1
    buffer_load_dword v29, v30, s[20:23], s93 offen sc1
    s_lshl_b32 s56, s84, 2
    s_lshl_b32 s57, s85, 1
    s_add_u32 s56, s56, s57
    s_mul_i32 s56, s56, 112
    s_mul_i32 s57, s40, 28
    s_add_u32 s56, s56, s57
    s_lshl_b32 s72, s56, 10
    s_add_u32 s72, s72, 8388608
    s_mul_i32 s77, s86, 11
    s_lshr_b32 s77, s77, 5
    s_mul_i32 s77, s77, 3
    s_sub_u32 s77, s86, s77
    s_add_u32 s79, s77, 0
    s_sub_u32 s76, s79, 3
    s_min_u32 s79, s79, s76
    s_lshl_b32 s79, s79, 12
    s_add_u32 s8, s72, s79
    s_add_u32 s79, s77, 1
    s_sub_u32 s76, s79, 3
    s_min_u32 s79, s79, s76
    s_lshl_b32 s79, s79, 12
    s_add_u32 s9, s72, s79
    s_add_u32 s79, s77, 2
    s_sub_u32 s76, s79, 3
    s_min_u32 s79, s79, s76
    s_lshl_b32 s79, s79, 12
    s_add_u32 s10, s72, s79
    s_add_u32 s79, s86, 0
    s_and_b32 s79, s79, 3
    s_lshl_b32 s79, s79, 12
    s_add_u32 s79, s79, 12288
    s_add_u32 s11, s72, s79
    s_add_u32 s79, s86, 1
    s_and_b32 s79, s79, 3
    s_lshl_b32 s79, s79, 12
    s_add_u32 s79, s79, 12288
    s_add_u32 s12, s72, s79
    s_add_u32 s79, s86, 2
    s_and_b32 s79, s79, 3
    s_lshl_b32 s79, s79, 12
    s_add_u32 s79, s79, 12288
    s_add_u32 s13, s72, s79
    s_add_u32 s79, s86, 3
    s_and_b32 s79, s79, 3
    s_lshl_b32 s79, s79, 12
    s_add_u32 s79, s79, 12288
    s_add_u32 s14, s72, s79
    v_pk_mul_f32 v[80:81], v[192:193], v[96:97]
    v_pk_mul_f32 v[82:83], v[194:195], v[96:97]
    v_exp_f32 v80, v80
    v_pk_mul_f32 v[192:193], v[192:193], v[200:201]
    v_exp_f32 v81, v81
    v_pk_mul_f32 v[194:195], v[194:195], v[202:203]
    v_exp_f32 v82, v82
    v_exp_f32 v83, v83
    v_pk_fma_f32 v[80:81], v[80:81], v[100:101], v[100:101]
    v_pk_fma_f32 v[82:83], v[82:83], v[100:101], v[100:101]
    v_rcp_f32 v80, v80
    s_add_u32 m0, s75, 0
    s_add_u32 s81, s33, 16384
    buffer_load_dwordx4 v44, s[16:19], s81 offen lds
    v_rcp_f32 v81, v81
    v_rcp_f32 v82, v82
    v_rcp_f32 v83, v83
    s_nop 0
    v_pk_mul_f32 v[192:193], v[192:193], v[80:81]
    v_pk_mul_f32 v[194:195], v[194:195], v[82:83]
    v_cvt_pk_bf16_f32 v84, v192, v193
    v_cvt_pk_bf16_f32 v85, v194, v195
    v_pk_mul_f32 v[80:81], v[196:197], v[96:97]
    v_pk_mul_f32 v[82:83], v[198:199], v[96:97]
    v_exp_f32 v80, v80
    v_pk_mul_f32 v[196:197], v[196:197], v[204:205]
    buffer_load_dwordx4 v46, s[16:19], s81 offen offset:1024 lds
    v_exp_f32 v81, v81
    v_pk_mul_f32 v[198:199], v[198:199], v[206:207]
    v_exp_f32 v82, v82
    v_exp_f32 v83, v83
    v_pk_fma_f32 v[80:81], v[80:81], v[100:101], v[100:101]
    v_pk_fma_f32 v[82:83], v[82:83], v[100:101], v[100:101]
    v_rcp_f32 v80, v80
    v_rcp_f32 v81, v81
    v_rcp_f32 v82, v82
    v_rcp_f32 v83, v83
    s_add_u32 m0, s75, 8192
    s_add_u32 s81, s33, 32768
    buffer_load_dwordx4 v44, s[16:19], s81 offen lds
    s_add_u32 s98, s52, 12288
    v_pk_mul_f32 v[196:197], v[196:197], v[80:81]
    v_pk_mul_f32 v[198:199], v[198:199], v[82:83]
    v_cvt_pk_bf16_f32 v86, v196, v197
    v_cvt_pk_bf16_f32 v87, v198, v199
    buffer_store_dwordx4 v[84:87], v32, s[20:23], s98 offen sc1
    v_pk_mul_f32 v[80:81], v[208:209], v[98:99]
    v_pk_mul_f32 v[82:83], v[210:211], v[98:99]
    v_exp_f32 v80, v80
    v_pk_mul_f32 v[208:209], v[208:209], v[216:217]
    v_exp_f32 v81, v81
    v_pk_mul_f32 v[210:211], v[210:211], v[218:219]
    v_exp_f32 v82, v82
    v_exp_f32 v83, v83
    v_pk_fma_f32 v[80:81], v[80:81], v[102:103], v[102:103]
    v_pk_fma_f32 v[82:83], v[82:83], v[102:103], v[102:103]
    v_rcp_f32 v80, v80
    buffer_load_dwordx4 v46, s[16:19], s81 offen offset:1024 lds
    v_rcp_f32 v81, v81
    v_rcp_f32 v82, v82
    v_rcp_f32 v83, v83
    s_nop 0
    v_pk_mul_f32 v[208:209], v[208:209], v[80:81]
    v_pk_mul_f32 v[210:211], v[210:211], v[82:83]
    v_cvt_pk_bf16_f32 v84, v208, v209
    v_cvt_pk_bf16_f32 v85, v210, v211
    v_pk_mul_f32 v[80:81], v[212:213], v[98:99]
    v_pk_mul_f32 v[82:83], v[214:215], v[98:99]
    v_exp_f32 v80, v80
    v_pk_mul_f32 v[212:213], v[212:213], v[220:221]
    s_add_u32 m0, s75, 16384
    s_add_u32 s81, s33, 49152
    buffer_load_dwordx4 v44, s[16:19], s81 offen lds
    v_exp_f32 v81, v81
    v_pk_mul_f32 v[214:215], v[214:215], v[222:223]
    v_exp_f32 v82, v82
    v_exp_f32 v83, v83
    v_pk_fma_f32 v[80:81], v[80:81], v[102:103], v[102:103]
    v_pk_fma_f32 v[82:83], v[82:83], v[102:103], v[102:103]
    v_rcp_f32 v80, v80
    v_rcp_f32 v81, v81
    v_rcp_f32 v82, v82
    v_rcp_f32 v83, v83
    buffer_load_dwordx4 v46, s[16:19], s81 offen offset:1024 lds
    s_add_u32 s98, s52, 126976
    v_pk_mul_f32 v[212:213], v[212:213], v[80:81]
    v_pk_mul_f32 v[214:215], v[214:215], v[82:83]
    v_cvt_pk_bf16_f32 v86, v212, v213
    v_cvt_pk_bf16_f32 v87, v214, v215
    buffer_store_dwordx4 v[84:87], v32, s[20:23], s98 offen sc1
    v_lshrrev_b32 v10, 4, v1
    v_mul_u32_u24 v6, 8704, v10
    v_and_b32 v10, 1, v10
    v_lshlrev_b32 v10, 3, v10
    v_and_b32 v11, 15, v1
    v_xor_b32 v10, v10, v11
    v_lshl_add_u32 v6, v10, 4, v6
    v_add_u32 v40, 33792, v6
    s_mul_i32 s74, s40, 557056
    s_lshl_b32 s56, s84, 9
    s_add_u32 s74, s74, s56
    s_lshl_b32 s56, s85, 8
    s_add_u32 s74, s74, s56
    s_add_u32 s74, s74, 5767168
    v_lshrrev_b32 v10, 5, v1
    v_lshlrev_b32 v4, 10, v10
    s_add_u32 m0, s75, 24576
    s_add_u32 s81, s34, 0
    buffer_load_dwordx4 v44, s[16:19], s81 offen lds
    v_bfe_u32 v10, v1, 3, 1
    v_lshl_add_u32 v4, v10, 8, v4
    v_lshl_add_u32 v4, v10, 7, v4
    v_bfe_u32 v10, v1, 4, 1
    v_lshl_add_u32 v4, v10, 6, v4
    v_and_b32 v10, 3, v1
    v_lshl_add_u32 v4, v10, 4, v4
    v_bfe_u32 v10, v1, 2, 1
    v_lshl_add_u32 v4, v10, 3, v4
    v_add_u32 v4, s75, v4
    v_xor_b32 v5, 128, v4
    v_add_u32 v34, 0x10000, v4
    v_add_u32 v38, 0x20000, v4
    v_add_u32 v35, 0x10000, v5
    v_add_u32 v39, 0x20000, v5
    s_lshr_b32 s56, s40, 1
    buffer_load_dwordx4 v46, s[16:19], s81 offen offset:1024 lds
    s_and_b32 s57, s40, 1
    s_lshl_b32 s57, s57, 4
    v_lshrrev_b32 v10, 3, v1
    v_add_u32 v10, s57, v10
    v_and_b32 v11, 7, v1
    v_mul_u32_u24 v7, 1056, v11
    v_lshl_add_u32 v7, v10, 4, v7
    s_mul_i32 s58, s56, 8448
    v_add_u32 v7, s58, v7
    v_lshlrev_b32 v8, 4, v11
    v_and_b32 v11, 3, v10
    v_lshl_add_u32 v8, v11, 15, v8
    v_lshrrev_b32 v11, 3, v10
    v_lshl_add_u32 v8, v11, 11, v8
    v_bfe_u32 v11, v10, 2, 1
    v_lshl_add_u32 v8, v11, 10, v8
    s_add_u32 m0, s75, 32768
    s_add_u32 s81, s34, 16384
    buffer_load_dwordx4 v44, s[16:19], s81 offen lds
    s_lshl_b32 s58, s85, 1
    s_add_u32 s58, s58, s56
    s_lshl_b32 s58, s58, 13
    s_lshl_b32 s59, s84, 17
    s_add_u32 s58, s58, s59
    s_lshl_b32 s59, s86, 7
    s_add_u32 s58, s58, s59
    v_add_u32 v8, s58, v8
    v_and_b32 v10, 31, v1
    s_lshl_b32 s56, s86, 6
    v_add_u32 v10, s56, v10
    v_cvt_f32_u32 v12, v10
    v_add_u32 v10, 32, v10
    v_cvt_f32_u32 v13, v10
    v_lshrrev_b32 v11, 5, v1
    v_lshlrev_b32 v11, 2, v11
    buffer_load_dwordx4 v46, s[16:19], s81 offen offset:1024 lds
    s_lshl_b32 s56, s40, 6
    s_add_u32 s56, s56, 1
    v_add_u32 v11, s56, v11
    v_cvt_f32_u32 v11, v11
    v_mul_f32 v12, 0x3b000000, v12
    v_mul_f32 v14, 0x40a00000, v12
    v_mul_f32 v16, v11, v12
    v_mul_f32 v13, 0x3b000000, v13
    v_mul_f32 v15, 0x40a00000, v13
    v_mul_f32 v17, v11, v13
    s_waitcnt vmcnt(12)
    v_cmp_ne_u32 vcc, s46, v28
    v_cmp_ne_u32 s[62:63], s46, v29
    s_nop 3
    s_or_b64 vcc, vcc, s[62:63]
    s_cmp_lg_u64 vcc, 0
    s_cbranch_scc1 L_slow_p2a
L_back_p2a:
    s_mul_i32 s56, s2, 8704
    s_lshl_b32 s57, s40, 11
    s_add_u32 s58, s56, s57
    s_add_u32 m0, s57, 147456
    s_add_u32 s59, s58, 3407872
    buffer_load_dwordx4 v43, s[20:23], s59 offen offset:0 sc1 lds
    buffer_load_dwordx4 v43, s[20:23], s59 offen offset:1024 sc1 lds
    v_and_b32 v30, 15, v1
    v_lshrrev_b32 v31, 4, v1
    v_lshlrev_b32 v25, 7, v30
    v_lshl_add_u32 v25, v31, 4, v25
    s_mul_i32 s58, s2, 8320
    s_add_u32 s58, s58, s57
    s_add_u32 s59, s58, 1048576
    buffer_load_dwordx4 v[112:115], v25, s[20:23], s59 offen offset:0 sc1
    buffer_load_dwordx4 v[116:119], v25, s[20:23], s59 offen offset:64 sc1
    v_lshlrev_b32 v25, 9, v31
    v_lshl_add_u32 v25, v30, 4, v25
    v_add_u32 v24, 147456, v25
    s_lshl_b32 s93, s84, 7
    s_add_u32 s93, s93, 4096
    v_lshlrev_b32 v9, 2, v1
    v_min_u32 v9, 44, v9
    buffer_load_dword v41, v9, s[20:23], s93 offen sc1
    v_pk_mul_f32 v[80:81], v[224:225], v[96:97]
    v_pk_mul_f32 v[82:83], v[226:227], v[96:97]
    v_exp_f32 v80, v80
    v_pk_mul_f32 v[224:225], v[224:225], v[232:233]
    v_exp_f32 v81, v81
    v_pk_mul_f32 v[226:227], v[226:227], v[234:235]
    v_exp_f32 v82, v82
    v_exp_f32 v83, v83
    v_pk_fma_f32 v[80:81], v[80:81], v[100:101], v[100:101]
    v_pk_fma_f32 v[82:83], v[82:83], v[100:101], v[100:101]
    v_rcp_f32 v80, v80
    s_add_u32 m0, s75, 65536
    s_add_u32 s81, s34, 32768
    buffer_load_dwordx4 v44, s[16:19], s81 offen lds
    v_rcp_f32 v81, v81
    v_rcp_f32 v82, v82
    v_rcp_f32 v83, v83
    s_nop 0
    v_pk_mul_f32 v[224:225], v[224:225], v[80:81]
    v_pk_mul_f32 v[226:227], v[226:227], v[82:83]
    v_cvt_pk_bf16_f32 v84, v224, v225
    v_cvt_pk_bf16_f32 v85, v226, v227
    v_pk_mul_f32 v[80:81], v[228:229], v[96:97]
    v_pk_mul_f32 v[82:83], v[230:231], v[96:97]
    v_exp_f32 v80, v80
    v_pk_mul_f32 v[228:229], v[228:229], v[236:237]
    buffer_load_dwordx4 v46, s[16:19], s81 offen offset:1024 lds
    v_exp_f32 v81, v81
    v_pk_mul_f32 v[230:231], v[230:231], v[238:239]
    v_exp_f32 v82, v82
    v_exp_f32 v83, v83
    v_pk_fma_f32 v[80:81], v[80:81], v[100:101], v[100:101]
    v_pk_fma_f32 v[82:83], v[82:83], v[100:101], v[100:101]
    v_rcp_f32 v80, v80
    v_rcp_f32 v81, v81
    v_rcp_f32 v82, v82
    v_rcp_f32 v83, v83
    s_add_u32 m0, s75, 73728
    s_add_u32 s81, s34, 49152
    buffer_load_dwordx4 v44, s[16:19], s81 offen lds
    s_add_u32 s98, s52, 13312
    v_pk_mul_f32 v[228:229], v[228:229], v[80:81]
    v_pk_mul_f32 v[230:231], v[230:231], v[82:83]
    v_cvt_pk_bf16_f32 v86, v228, v229
    v_cvt_pk_bf16_f32 v87, v230, v231
    buffer_store_dwordx4 v[84:87], v32, s[20:23], s98 offen sc1
    v_pk_mul_f32 v[80:81], v[240:241], v[98:99]
    v_pk_mul_f32 v[82:83], v[242:243], v[98:99]
    v_exp_f32 v80, v80
    v_pk_mul_f32 v[240:241], v[240:241], v[248:249]
    v_exp_f32 v81, v81
    v_pk_mul_f32 v[242:243], v[242:243], v[250:251]
    v_exp_f32 v82, v82
    v_exp_f32 v83, v83
    v_pk_fma_f32 v[80:81], v[80:81], v[102:103], v[102:103]
    v_pk_fma_f32 v[82:83], v[82:83], v[102:103], v[102:103]
    v_rcp_f32 v80, v80
    buffer_load_dwordx4 v46, s[16:19], s81 offen offset:1024 lds
    v_rcp_f32 v81, v81
    v_rcp_f32 v82, v82
    v_rcp_f32 v83, v83
    s_nop 0
    v_pk_mul_f32 v[240:241], v[240:241], v[80:81]
    v_pk_mul_f32 v[242:243], v[242:243], v[82:83]
    v_cvt_pk_bf16_f32 v84, v240, v241
    v_cvt_pk_bf16_f32 v85, v242, v243
    v_pk_mul_f32 v[80:81], v[244:245], v[98:99]
    v_pk_mul_f32 v[82:83], v[246:247], v[98:99]
    v_exp_f32 v80, v80
    v_pk_mul_f32 v[244:245], v[244:245], v[252:253]
    s_add_u32 m0, s75, 81920
    s_add_u32 s81, s35, 0
    buffer_load_dwordx4 v44, s[16:19], s81 offen lds
    v_exp_f32 v81, v81
    v_pk_mul_f32 v[246:247], v[246:247], v[254:255]
    v_exp_f32 v82, v82
    v_exp_f32 v83, v83
    v_pk_fma_f32 v[80:81], v[80:81], v[102:103], v[102:103]
    v_pk_fma_f32 v[82:83], v[82:83], v[102:103], v[102:103]
    v_rcp_f32 v80, v80
    v_rcp_f32 v81, v81
    v_rcp_f32 v82, v82
    v_rcp_f32 v83, v83
    buffer_load_dwordx4 v46, s[16:19], s81 offen offset:1024 lds
    s_add_u32 s98, s52, 128000
    v_pk_mul_f32 v[244:245], v[244:245], v[80:81]
    v_pk_mul_f32 v[246:247], v[246:247], v[82:83]
    v_cvt_pk_bf16_f32 v86, v244, v245
    v_cvt_pk_bf16_f32 v87, v246, v247
    buffer_store_dwordx4 v[84:87], v32, s[20:23], s98 offen sc1
    v_lshrrev_b32 v10, 5, v1
    v_lshlrev_b32 v2, 9, v10
    v_bfe_u32 v10, v1, 2, 2
    v_lshl_add_u32 v2, v10, 7, v2
    v_bfe_u32 v10, v1, 3, 1
    v_lshl_add_u32 v2, v10, 6, v2
    v_bfe_u32 v10, v1, 4, 1
    v_lshl_add_u32 v2, v10, 5, v2
    v_and_b32 v10, 3, v1
    v_lshl_add_u32 v2, v10, 3, v2
    v_add_u32 v2, s75, v2
    v_xor_b32 v3, 64, v2
    v_add_u32 v32, 0x10000, v2
    v_add_u32 v36, 0x20000, v2
    v_add_u32 v33, 0x10000, v3
    v_add_u32 v37, 0x20000, v3
    s_add_u32 m0, s75, 90112
    s_add_u32 s81, s35, 16384
    buffer_load_dwordx4 v44, s[16:19], s81 offen lds
    buffer_load_dwordx4 v46, s[16:19], s81 offen offset:1024 lds
    s_waitcnt vmcnt(10)
    v_cmp_ne_u32 vcc, s46, v41
    s_nop 3
    s_cmp_lg_u64 vcc, 0
    s_cbranch_scc1 L_slow_hf0
L_back_hf0:
    s_barrier
    ds_read_b128 v[64:67], v24 offset:0
    ds_read_b128 v[80:83], v24 offset:256
    ds_read_b128 v[68:71], v24 offset:2048
    ds_read_b128 v[84:87], v24 offset:2304
    ds_read_b128 v[72:75], v24 offset:4096
    ds_read_b128 v[88:91], v24 offset:4352
    ds_read_b128 v[76:79], v24 offset:6144
    ds_read_b128 v[92:95], v24 offset:6400
    v_and_b32 v30, 15, v1
    v_lshlrev_b32 v26, 6, v30
    v_bfe_u32 v30, v1, 2, 1
    v_lshl_add_u32 v26, v30, 5, v26
    v_lshrrev_b32 v30, 4, v1
    v_lshl_add_u32 v26, v30, 3, v26
    s_lshl_b32 s56, s40, 10
    s_add_u32 s56, s56, 155648
    v_add_u32 v26, s56, v26
    v_xor_b32 v27, 32, v26
    v_lshrrev_b32 v30, 2, v1
    v_lshlrev_b32 v28, 6, v30
    v_bfe_u32 v30, v1, 4, 1
    v_lshl_add_u32 v28, v30, 5, v28
    v_and_b32 v30, 3, v1
    v_lshl_add_u32 v28, v30, 3, v28
    v_add_u32 v28, 155648, v28
    v_xor_b32 v29, 32, v28
    s_add_u32 s83, s8, 0
    buffer_load_dwordx4 a[96:99], v43, s[20:23], s83 offen sc1
    s_waitcnt lgkmcnt(6)
    v_mfma_f32_16x16x32_bf16 v[192:195], v[64:67], a[0:3], 0
    v_mfma_f32_16x16x32_bf16 v[196:199], v[64:67], a[4:7], 0
    v_mfma_f32_16x16x32_bf16 v[200:203], v[80:83], a[0:3], 0
    v_mfma_f32_16x16x32_bf16 v[204:207], v[80:83], a[4:7], 0
    buffer_load_dwordx4 a[100:103], v47, s[20:23], s83 offen sc1
    s_waitcnt lgkmcnt(4)
    v_mfma_f32_16x16x32_bf16 v[192:195], v[68:71], a[8:11], v[192:195]
    v_mfma_f32_16x16x32_bf16 v[196:199], v[68:71], a[12:15], v[196:199]
    v_mfma_f32_16x16x32_bf16 v[200:203], v[84:87], a[8:11], v[200:203]
    v_mfma_f32_16x16x32_bf16 v[204:207], v[84:87], a[12:15], v[204:207]
    s_add_u32 s83, s8, 1024
    buffer_load_dwordx4 a[104:107], v43, s[20:23], s83 offen sc1
    s_waitcnt lgkmcnt(2)
    v_mfma_f32_16x16x32_bf16 v[192:195], v[72:75], a[16:19], v[192:195]
    v_mfma_f32_16x16x32_bf16 v[196:199], v[72:75], a[20:23], v[196:199]
    v_mfma_f32_16x16x32_bf16 v[200:203], v[88:91], a[16:19], v[200:203]
    v_mfma_f32_16x16x32_bf16 v[204:207], v[88:91], a[20:23], v[204:207]
    buffer_load_dwordx4 a[108:111], v47, s[20:23], s83 offen sc1
    s_waitcnt lgkmcnt(0)
    v_mfma_f32_16x16x32_bf16 v[192:195], v[76:79], a[24:27], v[192:195]
    v_mfma_f32_16x16x32_bf16 v[196:199], v[76:79], a[28:31], v[196:199]
    v_mfma_f32_16x16x32_bf16 v[200:203], v[92:95], a[24:27], v[200:203]
    v_mfma_f32_16x16x32_bf16 v[204:207], v[92:95], a[28:31], v[204:207]
    s_add_u32 s83, s8, 2048
    buffer_load_dwordx4 a[112:115], v43, s[20:23], s83 offen sc1
    s_nop 5
    v_pk_mul_f32 v[208:209], v[192:193], v[48:49]
    v_pk_mul_f32 v[212:213], v[196:197], v[48:49]
    v_pk_fma_f32 v[208:209], v[196:197], v[52:53], v[208:209]
    v_pk_fma_f32 v[212:213], v[192:193], v[52:53], v[212:213] neg_lo:[1,0,0] neg_hi:[1,0,0]
    v_pk_mul_f32 v[210:211], v[194:195], v[50:51]
    v_pk_mul_f32 v[214:215], v[198:199], v[50:51]
    v_pk_fma_f32 v[210:211], v[198:199], v[54:55], v[210:211]
    v_pk_fma_f32 v[214:215], v[194:195], v[54:55], v[214:215] neg_lo:[1,0,0] neg_hi:[1,0,0]
    v_pk_mul_f32 v[216:217], v[200:201], v[56:57]
    v_pk_mul_f32 v[220:221], v[204:205], v[56:57]
    v_pk_fma_f32 v[216:217], v[204:205], v[60:61], v[216:217]
    v_pk_fma_f32 v[220:221], v[200:201], v[60:61], v[220:221] neg_lo:[1,0,0] neg_hi:[1,0,0]
    v_pk_mul_f32 v[218:219], v[202:203], v[58:59]
    v_pk_mul_f32 v[222:223], v[206:207], v[58:59]
    v_pk_fma_f32 v[218:219], v[206:207], v[62:63], v[218:219]
    v_pk_fma_f32 v[222:223], v[202:203], v[62:63], v[222:223] neg_lo:[1,0,0] neg_hi:[1,0,0]
    buffer_load_dwordx4 a[116:119], v47, s[20:23], s83 offen sc1
    v_cvt_pk_bf16_f32 v224, v208, v209
    v_cvt_pk_bf16_f32 v225, v210, v211
    v_cvt_pk_bf16_f32 v228, v212, v213
    v_cvt_pk_bf16_f32 v229, v214, v215
    v_cvt_pk_bf16_f32 v226, v216, v217
    v_cvt_pk_bf16_f32 v227, v218, v219
    v_cvt_pk_bf16_f32 v230, v220, v221
    v_cvt_pk_bf16_f32 v231, v222, v223
    s_nop 1
    v_mfma_f32_16x16x32_bf16 v[192:195], a[32:35], v[224:227], 0
    v_mfma_f32_16x16x32_bf16 v[196:199], a[32:35], v[228:231], 0
    s_add_u32 s83, s8, 3072
    buffer_load_dwordx4 a[120:123], v43, s[20:23], s83 offen sc1
    v_mfma_f32_16x16x32_bf16 v[200:203], a[44:47], v[224:227], 0
    v_mfma_f32_16x16x32_bf16 v[204:207], a[44:47], v[228:231], 0
    v_mfma_f32_16x16x32_bf16 v[192:195], a[36:39], v[228:231], v[192:195]
    v_mfma_f32_16x16x32_bf16 v[196:199], a[40:43], v[224:227], v[196:199]
    buffer_load_dwordx4 a[124:127], v47, s[20:23], s83 offen sc1
    v_mfma_f32_16x16x32_bf16 v[200:203], a[48:51], v[228:231], v[200:203]
    v_mfma_f32_16x16x32_bf16 v[204:207], a[52:55], v[224:227], v[204:207]
    v_lshlrev_b32 v232, 16, v112
    v_and_b32 v240, 0xffff0000, v112
    v_lshlrev_b32 v233, 16, v113
    v_and_b32 v241, 0xffff0000, v113
    v_lshlrev_b32 v234, 16, v114
    v_and_b32 v242, 0xffff0000, v114
    v_lshlrev_b32 v235, 16, v115
    v_and_b32 v243, 0xffff0000, v115
    s_add_u32 s83, s9, 0
    buffer_load_dwordx4 a[128:131], v43, s[20:23], s83 offen sc1
    v_lshlrev_b32 v236, 16, v116
    v_and_b32 v244, 0xffff0000, v116
    v_lshlrev_b32 v237, 16, v117
    v_and_b32 v245, 0xffff0000, v117
    v_lshlrev_b32 v238, 16, v118
    v_and_b32 v246, 0xffff0000, v118
    v_lshlrev_b32 v239, 16, v119
    v_and_b32 v247, 0xffff0000, v119
    v_pk_mul_f32 v[208:209], v[192:193], v[232:233]
    v_pk_mul_f32 v[212:213], v[196:197], v[232:233]
    v_pk_fma_f32 v[208:209], v[196:197], v[240:241], v[208:209] neg_lo:[1,0,0] neg_hi:[1,0,0]
    v_pk_fma_f32 v[212:213], v[192:193], v[240:241], v[212:213]
    v_pk_mul_f32 v[210:211], v[194:195], v[234:235]
    v_pk_mul_f32 v[214:215], v[198:199], v[234:235]
    v_pk_fma_f32 v[210:211], v[198:199], v[242:243], v[210:211] neg_lo:[1,0,0] neg_hi:[1,0,0]
    v_pk_fma_f32 v[214:215], v[194:195], v[242:243], v[214:215]
    buffer_load_dwordx4 a[132:135], v47, s[20:23], s83 offen sc1
    v_pk_mul_f32 v[216:217], v[200:201], v[236:237]
    v_pk_mul_f32 v[220:221], v[204:205], v[236:237]
    v_pk_fma_f32 v[216:217], v[204:205], v[244:245], v[216:217] neg_lo:[1,0,0] neg_hi:[1,0,0]
    v_pk_fma_f32 v[220:221], v[200:201], v[244:245], v[220:221]
    v_pk_mul_f32 v[218:219], v[202:203], v[238:239]
    v_pk_mul_f32 v[222:223], v[206:207], v[238:239]
    v_pk_fma_f32 v[218:219], v[206:207], v[246:247], v[218:219] neg_lo:[1,0,0] neg_hi:[1,0,0]
    v_pk_fma_f32 v[222:223], v[202:203], v[246:247], v[222:223]
    v_cvt_pk_bf16_f32 v224, v208, v209
    v_cvt_pk_bf16_f32 v225, v210, v211
    v_cvt_pk_bf16_f32 v228, v212, v213
    v_cvt_pk_bf16_f32 v229, v214, v215
    v_cvt_pk_bf16_f32 v226, v216, v217
    v_cvt_pk_bf16_f32 v227, v218, v219
    v_cvt_pk_bf16_f32 v230, v220, v221
    v_cvt_pk_bf16_f32 v231, v222, v223
    s_add_u32 s83, s9, 1024
    buffer_load_dwordx4 a[136:139], v43, s[20:23], s83 offen sc1
    s_nop 1
    v_mfma_f32_16x16x32_bf16 v[192:195], a[32:35], v[224:227], 0
    v_mfma_f32_16x16x32_bf16 v[196:199], a[32:35], v[228:231], 0
    v_mfma_f32_16x16x32_bf16 v[200:203], a[44:47], v[224:227], 0
    v_mfma_f32_16x16x32_bf16 v[204:207], a[44:47], v[228:231], 0
    buffer_load_dwordx4 a[140:143], v47, s[20:23], s83 offen sc1
    v_mfma_f32_16x16x32_bf16 v[192:195], a[40:43], v[228:231], v[192:195]
    v_mfma_f32_16x16x32_bf16 v[196:199], a[36:39], v[224:227], v[196:199]
    v_mfma_f32_16x16x32_bf16 v[200:203], a[52:55], v[228:231], v[200:203]
    v_mfma_f32_16x16x32_bf16 v[204:207], a[48:51], v[224:227], v[204:207]
    s_add_u32 s83, s9, 2048
    buffer_load_dwordx4 a[144:147], v43, s[20:23], s83 offen sc1
    s_nop 7
    v_pk_mul_f32 v[208:209], v[192:193], v[48:49]
    v_pk_mul_f32 v[212:213], v[196:197], v[48:49]
    v_pk_fma_f32 v[208:209], v[196:197], v[52:53], v[208:209] neg_lo:[1,0,0] neg_hi:[1,0,0]
    v_pk_fma_f32 v[212:213], v[192:193], v[52:53], v[212:213]
    v_pk_mul_f32 v[210:211], v[194:195], v[50:51]
    v_pk_mul_f32 v[214:215], v[198:199], v[50:51]
    v_pk_fma_f32 v[210:211], v[198:199], v[54:55], v[210:211] neg_lo:[1,0,0] neg_hi:[1,0,0]
    v_pk_fma_f32 v[214:215], v[194:195], v[54:55], v[214:215]
    v_pk_mul_f32 v[216:217], v[200:201], v[56:57]
    v_pk_mul_f32 v[220:221], v[204:205], v[56:57]
    v_pk_fma_f32 v[216:217], v[204:205], v[60:61], v[216:217] neg_lo:[1,0,0] neg_hi:[1,0,0]
    v_pk_fma_f32 v[220:221], v[200:201], v[60:61], v[220:221]
    v_pk_mul_f32 v[218:219], v[202:203], v[58:59]
    v_pk_mul_f32 v[222:223], v[206:207], v[58:59]
    v_pk_fma_f32 v[218:219], v[206:207], v[62:63], v[218:219] neg_lo:[1,0,0] neg_hi:[1,0,0]
    v_pk_fma_f32 v[222:223], v[202:203], v[62:63], v[222:223]
    buffer_load_dwordx4 a[148:151], v47, s[20:23], s83 offen sc1
    v_cvt_pk_bf16_f32 v224, v208, v209
    v_cvt_pk_bf16_f32 v225, v210, v211
    v_cvt_pk_bf16_f32 v228, v212, v213
    v_cvt_pk_bf16_f32 v229, v214, v215
    v_cvt_pk_bf16_f32 v226, v216, v217
    v_cvt_pk_bf16_f32 v227, v218, v219
    v_cvt_pk_bf16_f32 v230, v220, v221
    v_cvt_pk_bf16_f32 v231, v222, v223
    ds_write_b64 v26, v[228:229]
    ds_write_b64 v26, v[224:225] offset:4096
    ds_write_b64 v27, v[230:231]
    ds_write_b64 v27, v[226:227] offset:4096
    s_waitcnt vmcnt(16) lgkmcnt(0)
    s_barrier
    s_cmp_lg_u32 s40, 0
    s_cbranch_scc1 L_fl_h1
    s_lshl_b32 s96, s43, 7
    s_lshl_b32 s97, s44, 2
    s_add_u32 s96, s96, s97
    s_add_u32 s96, s96, 4160
    v_mov_b32 v45, s46
    buffer_store_dword v45, v22, s[20:23], s96 offen sc1
L_fl_h1:
    ds_read_b64_tr_b16 v[64:65], v28 offset:0
    ds_read_b64_tr_b16 v[66:67], v28 offset:4096
    ds_read_b64_tr_b16 v[68:69], v28 offset:1024
    ds_read_b64_tr_b16 v[70:71], v28 offset:5120
    s_add_u32 s83, s9, 3072
    buffer_load_dwordx4 a[152:155], v43, s[20:23], s83 offen sc1
    ds_read_b64_tr_b16 v[72:73], v28 offset:2048
    ds_read_b64_tr_b16 v[74:75], v28 offset:6144
    ds_read_b64_tr_b16 v[76:77], v28 offset:3072
    ds_read_b64_tr_b16 v[78:79], v28 offset:7168
    ds_read_b64_tr_b16 v[80:81], v29 offset:0
    ds_read_b64_tr_b16 v[82:83], v29 offset:4096
    ds_read_b64_tr_b16 v[84:85], v29 offset:1024
    ds_read_b64_tr_b16 v[86:87], v29 offset:5120
    buffer_load_dwordx4 a[156:159], v47, s[20:23], s83 offen sc1
    ds_read_b64_tr_b16 v[88:89], v29 offset:2048
    ds_read_b64_tr_b16 v[90:91], v29 offset:6144
    ds_read_b64_tr_b16 v[92:93], v29 offset:3072
    ds_read_b64_tr_b16 v[94:95], v29 offset:7168
    s_mov_b32 s78, 0x36000000
    s_cmp_eq_u32 s2, 255
    s_cselect_b32 s78, 0x35800000, s78
    s_mul_i32 s56, s2, 8704
    s_lshl_b32 s57, s40, 11
    s_add_u32 s56, s56, s57
    s_add_u32 s60, s56, 5767168
    v_mov_b32 v232, s78
    v_mov_b32 v233, s78
    s_waitcnt lgkmcnt(8)
    v_mfma_f32_16x16x32_bf16 v[196:199], a[0:3], v[64:67], 0
    v_mfma_f32_16x16x32_bf16 v[192:195], a[4:7], v[64:67], 0
    s_add_u32 s83, s10, 0
    buffer_load_dwordx4 a[160:163], v43, s[20:23], s83 offen sc1
    v_mfma_f32_16x16x32_bf16 v[196:199], a[8:11], v[68:71], v[196:199]
    v_mfma_f32_16x16x32_bf16 v[192:195], a[12:15], v[68:71], v[192:195]
    v_mfma_f32_16x16x32_bf16 v[196:199], a[16:19], v[72:75], v[196:199]
    v_mfma_f32_16x16x32_bf16 v[192:195], a[20:23], v[72:75], v[192:195]
    buffer_load_dwordx4 a[164:167], v47, s[20:23], s83 offen sc1
    v_mfma_f32_16x16x32_bf16 v[196:199], a[24:27], v[76:79], v[196:199]
    v_mfma_f32_16x16x32_bf16 v[192:195], a[28:31], v[76:79], v[192:195]
    s_waitcnt lgkmcnt(0)
    v_mfma_f32_16x16x32_bf16 v[204:207], a[0:3], v[80:83], 0
    v_mfma_f32_16x16x32_bf16 v[200:203], a[4:7], v[80:83], 0
    s_add_u32 s83, s10, 1024
    buffer_load_dwordx4 a[168:171], v43, s[20:23], s83 offen sc1
    v_mfma_f32_16x16x32_bf16 v[204:207], a[8:11], v[84:87], v[204:207]
    v_mfma_f32_16x16x32_bf16 v[200:203], a[12:15], v[84:87], v[200:203]
    v_mfma_f32_16x16x32_bf16 v[204:207], a[16:19], v[88:91], v[204:207]
    v_mfma_f32_16x16x32_bf16 v[200:203], a[20:23], v[88:91], v[200:203]
    buffer_load_dwordx4 a[172:175], v47, s[20:23], s83 offen sc1
    v_mfma_f32_16x16x32_bf16 v[204:207], a[24:27], v[92:95], v[204:207]
    v_mfma_f32_16x16x32_bf16 v[200:203], a[28:31], v[92:95], v[200:203]
    ds_read_b64_tr_b16 v[96:97], v36 offset:0
    ds_read_b64_tr_b16 v[98:99], v36 offset:1024
    ds_read_b64_tr_b16 v[100:101], v37 offset:0
    ds_read_b64_tr_b16 v[102:103], v37 offset:1024
    s_nop 3
    v_pk_mul_f32 v[192:193], v[192:193], v[232:233]
    v_pk_mul_f32 v[194:195], v[194:195], v[232:233]
    v_pk_mul_f32 v[196:197], v[196:197], v[232:233]
    v_pk_mul_f32 v[198:199], v[198:199], v[232:233]
    v_cvt_pk_bf16_f32 v224, v192, v193
    v_cvt_pk_bf16_f32 v225, v194, v195
    v_cvt_pk_bf16_f32 v226, v196, v197
    v_cvt_pk_bf16_f32 v227, v198, v199
    s_add_u32 s83, s10, 2048
    buffer_load_dwordx4 a[176:179], v43, s[20:23], s83 offen sc1
    buffer_store_dwordx4 v[224:227], v25, s[20:23], s60 offen offset:0 sc1
    v_pk_mul_f32 v[200:201], v[200:201], v[232:233]
    v_pk_mul_f32 v[202:203], v[202:203], v[232:233]
    v_pk_mul_f32 v[204:205], v[204:205], v[232:233]
    v_pk_mul_f32 v[206:207], v[206:207], v[232:233]
    v_cvt_pk_bf16_f32 v228, v200, v201
    v_cvt_pk_bf16_f32 v229, v202, v203
    v_cvt_pk_bf16_f32 v230, v204, v205
    v_cvt_pk_bf16_f32 v231, v206, v207
    buffer_store_dwordx4 v[228:231], v25, s[20:23], s60 offen offset:256 sc1
    buffer_load_dwordx4 a[180:183], v47, s[20:23], s83 offen sc1
    s_waitcnt vmcnt(22) lgkmcnt(0)
    v_mfma_f32_32x32x16_bf16 v[128:143], v[96:99], a[96:99], 0
    ds_read_b64_tr_b16 v[104:105], v36 offset:8192
    ds_read_b64_tr_b16 v[106:107], v36 offset:9216
    s_add_u32 s83, s10, 3072
    buffer_load_dwordx4 a[184:187], v43, s[20:23], s83 offen sc1
    v_cos_f32 v120, v16
    v_sin_f32 v121, v16
    v_cos_f32 v122, v17
    v_mfma_f32_32x32x16_bf16 v[144:159], v[100:103], a[96:99], 0
    ds_read_b64_tr_b16 v[108:109], v37 offset:8192
    ds_read_b64_tr_b16 v[110:111], v37 offset:9216
    buffer_load_dwordx4 a[188:191], v47, s[20:23], s83 offen sc1
    v_sin_f32 v123, v17
    v_add_f32 v16, v16, v12
    v_add_f32 v17, v17, v13
    v_mfma_f32_32x32x16_bf16 v[160:175], v[96:99], a[100:103], 0
    v_cvt_pk_bf16_f32 v192, v120, -v121
    v_cvt_pk_bf16_f32 v196, v122, -v123
    v_mfma_f32_32x32x16_bf16 v[176:191], v[100:103], a[100:103], 0
    v_cos_f32 v120, v16
    v_sin_f32 v121, v16
    s_waitcnt vmcnt(22) lgkmcnt(0)
    v_mfma_f32_32x32x16_bf16 v[128:143], v[104:107], a[104:107], v[128:143]
    ds_read_b64_tr_b16 v[96:97], v2 offset:40960
    ds_read_b64_tr_b16 v[98:99], v2 offset:41984
    s_add_u32 m0, s75, 98304
    s_add_u32 s81, s35, 32768
    buffer_load_dwordx4 v44, s[16:19], s81 offen lds
    v_cos_f32 v122, v17
    v_sin_f32 v123, v17
    v_add_f32 v16, v16, v12
    v_mfma_f32_32x32x16_bf16 v[144:159], v[108:111], a[104:107], v[144:159]
    ds_read_b64_tr_b16 v[100:101], v3 offset:40960
    ds_read_b64_tr_b16 v[102:103], v3 offset:41984
    buffer_load_dwordx4 v46, s[16:19], s81 offen offset:1024 lds
    v_add_f32 v17, v17, v13
    v_cvt_pk_bf16_f32 v193, v120, -v121
    v_cvt_pk_bf16_f32 v197, v122, -v123
    v_mfma_f32_32x32x16_bf16 v[160:175], v[104:107], a[108:111], v[160:175]
    v_cos_f32 v120, v16
    v_sin_f32 v121, v16
    v_mfma_f32_32x32x16_bf16 v[176:191], v[108:111], a[108:111], v[176:191]
    v_cos_f32 v122, v17
    v_sin_f32 v123, v17
    s_lshl_b32 s93, s84, 7
    s_add_u32 s93, s93, 4160
    v_lshlrev_b32 v9, 2, v1
    v_min_u32 v9, 60, v9
    buffer_load_dword v41, v9, s[20:23], s93 offen sc1
    s_waitcnt vmcnt(23) lgkmcnt(0)
    v_mfma_f32_32x32x16_bf16 v[128:143], v[96:99], a[112:115], v[128:143]
    ds_read_b64_tr_b16 v[104:105], v2 offset:49152
    ds_read_b64_tr_b16 v[106:107], v2 offset:50176
    s_add_u32 m0, s75, 106496
    s_add_u32 s81, s35, 49152
    buffer_load_dwordx4 v44, s[16:19], s81 offen lds
    v_add_f32 v16, v16, v12
    v_add_f32 v17, v17, v13
    v_cvt_pk_bf16_f32 v194, v120, -v121
    v_mfma_f32_32x32x16_bf16 v[144:159], v[100:103], a[112:115], v[144:159]
    ds_read_b64_tr_b16 v[108:109], v3 offset:49152
    ds_read_b64_tr_b16 v[110:111], v3 offset:50176
    buffer_load_dwordx4 v46, s[16:19], s81 offen offset:1024 lds
    v_cvt_pk_bf16_f32 v198, v122, -v123
    v_cos_f32 v120, v16
    v_sin_f32 v121, v16
    v_mfma_f32_32x32x16_bf16 v[160:175], v[96:99], a[116:119], v[160:175]
    v_cos_f32 v122, v17
    v_sin_f32 v123, v17
    v_mfma_f32_32x32x16_bf16 v[176:191], v[100:103], a[116:119], v[176:191]
    v_add_f32 v16, v16, v14
    v_add_f32 v17, v17, v15
    s_waitcnt vmcnt(23) lgkmcnt(0)
    v_mfma_f32_32x32x16_bf16 v[128:143], v[104:107], a[120:123], v[128:143]
    ds_read_b64_tr_b16 v[96:97], v2 offset:57344
    ds_read_b64_tr_b16 v[98:99], v2 offset:58368
    s_add_u32 m0, s75, 114688
    s_add_u32 s81, s36, 0
    buffer_load_dwordx4 v44, s[16:19], s81 offen lds
    v_cvt_pk_bf16_f32 v195, v120, -v121
    v_cvt_pk_bf16_f32 v199, v122, -v123
    v_cos_f32 v120, v16
    v_mfma_f32_32x32x16_bf16 v[144:159], v[108:111], a[120:123], v[144:159]
    ds_read_b64_tr_b16 v[100:101], v3 offset:57344
    ds_read_b64_tr_b16 v[102:103], v3 offset:58368
    buffer_load_dwordx4 v46, s[16:19], s81 offen offset:1024 lds
    v_sin_f32 v121, v16
    v_cos_f32 v122, v17
    v_sin_f32 v123, v17
    v_mfma_f32_32x32x16_bf16 v[160:175], v[104:107], a[124:127], v[160:175]
    v_add_f32 v16, v16, v12
    v_add_f32 v17, v17, v13
    v_mfma_f32_32x32x16_bf16 v[176:191], v[108:111], a[124:127], v[176:191]
    v_cvt_pk_bf16_f32 v200, v120, -v121
    v_cvt_pk_bf16_f32 v204, v122, -v123
    s_waitcnt vmcnt(23) lgkmcnt(0)
    v_mfma_f32_32x32x16_bf16 v[128:143], v[96:99], a[128:131], v[128:143]
    ds_read_b64_tr_b16 v[104:105], v2 offset:0
    ds_read_b64_tr_b16 v[106:107], v2 offset:1024
    s_add_u32 m0, s75, 122880
    s_add_u32 s81, s36, 16384
    buffer_load_dwordx4 v44, s[16:19], s81 offen lds
    v_cos_f32 v120, v16
    v_sin_f32 v121, v16
    v_cos_f32 v122, v17
    v_mfma_f32_32x32x16_bf16 v[144:159], v[100:103], a[128:131], v[144:159]
    ds_read_b64_tr_b16 v[108:109], v3 offset:0
    ds_read_b64_tr_b16 v[110:111], v3 offset:1024
    buffer_load_dwordx4 v46, s[16:19], s81 offen offset:1024 lds
    v_sin_f32 v123, v17
    v_add_f32 v16, v16, v12
    v_add_f32 v17, v17, v13
    v_mfma_f32_32x32x16_bf16 v[160:175], v[96:99], a[132:135], v[160:175]
    v_cvt_pk_bf16_f32 v201, v120, -v121
    v_cvt_pk_bf16_f32 v205, v122, -v123
    v_mfma_f32_32x32x16_bf16 v[176:191], v[100:103], a[132:135], v[176:191]
    v_cos_f32 v120, v16
    v_sin_f32 v121, v16
    s_waitcnt vmcnt(23) lgkmcnt(0)
    v_mfma_f32_32x32x16_bf16 v[128:143], v[104:107], a[136:139], v[128:143]
    ds_read_b64_tr_b16 v[96:97], v2 offset:8192
    ds_read_b64_tr_b16 v[98:99], v2 offset:9216
    s_add_u32 m0, s75, 131072
    s_add_u32 s81, s36, 32768
    buffer_load_dwordx4 v44, s[16:19], s81 offen lds
    v_cos_f32 v122, v17
    v_sin_f32 v123, v17
    v_add_f32 v16, v16, v12
    v_mfma_f32_32x32x16_bf16 v[144:159], v[108:111], a[136:139], v[144:159]
    ds_read_b64_tr_b16 v[100:101], v3 offset:8192
    ds_read_b64_tr_b16 v[102:103], v3 offset:9216
    buffer_load_dwordx4 v46, s[16:19], s81 offen offset:1024 lds
    v_add_f32 v17, v17, v13
    v_cvt_pk_bf16_f32 v202, v120, -v121
    v_cvt_pk_bf16_f32 v206, v122, -v123
    v_mfma_f32_32x32x16_bf16 v[160:175], v[104:107], a[140:143], v[160:175]
    v_cos_f32 v120, v16
    v_sin_f32 v121, v16
    v_mfma_f32_32x32x16_bf16 v[176:191], v[108:111], a[140:143], v[176:191]
    v_cos_f32 v122, v17
    v_sin_f32 v123, v17
    s_waitcnt vmcnt(14)
    s_barrier
    s_cmp_lg_u32 s40, 0
    s_cbranch_scc1 L_fl_v
    s_lshl_b32 s96, s2, 2
    s_add_u32 s96, s96, 16384
    v_mov_b32 v45, s46
    buffer_store_dword v45, v22, s[20:23], s96 offen sc1
L_fl_v:
    s_waitcnt vmcnt(8)
    v_cmp_ne_u32 vcc, s46, v41
    s_nop 3
    s_cmp_lg_u64 vcc, 0
    s_cbranch_scc1 L_slow_hf1
L_back_hf1:
    s_waitcnt lgkmcnt(0)
    v_mfma_f32_32x32x16_bf16 v[128:143], v[96:99], a[144:147], v[128:143]
    ds_read_b64_tr_b16 v[104:105], v2 offset:16384
    ds_read_b64_tr_b16 v[106:107], v2 offset:17408
    s_add_u32 s83, s11, 0
    buffer_load_dwordx4 a[192:195], v43, s[20:23], s83 offen sc1
    v_add_f32 v16, v16, v14
    v_add_f32 v17, v17, v15
    v_cvt_pk_bf16_f32 v203, v120, -v121
    v_mfma_f32_32x32x16_bf16 v[144:159], v[100:103], a[144:147], v[144:159]
    ds_read_b64_tr_b16 v[108:109], v3 offset:16384
    ds_read_b64_tr_b16 v[110:111], v3 offset:17408
    buffer_load_dwordx4 a[196:199], v47, s[20:23], s83 offen sc1
    v_cvt_pk_bf16_f32 v207, v122, -v123
    v_cos_f32 v120, v16
    v_sin_f32 v121, v16
    v_mfma_f32_32x32x16_bf16 v[160:175], v[96:99], a[148:151], v[160:175]
    s_add_u32 s83, s11, 1024
    buffer_load_dwordx4 a[200:203], v43, s[20:23], s83 offen sc1
    v_cos_f32 v122, v17
    v_sin_f32 v123, v17
    v_mfma_f32_32x32x16_bf16 v[176:191], v[100:103], a[148:151], v[176:191]
    buffer_load_dwordx4 a[204:207], v47, s[20:23], s83 offen sc1
    v_add_f32 v16, v16, v12
    v_add_f32 v17, v17, v13
    s_waitcnt lgkmcnt(0)
    v_mfma_f32_32x32x16_bf16 v[128:143], v[104:107], a[152:155], v[128:143]
    ds_read_b64_tr_b16 v[96:97], v2 offset:24576
    ds_read_b64_tr_b16 v[98:99], v2 offset:25600
    s_add_u32 s83, s11, 2048
    buffer_load_dwordx4 a[208:211], v43, s[20:23], s83 offen sc1
    v_cvt_pk_bf16_f32 v208, v120, -v121
    v_cvt_pk_bf16_f32 v212, v122, -v123
    v_cos_f32 v120, v16
    v_mfma_f32_32x32x16_bf16 v[144:159], v[108:111], a[152:155], v[144:159]
    ds_read_b64_tr_b16 v[100:101], v3 offset:24576
    ds_read_b64_tr_b16 v[102:103], v3 offset:25600
    buffer_load_dwordx4 a[212:215], v47, s[20:23], s83 offen sc1
    v_sin_f32 v121, v16
    v_cos_f32 v122, v17
    v_sin_f32 v123, v17
    v_mfma_f32_32x32x16_bf16 v[160:175], v[104:107], a[156:159], v[160:175]
    s_add_u32 s83, s11, 3072
    buffer_load_dwordx4 a[216:219], v43, s[20:23], s83 offen sc1
    v_add_f32 v16, v16, v12
    v_add_f32 v17, v17, v13
    v_mfma_f32_32x32x16_bf16 v[176:191], v[108:111], a[156:159], v[176:191]
    buffer_load_dwordx4 a[220:223], v47, s[20:23], s83 offen sc1
    v_cvt_pk_bf16_f32 v209, v120, -v121
    v_cvt_pk_bf16_f32 v213, v122, -v123
    s_waitcnt lgkmcnt(0)
    v_mfma_f32_32x32x16_bf16 v[128:143], v[96:99], a[160:163], v[128:143]
    ds_read_b64_tr_b16 v[104:105], v2 offset:32768
    ds_read_b64_tr_b16 v[106:107], v2 offset:33792
    s_add_u32 s83, s12, 0
    buffer_load_dwordx4 a[224:227], v43, s[20:23], s83 offen sc1
    v_cos_f32 v120, v16
    v_sin_f32 v121, v16
    v_cos_f32 v122, v17
    v_mfma_f32_32x32x16_bf16 v[144:159], v[100:103], a[160:163], v[144:159]
    ds_read_b64_tr_b16 v[108:109], v3 offset:32768
    ds_read_b64_tr_b16 v[110:111], v3 offset:33792
    buffer_load_dwordx4 a[228:231], v47, s[20:23], s83 offen sc1
    v_sin_f32 v123, v17
    v_add_f32 v16, v16, v12
    v_add_f32 v17, v17, v13
    v_mfma_f32_32x32x16_bf16 v[160:175], v[96:99], a[164:167], v[160:175]
    s_add_u32 s83, s12, 1024
    buffer_load_dwordx4 a[232:235], v43, s[20:23], s83 offen sc1
    v_cvt_pk_bf16_f32 v210, v120, -v121
    v_cvt_pk_bf16_f32 v214, v122, -v123
    v_mfma_f32_32x32x16_bf16 v[176:191], v[100:103], a[164:167], v[176:191]
    buffer_load_dwordx4 a[236:239], v47, s[20:23], s83 offen sc1
    v_cos_f32 v120, v16
    v_sin_f32 v121, v16
    s_waitcnt lgkmcnt(0)
    v_mfma_f32_32x32x16_bf16 v[128:143], v[104:107], a[168:171], v[128:143]
    ds_read_b64_tr_b16 v[96:97], v32 offset:0
    ds_read_b64_tr_b16 v[98:99], v32 offset:1024
    s_add_u32 m0, s75, 139264
    s_add_u32 s81, s36, 49152
    buffer_load_dwordx4 v44, s[16:19], s81 offen lds
    v_cos_f32 v122, v17
    v_sin_f32 v123, v17
    v_add_f32 v16, v16, v14
    v_mfma_f32_32x32x16_bf16 v[144:159], v[108:111], a[168:171], v[144:159]
    ds_read_b64_tr_b16 v[100:101], v33 offset:0
    ds_read_b64_tr_b16 v[102:103], v33 offset:1024
    buffer_load_dwordx4 v46, s[16:19], s81 offen offset:1024 lds
    v_add_f32 v17, v17, v15
    v_cvt_pk_bf16_f32 v211, v120, -v121
    v_cvt_pk_bf16_f32 v215, v122, -v123
    v_mfma_f32_32x32x16_bf16 v[160:175], v[104:107], a[172:175], v[160:175]
    s_add_u32 s83, s12, 2048
    buffer_load_dwordx4 a[240:243], v43, s[20:23], s83 offen sc1
    v_cos_f32 v120, v16
    v_sin_f32 v121, v16
    v_mfma_f32_32x32x16_bf16 v[176:191], v[108:111], a[172:175], v[176:191]
    buffer_load_dwordx4 a[244:247], v47, s[20:23], s83 offen sc1
    v_cos_f32 v122, v17
    v_sin_f32 v123, v17
    s_waitcnt lgkmcnt(0)
    v_mfma_f32_32x32x16_bf16 v[128:143], v[96:99], a[176:179], v[128:143]
    ds_read_b64_tr_b16 v[104:105], v32 offset:8192
    ds_read_b64_tr_b16 v[106:107], v32 offset:9216
    s_add_u32 m0, s75, 40960
    s_add_u32 s81, s37, 0
    buffer_load_dwordx4 v44, s[16:19], s81 offen lds
    v_add_f32 v16, v16, v12
    v_add_f32 v17, v17, v13
    v_cvt_pk_bf16_f32 v216, v120, -v121
    v_mfma_f32_32x32x16_bf16 v[144:159], v[100:103], a[176:179], v[144:159]
    ds_read_b64_tr_b16 v[108:109], v33 offset:8192
    ds_read_b64_tr_b16 v[110:111], v33 offset:9216
    buffer_load_dwordx4 v46, s[16:19], s81 offen offset:1024 lds
    v_cvt_pk_bf16_f32 v220, v122, -v123
    v_cos_f32 v120, v16
    v_sin_f32 v121, v16
    v_mfma_f32_32x32x16_bf16 v[160:175], v[96:99], a[180:183], v[160:175]
    s_add_u32 s83, s12, 3072
    buffer_load_dwordx4 a[248:251], v43, s[20:23], s83 offen sc1
    v_cos_f32 v122, v17
    v_sin_f32 v123, v17
    v_mfma_f32_32x32x16_bf16 v[176:191], v[100:103], a[180:183], v[176:191]
    buffer_load_dwordx4 a[252:255], v47, s[20:23], s83 offen sc1
    v_add_f32 v16, v16, v12
    v_add_f32 v17, v17, v13
    s_waitcnt lgkmcnt(0)
    v_mfma_f32_32x32x16_bf16 v[128:143], v[104:107], a[184:187], v[128:143]
    ds_read_b64_tr_b16 v[96:97], v32 offset:16384
    ds_read_b64_tr_b16 v[98:99], v32 offset:17408
    s_add_u32 m0, s75, 49152
    s_add_u32 s81, s37, 16384
    buffer_load_dwordx4 v44, s[16:19], s81 offen lds
    v_cvt_pk_bf16_f32 v217, v120, -v121
    v_cvt_pk_bf16_f32 v221, v122, -v123
    v_cos_f32 v120, v16
    v_mfma_f32_32x32x16_bf16 v[144:159], v[108:111], a[184:187], v[144:159]
    ds_read_b64_tr_b16 v[100:101], v33 offset:16384
    ds_read_b64_tr_b16 v[102:103], v33 offset:17408
    buffer_load_dwordx4 v46, s[16:19], s81 offen offset:1024 lds
    v_sin_f32 v121, v16
    v_cos_f32 v122, v17
    v_sin_f32 v123, v17
    v_mfma_f32_32x32x16_bf16 v[160:175], v[104:107], a[188:191], v[160:175]
    s_add_u32 s83, s13, 0
    buffer_load_dwordx4 a[96:99], v43, s[20:23], s83 offen sc1
    v_add_f32 v16, v16, v12
    v_add_f32 v17, v17, v13
    v_mfma_f32_32x32x16_bf16 v[176:191], v[108:111], a[188:191], v[176:191]
    buffer_load_dwordx4 a[100:103], v47, s[20:23], s83 offen sc1
    v_cvt_pk_bf16_f32 v218, v120, -v121
    v_cvt_pk_bf16_f32 v222, v122, -v123
    s_waitcnt vmcnt(22) lgkmcnt(0)
    v_mfma_f32_32x32x16_bf16 v[128:143], v[96:99], a[192:195], v[128:143]
    ds_read_b64_tr_b16 v[104:105], v32 offset:24576
    ds_read_b64_tr_b16 v[106:107], v32 offset:25600
    s_add_u32 m0, s75, 57344
    s_add_u32 s81, s37, 32768
    buffer_load_dwordx4 v44, s[16:19], s81 offen lds
    v_cos_f32 v120, v16
    v_sin_f32 v121, v16
    v_cos_f32 v122, v17
    v_mfma_f32_32x32x16_bf16 v[144:159], v[100:103], a[192:195], v[144:159]
    ds_read_b64_tr_b16 v[108:109], v33 offset:24576
    ds_read_b64_tr_b16 v[110:111], v33 offset:25600
    buffer_load_dwordx4 v46, s[16:19], s81 offen offset:1024 lds
    v_sin_f32 v123, v17
    v_add_f32 v16, v16, v14
    v_add_f32 v17, v17, v15
    v_mfma_f32_32x32x16_bf16 v[160:175], v[96:99], a[196:199], v[160:175]
    s_add_u32 s83, s13, 1024
    buffer_load_dwordx4 a[104:107], v43, s[20:23], s83 offen sc1
    v_cvt_pk_bf16_f32 v219, v120, -v121
    v_cvt_pk_bf16_f32 v223, v122, -v123
    v_mfma_f32_32x32x16_bf16 v[176:191], v[100:103], a[196:199], v[176:191]
    buffer_load_dwordx4 a[108:111], v47, s[20:23], s83 offen sc1
    v_cos_f32 v120, v16
    v_sin_f32 v121, v16
    s_waitcnt vmcnt(24) lgkmcnt(0)
    v_mfma_f32_32x32x16_bf16 v[128:143], v[104:107], a[200:203], v[128:143]
    ds_read_b64_tr_b16 v[96:97], v32 offset:32768
    ds_read_b64_tr_b16 v[98:99], v32 offset:33792
    s_add_u32 s83, s13, 2048
    buffer_load_dwordx4 a[112:115], v43, s[20:23], s83 offen sc1
    v_cos_f32 v122, v17
    v_sin_f32 v123, v17
    v_add_f32 v16, v16, v12
    v_mfma_f32_32x32x16_bf16 v[144:159], v[108:111], a[200:203], v[144:159]
    ds_read_b64_tr_b16 v[100:101], v33 offset:32768
    ds_read_b64_tr_b16 v[102:103], v33 offset:33792
    buffer_load_dwordx4 a[116:119], v47, s[20:23], s83 offen sc1
    v_add_f32 v17, v17, v13
    v_cvt_pk_bf16_f32 v224, v120, -v121
    v_cvt_pk_bf16_f32 v228, v122, -v123
    v_mfma_f32_32x32x16_bf16 v[160:175], v[104:107], a[204:207], v[160:175]
    s_add_u32 m0, s75, 0
    s_add_u32 s81, s37, 49152
    buffer_load_dwordx4 v44, s[16:19], s81 offen lds
    v_cos_f32 v120, v16
    v_sin_f32 v121, v16
    v_mfma_f32_32x32x16_bf16 v[176:191], v[108:111], a[204:207], v[176:191]
    buffer_load_dwordx4 v46, s[16:19], s81 offen offset:1024 lds
    v_cos_f32 v122, v17
    v_sin_f32 v123, v17
    s_waitcnt vmcnt(26) lgkmcnt(0)
    v_mfma_f32_32x32x16_bf16 v[128:143], v[96:99], a[208:211], v[128:143]
    ds_read_b64_tr_b16 v[104:105], v32 offset:40960
    ds_read_b64_tr_b16 v[106:107], v32 offset:41984
    s_add_u32 s83, s13, 3072
    buffer_load_dwordx4 a[120:123], v43, s[20:23], s83 offen sc1
    v_add_f32 v16, v16, v12
    v_add_f32 v17, v17, v13
    v_cvt_pk_bf16_f32 v225, v120, -v121
    v_mfma_f32_32x32x16_bf16 v[144:159], v[100:103], a[208:211], v[144:159]
    ds_read_b64_tr_b16 v[108:109], v33 offset:40960
    ds_read_b64_tr_b16 v[110:111], v33 offset:41984
    buffer_load_dwordx4 a[124:127], v47, s[20:23], s83 offen sc1
    v_cvt_pk_bf16_f32 v229, v122, -v123
    v_cos_f32 v120, v16
    v_sin_f32 v121, v16
    v_mfma_f32_32x32x16_bf16 v[160:175], v[96:99], a[212:215], v[160:175]
    s_add_u32 m0, s75, 8192
    s_add_u32 s81, s38, 0
    buffer_load_dwordx4 v44, s[16:19], s81 offen lds
    v_cos_f32 v122, v17
    v_sin_f32 v123, v17
    v_mfma_f32_32x32x16_bf16 v[176:191], v[100:103], a[212:215], v[176:191]
    buffer_load_dwordx4 v46, s[16:19], s81 offen offset:1024 lds
    v_add_f32 v16, v16, v12
    v_add_f32 v17, v17, v13
    s_waitcnt vmcnt(28) lgkmcnt(0)
    v_mfma_f32_32x32x16_bf16 v[128:143], v[104:107], a[216:219], v[128:143]
    ds_read_b64_tr_b16 v[96:97], v32 offset:49152
    ds_read_b64_tr_b16 v[98:99], v32 offset:50176
    s_add_u32 s83, s14, 0
    buffer_load_dwordx4 a[128:131], v43, s[20:23], s83 offen sc1
    v_cvt_pk_bf16_f32 v226, v120, -v121
    v_cvt_pk_bf16_f32 v230, v122, -v123
    v_cos_f32 v120, v16
    v_mfma_f32_32x32x16_bf16 v[144:159], v[108:111], a[216:219], v[144:159]
    ds_read_b64_tr_b16 v[100:101], v33 offset:49152
    ds_read_b64_tr_b16 v[102:103], v33 offset:50176
    buffer_load_dwordx4 a[132:135], v47, s[20:23], s83 offen sc1
    v_sin_f32 v121, v16
    v_cos_f32 v122, v17
    v_sin_f32 v123, v17
    v_mfma_f32_32x32x16_bf16 v[160:175], v[104:107], a[220:223], v[160:175]
    s_add_u32 m0, s75, 16384
    s_add_u32 s81, s38, 16384
    buffer_load_dwordx4 v44, s[16:19], s81 offen lds
    v_add_f32 v16, v16, v14
    v_add_f32 v17, v17, v15
    v_mfma_f32_32x32x16_bf16 v[176:191], v[108:111], a[220:223], v[176:191]
    buffer_load_dwordx4 v46, s[16:19], s81 offen offset:1024 lds
    v_cvt_pk_bf16_f32 v227, v120, -v121
    v_cvt_pk_bf16_f32 v231, v122, -v123
    s_waitcnt vmcnt(30) lgkmcnt(0)
    v_mfma_f32_32x32x16_bf16 v[128:143], v[96:99], a[224:227], v[128:143]
    ds_read_b64_tr_b16 v[104:105], v32 offset:57344
    ds_read_b64_tr_b16 v[106:107], v32 offset:58368
    s_add_u32 s83, s14, 1024
    buffer_load_dwordx4 a[136:139], v43, s[20:23], s83 offen sc1
    v_cos_f32 v120, v16
    v_sin_f32 v121, v16
    v_cos_f32 v122, v17
    v_mfma_f32_32x32x16_bf16 v[144:159], v[100:103], a[224:227], v[144:159]
    ds_read_b64_tr_b16 v[108:109], v33 offset:57344
    ds_read_b64_tr_b16 v[110:111], v33 offset:58368
    buffer_load_dwordx4 a[140:143], v47, s[20:23], s83 offen sc1
    v_sin_f32 v123, v17
    v_add_f32 v16, v16, v12
    v_add_f32 v17, v17, v13
    v_mfma_f32_32x32x16_bf16 v[160:175], v[96:99], a[228:231], v[160:175]
    s_add_u32 m0, s75, 24576
    s_add_u32 s81, s38, 32768
    buffer_load_dwordx4 v44, s[16:19], s81 offen lds
    v_cvt_pk_bf16_f32 v232, v120, -v121
    v_cvt_pk_bf16_f32 v236, v122, -v123
    v_mfma_f32_32x32x16_bf16 v[176:191], v[100:103], a[228:231], v[176:191]
    buffer_load_dwordx4 v46, s[16:19], s81 offen offset:1024 lds
    v_cos_f32 v120, v16
    v_sin_f32 v121, v16
    s_lshl_b32 s93, s40, 8
    s_add_u32 s93, s93, 16384
    v_lshlrev_b32 v9, 2, v1
    buffer_load_dword v11, v9, s[20:23], s93 offen sc1
    s_waitcnt vmcnt(33) lgkmcnt(0)
    v_mfma_f32_32x32x16_bf16 v[128:143], v[104:107], a[232:235], v[128:143]
    ds_read_b64_tr_b16 v[96:97], v36 offset:0
    ds_read_b64_tr_b16 v[98:99], v36 offset:1024
    s_add_u32 s83, s14, 2048
    buffer_load_dwordx4 a[144:147], v43, s[20:23], s83 offen sc1
    v_cos_f32 v122, v17
    v_sin_f32 v123, v17
    v_add_f32 v16, v16, v12
    v_mfma_f32_32x32x16_bf16 v[144:159], v[108:111], a[232:235], v[144:159]
    ds_read_b64_tr_b16 v[100:101], v37 offset:0
    ds_read_b64_tr_b16 v[102:103], v37 offset:1024
    buffer_load_dwordx4 a[148:151], v47, s[20:23], s83 offen sc1
    v_add_f32 v17, v17, v13
    v_cvt_pk_bf16_f32 v233, v120, -v121
    v_cvt_pk_bf16_f32 v237, v122, -v123
    v_mfma_f32_32x32x16_bf16 v[160:175], v[104:107], a[236:239], v[160:175]
    s_add_u32 m0, s75, 32768
    s_add_u32 s81, s38, 49152
    buffer_load_dwordx4 v44, s[16:19], s81 offen lds
    v_cos_f32 v120, v16
    v_sin_f32 v121, v16
    v_mfma_f32_32x32x16_bf16 v[176:191], v[108:111], a[236:239], v[176:191]
    buffer_load_dwordx4 v46, s[16:19], s81 offen offset:1024 lds
    v_cos_f32 v122, v17
    v_sin_f32 v123, v17
    s_waitcnt vmcnt(33) lgkmcnt(0)
    v_mfma_f32_32x32x16_bf16 v[128:143], v[96:99], a[240:243], v[128:143]
    ds_read_b64_tr_b16 v[104:105], v36 offset:8192
    ds_read_b64_tr_b16 v[106:107], v36 offset:9216
    s_add_u32 s83, s14, 3072
    buffer_load_dwordx4 a[152:155], v43, s[20:23], s83 offen sc1
    v_add_f32 v16, v16, v12
    v_add_f32 v17, v17, v13
    v_cvt_pk_bf16_f32 v234, v120, -v121
    v_mfma_f32_32x32x16_bf16 v[144:159], v[100:103], a[240:243], v[144:159]
    ds_read_b64_tr_b16 v[108:109], v37 offset:8192
    ds_read_b64_tr_b16 v[110:111], v37 offset:9216
    buffer_load_dwordx4 a[156:159], v47, s[20:23], s83 offen sc1
    v_cvt_pk_bf16_f32 v238, v122, -v123
    v_cos_f32 v120, v16
    v_sin_f32 v121, v16
    v_mfma_f32_32x32x16_bf16 v[160:175], v[96:99], a[244:247], v[160:175]
    v_cos_f32 v122, v17
    v_sin_f32 v123, v17
    v_mfma_f32_32x32x16_bf16 v[176:191], v[100:103], a[244:247], v[176:191]
    v_add_f32 v16, v16, v14
    v_add_f32 v17, v17, v15
    s_waitcnt vmcnt(31) lgkmcnt(0)
    v_mfma_f32_32x32x16_bf16 v[128:143], v[104:107], a[248:251], v[128:143]
    ds_read_b64_tr_b16 v[96:97], v2 offset:40960
    ds_read_b64_tr_b16 v[98:99], v2 offset:41984
    v_cvt_pk_bf16_f32 v235, v120, -v121
    v_cvt_pk_bf16_f32 v239, v122, -v123
    v_cos_f32 v120, v16
    v_mfma_f32_32x32x16_bf16 v[144:159], v[108:111], a[248:251], v[144:159]
    ds_read_b64_tr_b16 v[100:101], v3 offset:40960
    ds_read_b64_tr_b16 v[102:103], v3 offset:41984
    v_sin_f32 v121, v16
    v_cos_f32 v122, v17
    v_sin_f32 v123, v17
    v_mfma_f32_32x32x16_bf16 v[160:175], v[104:107], a[252:255], v[160:175]
    v_add_f32 v16, v16, v12
    v_add_f32 v17, v17, v13
    v_mfma_f32_32x32x16_bf16 v[176:191], v[108:111], a[252:255], v[176:191]
    v_cvt_pk_bf16_f32 v240, v120, -v121
    v_cvt_pk_bf16_f32 v244, v122, -v123
    s_waitcnt vmcnt(6)
    v_cmp_ne_u32 vcc, s46, v11
    s_nop 3
    s_cmp_lg_u64 vcc, 0
    s_cbranch_scc1 L_slow_vf
L_back_vf:
    s_waitcnt lgkmcnt(0)
    v_mfma_f32_32x32x16_bf16 v[128:143], v[96:99], a[96:99], v[128:143]
    ds_read_b64_tr_b16 v[104:105], v2 offset:49152
    ds_read_b64_tr_b16 v[106:107], v2 offset:50176
    v_cos_f32 v120, v16
    v_sin_f32 v121, v16
    v_cos_f32 v122, v17
    v_mfma_f32_32x32x16_bf16 v[144:159], v[100:103], a[96:99], v[144:159]
    ds_read_b64_tr_b16 v[108:109], v3 offset:49152
    ds_read_b64_tr_b16 v[110:111], v3 offset:50176
    v_sin_f32 v123, v17
    v_add_f32 v16, v16, v12
    v_add_f32 v17, v17, v13
    v_mfma_f32_32x32x16_bf16 v[160:175], v[96:99], a[100:103], v[160:175]
    v_cvt_pk_bf16_f32 v241, v120, -v121
    v_cvt_pk_bf16_f32 v245, v122, -v123
    v_mfma_f32_32x32x16_bf16 v[176:191], v[100:103], a[100:103], v[176:191]
    v_cos_f32 v120, v16
    v_sin_f32 v121, v16
    s_waitcnt lgkmcnt(0)
    v_mfma_f32_32x32x16_bf16 v[128:143], v[104:107], a[104:107], v[128:143]
    ds_read_b64_tr_b16 v[96:97], v2 offset:57344
    ds_read_b64_tr_b16 v[98:99], v2 offset:58368
    s_add_u32 m0, s75, 65536
    s_add_u32 s76, s74, 0
    buffer_load_dwordx4 v6, s[20:23], s76 offen sc1 lds
    v_cos_f32 v122, v17
    v_sin_f32 v123, v17
    v_add_f32 v16, v16, v12
    v_mfma_f32_32x32x16_bf16 v[144:159], v[108:111], a[104:107], v[144:159]
    ds_read_b64_tr_b16 v[100:101], v3 offset:57344
    ds_read_b64_tr_b16 v[102:103], v3 offset:58368
    buffer_load_dwordx4 v40, s[20:23], s76 offen offset:1024 sc1 lds
    v_add_f32 v17, v17, v13
    v_cvt_pk_bf16_f32 v242, v120, -v121
    v_cvt_pk_bf16_f32 v246, v122, -v123
    v_mfma_f32_32x32x16_bf16 v[160:175], v[104:107], a[108:111], v[160:175]
    s_add_u32 m0, s75, 73728
    s_add_u32 s76, s74, 69632
    buffer_load_dwordx4 v6, s[20:23], s76 offen sc1 lds
    v_cos_f32 v120, v16
    v_sin_f32 v121, v16
    v_mfma_f32_32x32x16_bf16 v[176:191], v[108:111], a[108:111], v[176:191]
    buffer_load_dwordx4 v40, s[20:23], s76 offen offset:1024 sc1 lds
    v_cos_f32 v122, v17
    v_sin_f32 v123, v17
    s_waitcnt lgkmcnt(0)
    v_mfma_f32_32x32x16_bf16 v[128:143], v[96:99], a[112:115], v[128:143]
    ds_read_b64_tr_b16 v[104:105], v2 offset:0
    ds_read_b64_tr_b16 v[106:107], v2 offset:1024
    s_add_u32 m0, s75, 81920
    s_add_u32 s76, s74, 139264
    buffer_load_dwordx4 v6, s[20:23], s76 offen sc1 lds
    v_add_f32 v16, v16, v14
    v_add_f32 v17, v17, v15
    v_cvt_pk_bf16_f32 v243, v120, -v121
    v_mfma_f32_32x32x16_bf16 v[144:159], v[100:103], a[112:115], v[144:159]
    ds_read_b64_tr_b16 v[108:109], v3 offset:0
    ds_read_b64_tr_b16 v[110:111], v3 offset:1024
    buffer_load_dwordx4 v40, s[20:23], s76 offen offset:1024 sc1 lds
    v_cvt_pk_bf16_f32 v247, v122, -v123
    v_cos_f32 v120, v16
    v_sin_f32 v121, v16
    v_mfma_f32_32x32x16_bf16 v[160:175], v[96:99], a[116:119], v[160:175]
    s_add_u32 m0, s75, 90112
    s_add_u32 s76, s74, 208896
    buffer_load_dwordx4 v6, s[20:23], s76 offen sc1 lds
    v_cos_f32 v122, v17
    v_sin_f32 v123, v17
    v_mfma_f32_32x32x16_bf16 v[176:191], v[100:103], a[116:119], v[176:191]
    buffer_load_dwordx4 v40, s[20:23], s76 offen offset:1024 sc1 lds
    v_add_f32 v16, v16, v12
    v_add_f32 v17, v17, v13
    s_waitcnt lgkmcnt(0)
    v_mfma_f32_32x32x16_bf16 v[128:143], v[104:107], a[120:123], v[128:143]
    ds_read_b64_tr_b16 v[96:97], v2 offset:8192
    ds_read_b64_tr_b16 v[98:99], v2 offset:9216
    s_add_u32 m0, s75, 98304
    s_add_u32 s76, s74, 278528
    buffer_load_dwordx4 v6, s[20:23], s76 offen sc1 lds
    v_cvt_pk_bf16_f32 v248, v120, -v121
    v_cvt_pk_bf16_f32 v252, v122, -v123
    v_cos_f32 v120, v16
    v_mfma_f32_32x32x16_bf16 v[144:159], v[108:111], a[120:123], v[144:159]
    ds_read_b64_tr_b16 v[100:101], v3 offset:8192
    ds_read_b64_tr_b16 v[102:103], v3 offset:9216
    buffer_load_dwordx4 v40, s[20:23], s76 offen offset:1024 sc1 lds
    v_sin_f32 v121, v16
    v_cos_f32 v122, v17
    v_sin_f32 v123, v17
    v_mfma_f32_32x32x16_bf16 v[160:175], v[104:107], a[124:127], v[160:175]
    s_add_u32 m0, s75, 106496
    s_add_u32 s76, s74, 348160
    buffer_load_dwordx4 v6, s[20:23], s76 offen sc1 lds
    v_add_f32 v16, v16, v12
    v_add_f32 v17, v17, v13
    v_mfma_f32_32x32x16_bf16 v[176:191], v[108:111], a[124:127], v[176:191]
    buffer_load_dwordx4 v40, s[20:23], s76 offen offset:1024 sc1 lds
    v_cvt_pk_bf16_f32 v249, v120, -v121
    v_cvt_pk_bf16_f32 v253, v122, -v123
    s_waitcnt lgkmcnt(0)
    v_mfma_f32_32x32x16_bf16 v[128:143], v[96:99], a[128:131], v[128:143]
    ds_read_b64_tr_b16 v[104:105], v2 offset:16384
    ds_read_b64_tr_b16 v[106:107], v2 offset:17408
    s_add_u32 m0, s75, 114688
    s_add_u32 s76, s74, 417792
    buffer_load_dwordx4 v6, s[20:23], s76 offen sc1 lds
    v_cos_f32 v120, v16
    v_sin_f32 v121, v16
    v_cos_f32 v122, v17
    v_mfma_f32_32x32x16_bf16 v[144:159], v[100:103], a[128:131], v[144:159]
    ds_read_b64_tr_b16 v[108:109], v3 offset:16384
    ds_read_b64_tr_b16 v[110:111], v3 offset:17408
    buffer_load_dwordx4 v40, s[20:23], s76 offen offset:1024 sc1 lds
    v_sin_f32 v123, v17
    v_add_f32 v16, v16, v12
    v_add_f32 v17, v17, v13
    v_mfma_f32_32x32x16_bf16 v[160:175], v[96:99], a[132:135], v[160:175]
    s_add_u32 m0, s75, 122880
    s_add_u32 s76, s74, 487424
    buffer_load_dwordx4 v6, s[20:23], s76 offen sc1 lds
    v_cvt_pk_bf16_f32 v250, v120, -v121
    v_cvt_pk_bf16_f32 v254, v122, -v123
    v_mfma_f32_32x32x16_bf16 v[176:191], v[100:103], a[132:135], v[176:191]
    buffer_load_dwordx4 v40, s[20:23], s76 offen offset:1024 sc1 lds
    v_cos_f32 v120, v16
    v_sin_f32 v121, v16
    s_waitcnt lgkmcnt(0)
    v_mfma_f32_32x32x16_bf16 v[128:143], v[104:107], a[136:139], v[128:143]
    ds_read_b64_tr_b16 v[96:97], v2 offset:24576
    ds_read_b64_tr_b16 v[98:99], v2 offset:25600
    v_cos_f32 v122, v17
    v_sin_f32 v123, v17
    v_cvt_pk_bf16_f32 v251, v120, -v121
    v_mfma_f32_32x32x16_bf16 v[144:159], v[108:111], a[136:139], v[144:159]
    ds_read_b64_tr_b16 v[100:101], v3 offset:24576
    ds_read_b64_tr_b16 v[102:103], v3 offset:25600
    v_cvt_pk_bf16_f32 v255, v122, -v123
    v_mfma_f32_32x32x16_bf16 v[160:175], v[104:107], a[140:143], v[160:175]
    v_mfma_f32_32x32x16_bf16 v[176:191], v[108:111], a[140:143], v[176:191]
    s_waitcnt vmcnt(18) lgkmcnt(0)
    v_mfma_f32_32x32x16_bf16 v[128:143], v[96:99], a[144:147], v[128:143]
    ds_read_b64_tr_b16 v[104:105], v2 offset:32768
    ds_read_b64_tr_b16 v[106:107], v2 offset:33792
    v_mfma_f32_32x32x16_bf16 v[144:159], v[100:103], a[144:147], v[144:159]
    ds_read_b64_tr_b16 v[108:109], v3 offset:32768
    ds_read_b64_tr_b16 v[110:111], v3 offset:33792
    v_mfma_f32_32x32x16_bf16 v[160:175], v[96:99], a[148:151], v[160:175]
    v_mfma_f32_32x32x16_bf16 v[176:191], v[100:103], a[148:151], v[176:191]
    s_waitcnt vmcnt(12) lgkmcnt(0)
    v_mfma_f32_32x32x16_bf16 v[128:143], v[104:107], a[152:155], v[128:143]
    ds_read_b64_tr_b16 v[96:97], v34 offset:0
    ds_read_b64_tr_b16 v[98:99], v34 offset:512
    v_mfma_f32_32x32x16_bf16 v[144:159], v[108:111], a[152:155], v[144:159]
    ds_read_b64_tr_b16 v[100:101], v34 offset:8192
    ds_read_b64_tr_b16 v[102:103], v34 offset:8704
    v_mfma_f32_32x32x16_bf16 v[160:175], v[104:107], a[156:159], v[160:175]
    v_mfma_f32_32x32x16_bf16 v[176:191], v[108:111], a[156:159], v[176:191]
    s_barrier
    s_mul_i32 s56, s40, 16896
    v_lshl_add_u32 v19, v1, 4, s56
    s_waitcnt vmcnt(8) lgkmcnt(0)
    v_mfma_f32_32x32x16_bf16 v[128:143], v[192:195], v[96:99], v[128:143]
    ds_read_b64_tr_b16 v[104:105], v34 offset:16384
    ds_read_b64_tr_b16 v[106:107], v34 offset:16896
    v_mfma_f32_32x32x16_bf16 v[144:159], v[196:199], v[96:99], v[144:159]
    ds_read_b64_tr_b16 v[108:109], v34 offset:24576
    ds_read_b64_tr_b16 v[110:111], v34 offset:25088
    v_mfma_f32_32x32x16_bf16 v[128:143], v[200:203], v[100:103], v[128:143]
    v_mfma_f32_32x32x16_bf16 v[144:159], v[204:207], v[100:103], v[144:159]
    s_waitcnt vmcnt(4) lgkmcnt(0)
    v_mfma_f32_32x32x16_bf16 v[128:143], v[208:211], v[104:107], v[128:143]
    ds_read_b64_tr_b16 v[96:97], v34 offset:32768
    ds_read_b64_tr_b16 v[98:99], v34 offset:33280
    v_mfma_f32_32x32x16_bf16 v[144:159], v[212:215], v[104:107], v[144:159]
    ds_read_b64_tr_b16 v[100:101], v34 offset:40960
    ds_read_b64_tr_b16 v[102:103], v34 offset:41472
    v_mfma_f32_32x32x16_bf16 v[128:143], v[216:219], v[108:111], v[128:143]
    v_mfma_f32_32x32x16_bf16 v[144:159], v[220:223], v[108:111], v[144:159]
    s_waitcnt vmcnt(0) lgkmcnt(0)
    v_mfma_f32_32x32x16_bf16 v[128:143], v[224:227], v[96:99], v[128:143]
    ds_read_b64_tr_b16 v[104:105], v34 offset:49152
    ds_read_b64_tr_b16 v[106:107], v34 offset:49664
    buffer_load_dwordx4 v[112:115], v8, s[4:7], 0 offen offset:0
    buffer_load_dwordx4 v[116:119], v8, s[4:7], 0 offen offset:2048
    v_mfma_f32_32x32x16_bf16 v[144:159], v[228:231], v[96:99], v[144:159]
    ds_read_b64_tr_b16 v[108:109], v34 offset:57344
    ds_read_b64_tr_b16 v[110:111], v34 offset:57856
    v_mfma_f32_32x32x16_bf16 v[128:143], v[232:235], v[100:103], v[128:143]
    v_mfma_f32_32x32x16_bf16 v[144:159], v[236:239], v[100:103], v[144:159]
    s_waitcnt lgkmcnt(0)
    v_mfma_f32_32x32x16_bf16 v[128:143], v[240:243], v[104:107], v[128:143]
    ds_read_b64_tr_b16 v[96:97], v35 offset:0
    ds_read_b64_tr_b16 v[98:99], v35 offset:512
    v_mfma_f32_32x32x16_bf16 v[144:159], v[244:247], v[104:107], v[144:159]
    ds_read_b64_tr_b16 v[100:101], v35 offset:8192
    ds_read_b64_tr_b16 v[102:103], v35 offset:8704
    v_mfma_f32_32x32x16_bf16 v[128:143], v[248:251], v[108:111], v[128:143]
    v_mfma_f32_32x32x16_bf16 v[144:159], v[252:255], v[108:111], v[144:159]
    s_waitcnt lgkmcnt(0)
    v_mfma_f32_32x32x16_bf16 v[160:175], v[192:195], v[96:99], v[160:175]
    ds_read_b64_tr_b16 v[104:105], v35 offset:16384
    ds_read_b64_tr_b16 v[106:107], v35 offset:16896
    v_mfma_f32_32x32x16_bf16 v[176:191], v[196:199], v[96:99], v[176:191]
    ds_read_b64_tr_b16 v[108:109], v35 offset:24576
    ds_read_b64_tr_b16 v[110:111], v35 offset:25088
    v_mfma_f32_32x32x16_bf16 v[160:175], v[200:203], v[100:103], v[160:175]
    v_mfma_f32_32x32x16_bf16 v[176:191], v[204:207], v[100:103], v[176:191]
    s_waitcnt lgkmcnt(0)
    v_mfma_f32_32x32x16_bf16 v[160:175], v[208:211], v[104:107], v[160:175]
    ds_write_b128 v19, v[128:131] offset:0
    ds_read_b64_tr_b16 v[96:97], v35 offset:32768
    ds_read_b64_tr_b16 v[98:99], v35 offset:33280
    v_mfma_f32_32x32x16_bf16 v[176:191], v[212:215], v[104:107], v[176:191]
    ds_write_b128 v19, v[132:135] offset:1056
    ds_read_b64_tr_b16 v[100:101], v35 offset:40960
    ds_read_b64_tr_b16 v[102:103], v35 offset:41472
    v_mfma_f32_32x32x16_bf16 v[160:175], v[216:219], v[108:111], v[160:175]
    ds_write_b128 v19, v[136:139] offset:2112
    v_mfma_f32_32x32x16_bf16 v[176:191], v[220:223], v[108:111], v[176:191]
    ds_write_b128 v19, v[140:143] offset:3168
    s_waitcnt lgkmcnt(2)
    v_mfma_f32_32x32x16_bf16 v[160:175], v[224:227], v[96:99], v[160:175]
    ds_write_b128 v19, v[144:147] offset:4224
    ds_read_b64_tr_b16 v[104:105], v35 offset:49152
    ds_read_b64_tr_b16 v[106:107], v35 offset:49664
    v_mfma_f32_32x32x16_bf16 v[176:191], v[228:231], v[96:99], v[176:191]
    ds_write_b128 v19, v[148:151] offset:5280
    ds_read_b64_tr_b16 v[108:109], v35 offset:57344
    ds_read_b64_tr_b16 v[110:111], v35 offset:57856
    v_mfma_f32_32x32x16_bf16 v[160:175], v[232:235], v[100:103], v[160:175]
    ds_write_b128 v19, v[152:155] offset:6336
    v_mfma_f32_32x32x16_bf16 v[176:191], v[236:239], v[100:103], v[176:191]
    ds_write_b128 v19, v[156:159] offset:7392
    s_waitcnt lgkmcnt(2)
    v_mfma_f32_32x32x16_bf16 v[160:175], v[240:243], v[104:107], v[160:175]
    v_mfma_f32_32x32x16_bf16 v[176:191], v[244:247], v[104:107], v[176:191]
    v_mfma_f32_32x32x16_bf16 v[160:175], v[248:251], v[108:111], v[160:175]
    v_mfma_f32_32x32x16_bf16 v[176:191], v[252:255], v[108:111], v[176:191]
    s_barrier
    s_nop 10
    ds_write_b128 v19, v[160:163] offset:8448
    ds_write_b128 v19, v[164:167] offset:9504
    ds_write_b128 v19, v[168:171] offset:10560
    ds_write_b128 v19, v[172:175] offset:11616
    ds_write_b128 v19, v[176:179] offset:12672
    ds_write_b128 v19, v[180:183] offset:13728
    ds_write_b128 v19, v[184:187] offset:14784
    ds_write_b128 v19, v[188:191] offset:15840
    s_waitcnt lgkmcnt(0)
    s_barrier
    ds_read_b128 v[128:131], v7 offset:0
    ds_read_b128 v[132:135], v7 offset:512
    ds_read_b128 v[136:139], v7 offset:16896
    ds_read_b128 v[140:143], v7 offset:17408
    ds_read_b128 v[144:147], v7 offset:33792
    ds_read_b128 v[148:151], v7 offset:34304
    ds_read_b128 v[152:155], v7 offset:50688
    ds_read_b128 v[156:159], v7 offset:51200
    ds_read_b128 v[160:163], v7 offset:128
    ds_read_b128 v[164:167], v7 offset:640
    ds_read_b128 v[168:171], v7 offset:17024
    ds_read_b128 v[172:175], v7 offset:17536
    ds_read_b128 v[176:179], v7 offset:33920
    ds_read_b128 v[180:183], v7 offset:34432
    ds_read_b128 v[184:187], v7 offset:50816
    ds_read_b128 v[188:191], v7 offset:51328
    s_waitcnt vmcnt(0)
    v_lshlrev_b32 v96, 16, v112
    v_and_b32 v97, 0xffff0000, v112
    v_lshlrev_b32 v98, 16, v113
    v_and_b32 v99, 0xffff0000, v113
    v_lshlrev_b32 v100, 16, v114
    v_and_b32 v101, 0xffff0000, v114
    v_lshlrev_b32 v102, 16, v115
    v_and_b32 v103, 0xffff0000, v115
    v_lshlrev_b32 v104, 16, v116
    v_and_b32 v105, 0xffff0000, v116
    v_lshlrev_b32 v106, 16, v117
    v_and_b32 v107, 0xffff0000, v117
    v_lshlrev_b32 v108, 16, v118
    v_and_b32 v109, 0xffff0000, v118
    v_lshlrev_b32 v110, 16, v119
    v_and_b32 v111, 0xffff0000, v119
    s_waitcnt lgkmcnt(12)
    v_pk_add_f32 v[128:129], v[128:129], v[136:137]
    v_pk_add_f32 v[130:131], v[130:131], v[138:139]
    v_pk_add_f32 v[132:133], v[132:133], v[140:141]
    v_pk_add_f32 v[134:135], v[134:135], v[142:143]
    s_waitcnt lgkmcnt(10)
    v_pk_add_f32 v[128:129], v[128:129], v[144:145]
    v_pk_add_f32 v[130:131], v[130:131], v[146:147]
    v_pk_add_f32 v[132:133], v[132:133], v[148:149]
    v_pk_add_f32 v[134:135], v[134:135], v[150:151]
    s_waitcnt lgkmcnt(8)
    v_pk_add_f32 v[128:129], v[128:129], v[152:153]
    v_pk_add_f32 v[130:131], v[130:131], v[154:155]
    v_pk_add_f32 v[132:133], v[132:133], v[156:157]
    v_pk_add_f32 v[134:135], v[134:135], v[158:159]
    v_pk_add_f32 v[128:129], v[128:129], v[96:97]
    v_pk_add_f32 v[130:131], v[130:131], v[98:99]
    v_pk_add_f32 v[132:133], v[132:133], v[100:101]
    v_pk_add_f32 v[134:135], v[134:135], v[102:103]
    v_cvt_pk_bf16_f32 v112, v128, v129
    v_cvt_pk_bf16_f32 v113, v130, v131
    v_cvt_pk_bf16_f32 v114, v132, v133
    v_cvt_pk_bf16_f32 v115, v134, v135
    buffer_store_dwordx4 v[112:115], v8, s[24:27], 0 offen offset:0
    s_waitcnt lgkmcnt(4)
    v_pk_add_f32 v[160:161], v[160:161], v[168:169]
    v_pk_add_f32 v[162:163], v[162:163], v[170:171]
    v_pk_add_f32 v[164:165], v[164:165], v[172:173]
    v_pk_add_f32 v[166:167], v[166:167], v[174:175]
    s_waitcnt lgkmcnt(2)
    v_pk_add_f32 v[160:161], v[160:161], v[176:177]
    v_pk_add_f32 v[162:163], v[162:163], v[178:179]
    v_pk_add_f32 v[164:165], v[164:165], v[180:181]
    v_pk_add_f32 v[166:167], v[166:167], v[182:183]
    s_waitcnt lgkmcnt(0)
    v_pk_add_f32 v[160:161], v[160:161], v[184:185]
    v_pk_add_f32 v[162:163], v[162:163], v[186:187]
    v_pk_add_f32 v[164:165], v[164:165], v[188:189]
    v_pk_add_f32 v[166:167], v[166:167], v[190:191]
    v_pk_add_f32 v[160:161], v[160:161], v[104:105]
    v_pk_add_f32 v[162:163], v[162:163], v[106:107]
    v_pk_add_f32 v[164:165], v[164:165], v[108:109]
    v_pk_add_f32 v[166:167], v[166:167], v[110:111]
    v_cvt_pk_bf16_f32 v116, v160, v161
    v_cvt_pk_bf16_f32 v117, v162, v163
    v_cvt_pk_bf16_f32 v118, v164, v165
    v_cvt_pk_bf16_f32 v119, v166, v167
    buffer_store_dwordx4 v[116:119], v8, s[24:27], 0 offen offset:2048
    s_cmp_lg_u32 s2, 0
    s_cbranch_scc1 L_noep
    s_cmp_lg_u32 s40, 0
    s_cbranch_scc1 L_fl_e
    s_mov_b32 s96, 0
    v_mov_b32 v45, s46
    buffer_store_dword v45, v22, s[20:23], s96 offen sc1
L_fl_e:
L_noep:
L_end:
    s_endpgm
L_slow_stA:
    s_sub_u32 s100, s100, 1
    s_cbranch_scc1 L_tmo_stA
    s_sleep 2
    v_and_b32 v76, 31, v1
    v_and_b32 v77, 3, v76
    v_lshlrev_b32 v78, 8, v77
    v_lshrrev_b32 v77, 3, v76
    v_lshl_add_u32 v78, v77, 4, v78
    v_bfe_u32 v77, v76, 2, 1
    v_lshl_add_u32 v78, v77, 3, v78
    s_lshl_b32 s94, s41, 7
    v_add_u32 v78, s94, v78
    v_add_u32 v79, 64, v78
    s_lshl_b32 s94, s43, 10
    s_add_u32 s94, s94, 65536
    buffer_load_dwordx2 v[64:65], v78, s[20:23], s94 offen sc1
    buffer_load_dwordx2 v[66:67], v79, s[20:23], s94 offen sc1
    s_waitcnt vmcnt(0)
    v_cmp_ne_u32 vcc, s46, v65
    v_cmp_ne_u32 s[62:63], s46, v67
    s_nop 3
    s_or_b64 vcc, vcc, s[62:63]
    s_cmp_lg_u64 vcc, 0
    s_cbranch_scc1 L_slow_stA
    s_branch L_back_stA
L_tmo_stA:
    s_mov_b32 s100, 0
    v_mov_b32 v65, 1
    v_mov_b32 v42, 4
    buffer_store_dword v65, v42, s[68:71], 0 offen
    s_branch L_back_stA
L_slow_csA0:
    s_sub_u32 s100, s100, 1
    s_cbranch_scc1 L_tmo_csA0
    s_sleep 2
    v_and_b32 v76, 31, v1
    v_lshlrev_b32 v76, 3, v76
    v_lshrrev_b32 v77, 5, v1
    v_lshl_add_u32 v76, v77, 10, v76
    s_lshl_b32 s93, s44, 3
    s_lshl_b32 s94, s42, 1
    s_add_u32 s93, s93, s94
    s_add_u32 s93, s93, s41
    s_add_u32 s93, s93, 0
    s_lshl_b32 s93, s93, 11
    s_add_u32 s93, s93, 131072
    buffer_load_dwordx2 v[68:69], v76, s[20:23], s93 offen offset:0 sc1
    buffer_load_dwordx2 v[70:71], v76, s[20:23], s93 offen offset:256 sc1
    buffer_load_dwordx2 v[72:73], v76, s[20:23], s93 offen offset:512 sc1
    buffer_load_dwordx2 v[74:75], v76, s[20:23], s93 offen offset:768 sc1
    s_waitcnt vmcnt(0)
    v_cmp_ne_u32 vcc, s46, v69
    v_cmp_ne_u32 s[62:63], s46, v71
    s_nop 3
    s_or_b64 vcc, vcc, s[62:63]
    v_cmp_ne_u32 s[62:63], s46, v73
    s_nop 3
    s_or_b64 vcc, vcc, s[62:63]
    v_cmp_ne_u32 s[62:63], s46, v75
    s_nop 3
    s_or_b64 vcc, vcc, s[62:63]
    s_cmp_lg_u64 vcc, 0
    s_cbranch_scc1 L_slow_csA0
    s_branch L_back_csA0
L_tmo_csA0:
    s_mov_b32 s100, 0
    v_mov_b32 v69, 2
    v_mov_b32 v42, 8
    buffer_store_dword v69, v42, s[68:71], 0 offen
    s_branch L_back_csA0
L_slow_csA1:
    s_sub_u32 s100, s100, 1
    s_cbranch_scc1 L_tmo_csA1
    s_sleep 2
    v_and_b32 v76, 31, v1
    v_lshlrev_b32 v76, 3, v76
    v_lshrrev_b32 v77, 5, v1
    v_lshl_add_u32 v76, v77, 10, v76
    s_lshl_b32 s93, s44, 3
    s_lshl_b32 s94, s42, 1
    s_add_u32 s93, s93, s94
    s_add_u32 s93, s93, s41
    s_add_u32 s93, s93, 4
    s_lshl_b32 s93, s93, 11
    s_add_u32 s93, s93, 131072
    buffer_load_dwordx2 v[80:81], v76, s[20:23], s93 offen offset:0 sc1
    buffer_load_dwordx2 v[82:83], v76, s[20:23], s93 offen offset:256 sc1
    buffer_load_dwordx2 v[84:85], v76, s[20:23], s93 offen offset:512 sc1
    buffer_load_dwordx2 v[86:87], v76, s[20:23], s93 offen offset:768 sc1
    s_waitcnt vmcnt(0)
    v_cmp_ne_u32 vcc, s46, v81
    v_cmp_ne_u32 s[62:63], s46, v83
    s_nop 3
    s_or_b64 vcc, vcc, s[62:63]
    v_cmp_ne_u32 s[62:63], s46, v85
    s_nop 3
    s_or_b64 vcc, vcc, s[62:63]
    v_cmp_ne_u32 s[62:63], s46, v87
    s_nop 3
    s_or_b64 vcc, vcc, s[62:63]
    s_cmp_lg_u64 vcc, 0
    s_cbranch_scc1 L_slow_csA1
    s_branch L_back_csA1
L_tmo_csA1:
    s_mov_b32 s100, 0
    v_mov_b32 v81, 3
    v_mov_b32 v42, 12
    buffer_store_dword v81, v42, s[68:71], 0 offen
    s_branch L_back_csA1
L_slow_stB:
    s_sub_u32 s100, s100, 1
    s_cbranch_scc1 L_tmo_stB
    s_sleep 2
    v_and_b32 v76, 31, v1
    v_and_b32 v77, 3, v76
    v_lshlrev_b32 v78, 8, v77
    v_lshrrev_b32 v77, 3, v76
    v_lshl_add_u32 v78, v77, 4, v78
    v_bfe_u32 v77, v76, 2, 1
    v_lshl_add_u32 v78, v77, 3, v78
    s_lshl_b32 s94, s41, 7
    v_add_u32 v78, s94, v78
    v_add_u32 v79, 64, v78
    s_lshl_b32 s94, s43, 10
    s_add_u32 s94, s94, 65536
    buffer_load_dwordx2 v[64:65], v78, s[20:23], s94 offen sc1
    buffer_load_dwordx2 v[66:67], v79, s[20:23], s94 offen sc1
    s_waitcnt vmcnt(0)
    v_cmp_ne_u32 vcc, s46, v65
    v_cmp_ne_u32 s[62:63], s46, v67
    s_nop 3
    s_or_b64 vcc, vcc, s[62:63]
    s_cmp_lg_u64 vcc, 0
    s_cbranch_scc1 L_slow_stB
    s_branch L_back_stB
L_tmo_stB:
    s_mov_b32 s100, 0
    v_mov_b32 v65, 4
    v_mov_b32 v42, 16
    buffer_store_dword v65, v42, s[68:71], 0 offen
    s_branch L_back_stB
L_slow_csB1:
    s_sub_u32 s100, s100, 1
    s_cbranch_scc1 L_tmo_csB1
    s_sleep 2
    v_and_b32 v76, 31, v1
    v_lshlrev_b32 v76, 3, v76
    v_lshrrev_b32 v77, 5, v1
    v_lshl_add_u32 v76, v77, 10, v76
    s_lshl_b32 s93, s44, 3
    s_lshl_b32 s94, s42, 1
    s_add_u32 s93, s93, s94
    s_add_u32 s93, s93, s41
    s_add_u32 s93, s93, 4
    s_lshl_b32 s93, s93, 11
    s_add_u32 s93, s93, 131072
    buffer_load_dwordx2 v[68:69], v76, s[20:23], s93 offen offset:0 sc1
    buffer_load_dwordx2 v[70:71], v76, s[20:23], s93 offen offset:256 sc1
    buffer_load_dwordx2 v[72:73], v76, s[20:23], s93 offen offset:512 sc1
    buffer_load_dwordx2 v[74:75], v76, s[20:23], s93 offen offset:768 sc1
    s_waitcnt vmcnt(0)
    v_cmp_ne_u32 vcc, s46, v69
    v_cmp_ne_u32 s[62:63], s46, v71
    s_nop 3
    s_or_b64 vcc, vcc, s[62:63]
    v_cmp_ne_u32 s[62:63], s46, v73
    s_nop 3
    s_or_b64 vcc, vcc, s[62:63]
    v_cmp_ne_u32 s[62:63], s46, v75
    s_nop 3
    s_or_b64 vcc, vcc, s[62:63]
    s_cmp_lg_u64 vcc, 0
    s_cbranch_scc1 L_slow_csB1
    s_branch L_back_csB1
L_tmo_csB1:
    s_mov_b32 s100, 0
    v_mov_b32 v69, 5
    v_mov_b32 v42, 20
    buffer_store_dword v69, v42, s[68:71], 0 offen
    s_branch L_back_csB1
L_slow_p2a:
    s_sub_u32 s100, s100, 1
    s_cbranch_scc1 L_tmo_p2a
    s_sleep 2
    s_lshr_b32 s93, s2, 6
    s_lshl_b32 s94, s93, 7
    s_add_u32 s94, s94, 8192
    s_lshl_b32 s93, s93, 8
    s_add_u32 s93, s93, 12288
    v_lshlrev_b32 v30, 2, v1
    v_and_b32 v31, 60, v30
    buffer_load_dword v28, v31, s[20:23], s94 offen sc1
    buffer_load_dword v29, v30, s[20:23], s93 offen sc1
    s_waitcnt vmcnt(0)
    v_cmp_ne_u32 vcc, s46, v28
    v_cmp_ne_u32 s[62:63], s46, v29
    s_nop 3
    s_or_b64 vcc, vcc, s[62:63]
    s_cmp_lg_u64 vcc, 0
    s_cbranch_scc1 L_slow_p2a
    s_branch L_back_p2a
L_tmo_p2a:
    s_mov_b32 s100, 0
    v_mov_b32 v28, 6
    v_mov_b32 v42, 24
    buffer_store_dword v28, v42, s[68:71], 0 offen
    s_branch L_back_p2a
L_slow_hf0:
    s_sub_u32 s100, s100, 1
    s_cbranch_scc1 L_tmo_hf0
    s_sleep 2
    s_lshl_b32 s93, s84, 7
    s_add_u32 s93, s93, 4096
    v_lshlrev_b32 v9, 2, v1
    v_min_u32 v9, 44, v9
    buffer_load_dword v41, v9, s[20:23], s93 offen sc1
    s_waitcnt vmcnt(0)
    v_cmp_ne_u32 vcc, s46, v41
    s_nop 3
    s_cmp_lg_u64 vcc, 0
    s_cbranch_scc1 L_slow_hf0
    s_branch L_back_hf0
L_tmo_hf0:
    s_mov_b32 s100, 0
    v_mov_b32 v41, 7
    v_mov_b32 v42, 28
    buffer_store_dword v41, v42, s[68:71], 0 offen
    s_branch L_back_hf0
L_slow_hf1:
    s_sub_u32 s100, s100, 1
    s_cbranch_scc1 L_tmo_hf1
    s_sleep 2
    s_lshl_b32 s93, s84, 7
    s_add_u32 s93, s93, 4160
    v_lshlrev_b32 v9, 2, v1
    v_min_u32 v9, 60, v9
    buffer_load_dword v41, v9, s[20:23], s93 offen sc1
    s_waitcnt vmcnt(0)
    v_cmp_ne_u32 vcc, s46, v41
    s_nop 3
    s_cmp_lg_u64 vcc, 0
    s_cbranch_scc1 L_slow_hf1
    s_branch L_back_hf1
L_tmo_hf1:
    s_mov_b32 s100, 0
    v_mov_b32 v41, 8
    v_mov_b32 v42, 32
    buffer_store_dword v41, v42, s[68:71], 0 offen
    s_branch L_back_hf1
L_slow_vf:
    s_sub_u32 s100, s100, 1
    s_cbranch_scc1 L_tmo_vf
    s_sleep 2
    s_lshl_b32 s93, s40, 8
    s_add_u32 s93, s93, 16384
    v_lshlrev_b32 v9, 2, v1
    buffer_load_dword v11, v9, s[20:23], s93 offen sc1
    s_waitcnt vmcnt(0)
    v_cmp_ne_u32 vcc, s46, v11
    s_nop 3
    s_cmp_lg_u64 vcc, 0
    s_cbranch_scc1 L_slow_vf
    s_branch L_back_vf
L_tmo_vf:
    s_mov_b32 s100, 0
    v_mov_b32 v11, 9
    v_mov_b32 v42, 36
    buffer_store_dword v11, v42, s[68:71], 0 offen
    s_branch L_back_vf
L_codeend:
    s_endpgm
.section .rodata,"a"
.p2align 6
.amdhsa_kernel parallel_sum__spectral_gfnet__glu_gated_swiglu__prompt_kernel
  .amdhsa_next_free_vgpr 512
  .amdhsa_next_free_sgpr 102
  .amdhsa_accum_offset 256
  .amdhsa_group_segment_fixed_size 0
  .amdhsa_kernarg_size 80
  .amdhsa_user_sgpr_count 2
  .amdhsa_user_sgpr_kernarg_segment_ptr 1
  .amdhsa_system_sgpr_workgroup_id_x 1
  .amdhsa_float_denorm_mode_32 3
.end_amdhsa_kernel
.text
.section .rodata,"a"
.p2align 8
.set QC0, 16256
.set QC1, 16256
.set QC2, 16256
.set QC3, 16256
.set QC4, 16256
.set QC5, 16256
.set QC6, 16255
.set QC7, 16255
.set QC8, 16255
.set QC9, 16254
.set QC10, 16254
.set QC11, 16254
.set QC12, 16253
.set QC13, 16253
.set QC14, 16252
.set QC15, 16252
.set QC16, 16251
.set QC17, 16250
.set QC18, 16250
.set QC19, 16249
.set QC20, 16248
.set QC21, 16248
.set QC22, 16247
.set QC23, 16246
.set QC24, 16245
.set QC25, 16244
.set QC26, 16243
.set QC27, 16242
.set QC28, 16241
.set QC29, 16240
.set QC30, 16239
.set QC31, 16238
.set QC32, 16237
.set QC33, 16235
.set QC34, 16234
.set QC35, 16233
.set QC36, 16231
.set QC37, 16230
.set QC38, 16229
.set QC39, 16227
.set QC40, 16226
.set QC41, 16224
.set QC42, 16223
.set QC43, 16221
.set QC44, 16220
.set QC45, 16218
.set QC46, 16216
.set QC47, 16215
.set QC48, 16213
.set QC49, 16211
.set QC50, 16209
.set QC51, 16207
.set QC52, 16206
.set QC53, 16204
.set QC54, 16202
.set QC55, 16200
.set QC56, 16198
.set QC57, 16196
.set QC58, 16194
.set QC59, 16192
.set QC60, 16190
.set QC61, 16188
.set QC62, 16185
.set QC63, 16183
.set QC64, 16181
.set QC65, 16179
.set QC66, 16177
.set QC67, 16174
.set QC68, 16172
.set QC69, 16170
.set QC70, 16167
.set QC71, 16165
.set QC72, 16162
.set QC73, 16160
.set QC74, 16157
.set QC75, 16155
.set QC76, 16152
.set QC77, 16150
.set QC78, 16147
.set QC79, 16145
.set QC80, 16142
.set QC81, 16140
.set QC82, 16137
.set QC83, 16134
.set QC84, 16132
.set QC85, 16129
.set QC86, 16124
.set QC87, 16119
.set QC88, 16113
.set QC89, 16108
.set QC90, 16102
.set QC91, 16097
.set QC92, 16091
.set QC93, 16085
.set QC94, 16079
.set QC95, 16074
.set QC96, 16068
.set QC97, 16062
.set QC98, 16056
.set QC99, 16050
.set QC100, 16044
.set QC101, 16039
.set QC102, 16033
.set QC103, 16027
.set QC104, 16021
.set QC105, 16015
.set QC106, 16009
.set QC107, 16002
.set QC108, 15993
.set QC109, 15981
.set QC110, 15968
.set QC111, 15956
.set QC112, 15944
.set QC113, 15931
.set QC114, 15919
.set QC115, 15907
.set QC116, 15894
.set QC117, 15882
.set QC118, 15867
.set QC119, 15842
.set QC120, 15817
.set QC121, 15792
.set QC122, 15767
.set QC123, 15739
.set QC124, 15689
.set QC125, 15639
.set QC126, 15561
.set QC127, 15433
.set QC128, 0
.set QC129, 48201
.set QC130, 48329
.set QC131, 48407
.set QC132, 48457
.set QC133, 48507
.set QC134, 48535
.set QC135, 48560
.set QC136, 48585
.set QC137, 48610
.set QC138, 48635
.set QC139, 48650
.set QC140, 48662
.set QC141, 48675
.set QC142, 48687
.set QC143, 48699
.set QC144, 48712
.set QC145, 48724
.set QC146, 48736
.set QC147, 48749
.set QC148, 48761
.set QC149, 48770
.set QC150, 48777
.set QC151, 48783
.set QC152, 48789
.set QC153, 48795
.set QC154, 48801
.set QC155, 48807
.set QC156, 48812
.set QC157, 48818
.set QC158, 48824
.set QC159, 48830
.set QC160, 48836
.set QC161, 48842
.set QC162, 48847
.set QC163, 48853
.set QC164, 48859
.set QC165, 48865
.set QC166, 48870
.set QC167, 48876
.set QC168, 48881
.set QC169, 48887
.set QC170, 48892
.set QC171, 48897
.set QC172, 48900
.set QC173, 48902
.set QC174, 48905
.set QC175, 48908
.set QC176, 48910
.set QC177, 48913
.set QC178, 48915
.set QC179, 48918
.set QC180, 48920
.set QC181, 48923
.set QC182, 48925
.set QC183, 48928
.set QC184, 48930
.set QC185, 48933
.set QC186, 48935
.set QC187, 48938
.set QC188, 48940
.set QC189, 48942
.set QC190, 48945
.set QC191, 48947
.set QC192, 48949
.set QC193, 48951
.set QC194, 48953
.set QC195, 48956
.set QC196, 48958
.set QC197, 48960
.set QC198, 48962
.set QC199, 48964
.set QC200, 48966
.set QC201, 48968
.set QC202, 48970
.set QC203, 48972
.set QC204, 48974
.set QC205, 48975
.set QC206, 48977
.set QC207, 48979
.set QC208, 48981
.set QC209, 48983
.set QC210, 48984
.set QC211, 48986
.set QC212, 48988
.set QC213, 48989
.set QC214, 48991
.set QC215, 48992
.set QC216, 48994
.set QC217, 48995
.set QC218, 48997
.set QC219, 48998
.set QC220, 48999
.set QC221, 49001
.set QC222, 49002
.set QC223, 49003
.set QC224, 49005
.set QC225, 49006
.set QC226, 49007
.set QC227, 49008
.set QC228, 49009
.set QC229, 49010
.set QC230, 49011
.set QC231, 49012
.set QC232, 49013
.set QC233, 49014
.set QC234, 49015
.set QC235, 49016
.set QC236, 49016
.set QC237, 49017
.set QC238, 49018
.set QC239, 49018
.set QC240, 49019
.set QC241, 49020
.set QC242, 49020
.set QC243, 49021
.set QC244, 49021
.set QC245, 49022
.set QC246, 49022
.set QC247, 49022
.set QC248, 49023
.set QC249, 49023
.set QC250, 49023
.set QC251, 49024
.set QC252, 49024
.set QC253, 49024
.set QC254, 49024
.set QC255, 49024
.set QC256, 49024
.set QC257, 49024
.set QC258, 49024
.set QC259, 49024
.set QC260, 49024
.set QC261, 49024
.set QC262, 49023
.set QC263, 49023
.set QC264, 49023
.set QC265, 49022
.set QC266, 49022
.set QC267, 49022
.set QC268, 49021
.set QC269, 49021
.set QC270, 49020
.set QC271, 49020
.set QC272, 49019
.set QC273, 49018
.set QC274, 49018
.set QC275, 49017
.set QC276, 49016
.set QC277, 49016
.set QC278, 49015
.set QC279, 49014
.set QC280, 49013
.set QC281, 49012
.set QC282, 49011
.set QC283, 49010
.set QC284, 49009
.set QC285, 49008
.set QC286, 49007
.set QC287, 49006
.set QC288, 49005
.set QC289, 49003
.set QC290, 49002
.set QC291, 49001
.set QC292, 48999
.set QC293, 48998
.set QC294, 48997
.set QC295, 48995
.set QC296, 48994
.set QC297, 48992
.set QC298, 48991
.set QC299, 48989
.set QC300, 48988
.set QC301, 48986
.set QC302, 48984
.set QC303, 48983
.set QC304, 48981
.set QC305, 48979
.set QC306, 48977
.set QC307, 48975
.set QC308, 48974
.set QC309, 48972
.set QC310, 48970
.set QC311, 48968
.set QC312, 48966
.set QC313, 48964
.set QC314, 48962
.set QC315, 48960
.set QC316, 48958
.set QC317, 48956
.set QC318, 48953
.set QC319, 48951
.set QC320, 48949
.set QC321, 48947
.set QC322, 48945
.set QC323, 48942
.set QC324, 48940
.set QC325, 48938
.set QC326, 48935
.set QC327, 48933
.set QC328, 48930
.set QC329, 48928
.set QC330, 48925
.set QC331, 48923
.set QC332, 48920
.set QC333, 48918
.set QC334, 48915
.set QC335, 48913
.set QC336, 48910
.set QC337, 48908
.set QC338, 48905
.set QC339, 48902
.set QC340, 48900
.set QC341, 48897
.set QC342, 48892
.set QC343, 48887
.set QC344, 48881
.set QC345, 48876
.set QC346, 48870
.set QC347, 48865
.set QC348, 48859
.set QC349, 48853
.set QC350, 48847
.set QC351, 48842
.set QC352, 48836
.set QC353, 48830
.set QC354, 48824
.set QC355, 48818
.set QC356, 48812
.set QC357, 48807
.set QC358, 48801
.set QC359, 48795
.set QC360, 48789
.set QC361, 48783
.set QC362, 48777
.set QC363, 48770
.set QC364, 48761
.set QC365, 48749
.set QC366, 48736
.set QC367, 48724
.set QC368, 48712
.set QC369, 48699
.set QC370, 48687
.set QC371, 48675
.set QC372, 48662
.set QC373, 48650
.set QC374, 48635
.set QC375, 48610
.set QC376, 48585
.set QC377, 48560
.set QC378, 48535
.set QC379, 48507
.set QC380, 48457
.set QC381, 48407
.set QC382, 48329
.set QC383, 48201
.set QC384, 0
.set QC385, 15433
.set QC386, 15561
.set QC387, 15639
.set QC388, 15689
.set QC389, 15739
.set QC390, 15767
.set QC391, 15792
.set QC392, 15817
.set QC393, 15842
.set QC394, 15867
.set QC395, 15882
.set QC396, 15894
.set QC397, 15907
.set QC398, 15919
.set QC399, 15931
.set QC400, 15944
.set QC401, 15956
.set QC402, 15968
.set QC403, 15981
.set QC404, 15993
.set QC405, 16002
.set QC406, 16009
.set QC407, 16015
.set QC408, 16021
.set QC409, 16027
.set QC410, 16033
.set QC411, 16039
.set QC412, 16044
.set QC413, 16050
.set QC414, 16056
.set QC415, 16062
.set QC416, 16068
.set QC417, 16074
.set QC418, 16079
.set QC419, 16085
.set QC420, 16091
.set QC421, 16097
.set QC422, 16102
.set QC423, 16108
.set QC424, 16113
.set QC425, 16119
.set QC426, 16124
.set QC427, 16129
.set QC428, 16132
.set QC429, 16134
.set QC430, 16137
.set QC431, 16140
.set QC432, 16142
.set QC433, 16145
.set QC434, 16147
.set QC435, 16150
.set QC436, 16152
.set QC437, 16155
.set QC438, 16157
.set QC439, 16160
.set QC440, 16162
.set QC441, 16165
.set QC442, 16167
.set QC443, 16170
.set QC444, 16172
.set QC445, 16174
.set QC446, 16177
.set QC447, 16179
.set QC448, 16181
.set QC449, 16183
.set QC450, 16185
.set QC451, 16188
.set QC452, 16190
.set QC453, 16192
.set QC454, 16194
.set QC455, 16196
.set QC456, 16198
.set QC457, 16200
.set QC458, 16202
.set QC459, 16204
.set QC460, 16206
.set QC461, 16207
.set QC462, 16209
.set QC463, 16211
.set QC464, 16213
.set QC465, 16215
.set QC466, 16216
.set QC467, 16218
.set QC468, 16220
.set QC469, 16221
.set QC470, 16223
.set QC471, 16224
.set QC472, 16226
.set QC473, 16227
.set QC474, 16229
.set QC475, 16230
.set QC476, 16231
.set QC477, 16233
.set QC478, 16234
.set QC479, 16235
.set QC480, 16237
.set QC481, 16238
.set QC482, 16239
.set QC483, 16240
.set QC484, 16241
.set QC485, 16242
.set QC486, 16243
.set QC487, 16244
.set QC488, 16245
.set QC489, 16246
.set QC490, 16247
.set QC491, 16248
.set QC492, 16248
.set QC493, 16249
.set QC494, 16250
.set QC495, 16250
.set QC496, 16251
.set QC497, 16252
.set QC498, 16252
.set QC499, 16253
.set QC500, 16253
.set QC501, 16254
.set QC502, 16254
.set QC503, 16254
.set QC504, 16255
.set QC505, 16255
.set QC506, 16255
.set QC507, 16256
.set QC508, 16256
.set QC509, 16256
.set QC510, 16256
.set QC511, 16256

.altmacro
.macro PC2 a, b
 .long QC\a | (QC\b << 16)
.endm
.macro PG2 a, b, ny
 .long (QG\a - ny*128) | (QG\b << 16)
.endm
.macro FLANE c, d0, o
 PC2 %((c*(d0)+o)&511), %((c*(d0+1)+o)&511)
 PC2 %((c*(d0+2)+o)&511), %((c*(d0+3)+o)&511)
 PC2 %((c*(d0+4)+o)&511), %((c*(d0+5)+o)&511)
 PC2 %((c*(d0+6)+o)&511), %((c*(d0+7)+o)&511)
.endm
.macro GLANE d, c0
 PG2 %((d*(c0))&511), %((d*(c0)+128)&511), 0
 PG2 %((d*(c0+1))&511), %((d*(c0+1)+128)&511), 0
 PG2 %((d*(c0+2))&511), %((d*(c0+2)+128)&511), 0
 PG2 %((d*(c0+3))&511), %((d*(c0+3)+128)&511), 0
.endm
.macro E4 m, i0, i1, i2, i3, o
 PC2 %((m*(i0)+o)&511), %((m*(i1)+o)&511)
 PC2 %((m*(i2)+o)&511), %((m*(i3)+o)&511)
.endm
.type TABS,@object
TABS:
.set tg_, 0
.rept 4
 .set ts_, 0
 .rept 32
  .set tt_, 0
  .rept 4
   .set tl_, 0
   .rept 64
    FLANE %(64*tg_+16*tt_+(tl_&15)+1), %(16*ts_+8*(tl_>>5)), %(128*((tl_>>4)&1))
    .set tl_, tl_+1
   .endr
   .set tt_, tt_+1
  .endr
  .set ts_, ts_+1
 .endr
 .set tg_, tg_+1
.endr

.set tg_, 0
.rept 4
 .set ts_, 0
 .rept 4
  .set tl_, 0
  .rept 64
   E4 %(8*(16*tg_+(tl_&15))), %(16*ts_+4*(tl_>>4)), %(16*ts_+4*(tl_>>4)+1), %(16*ts_+4*(tl_>>4)+2), %(16*ts_+4*(tl_>>4)+3), 0
   E4 %(8*(16*tg_+(tl_&15))), %(16*ts_+4*(tl_>>4)), %(16*ts_+4*(tl_>>4)+1), %(16*ts_+4*(tl_>>4)+2), %(16*ts_+4*(tl_>>4)+3), 384
   .set tl_, tl_+1
  .endr
  .set tl_, 0
  .rept 64
   E4 %(8*(16*tg_+(tl_&15))), %(16*ts_+4*(tl_>>4)), %(16*ts_+4*(tl_>>4)+1), %(16*ts_+4*(tl_>>4)+2), %(16*ts_+4*(tl_>>4)+3), 128
   E4 %(8*(16*tg_+(tl_&15))), %(16*ts_+4*(tl_>>4)), %(16*ts_+4*(tl_>>4)+1), %(16*ts_+4*(tl_>>4)+2), %(16*ts_+4*(tl_>>4)+3), 0
   .set tl_, tl_+1
  .endr
  .set ts_, ts_+1
 .endr
 .set tg_, tg_+1
.endr
.set tg_, 0
.rept 2
 .set ts_, 0
 .rept 3
  .set tl_, 0
  .rept 64
   E4 %(16*(16*tg_+(tl_&15))), %(4*(tl_>>4)), %(4*(tl_>>4)+1), %(4*(tl_>>4)+2), %(4*(tl_>>4)+3), %(((ts_==1)&384)|((ts_==2)&128))
   E4 %(16*(16*tg_+(tl_&15))), %(16+4*(tl_>>4)), %(16+4*(tl_>>4)+1), %(16+4*(tl_>>4)+2), %(16+4*(tl_>>4)+3), %(((ts_==1)&384)|((ts_==2)&128))
   .set tl_, tl_+1
  .endr
  .set ts_, ts_+1
 .endr
 .set tg_, tg_+1
.endr
.fill 512, 4, 0
.noaltmacro

.long 0x3f800000,0x3f800000,0x3f800000,0x3f800000
.long 0x3f800000,0x3f7fffb1,0x3f7ffec4,0x3f7ffd39
.long 0x3f800000,0x3f7ffec4,0x3f7ffb11,0x3f7ff4e6
.long 0x3f800000,0x3f7ffd39,0x3f7ff4e6,0x3f7fe705
.long 0x3f800000,0x3f7ffb11,0x3f7fec43,0x3f7fd397
.long 0x3f800000,0x3f7ff84a,0x3f7fe129,0x3f7fba9e
.long 0x3f800000,0x3f7ff4e6,0x3f7fd397,0x3f7f9c18
.long 0x3f800000,0x3f7ff0e3,0x3f7fc38f,0x3f7f7808
.long 0x3f800000,0x3f7fec43,0x3f7fb10f,0x3f7f4e6d
.long 0x3f800000,0x3f7fe705,0x3f7f9c18,0x3f7f1f49
.long 0x3f800000,0x3f7fe129,0x3f7f84ab,0x3f7eea9d
.long 0x3f800000,0x3f7fdaaf,0x3f7f6ac7,0x3f7eb069
.long 0x3f800000,0x3f7fd397,0x3f7f4e6d,0x3f7e70b0
.long 0x3f800000,0x3f7fcbe2,0x3f7f2f9d,0x3f7e2b72
.long 0x3f800000,0x3f7fc38f,0x3f7f0e58,0x3f7de0b1
.long 0x3f800000,0x3f7fba9e,0x3f7eea9d,0x3f7d906e
.long 0x3f800000,0x3f800000,0x3f800000,0x3f800000
.long 0x3f7ffb11,0x3f7ff84a,0x3f7ff4e6,0x3f7ff0e3
.long 0x3f7fec43,0x3f7fe129,0x3f7fd397,0x3f7fc38f
.long 0x3f7fd397,0x3f7fba9e,0x3f7f9c18,0x3f7f7808
.long 0x3f7fb10f,0x3f7f84ab,0x3f7f4e6d,0x3f7f0e58
.long 0x3f7f84ab,0x3f7f3f54,0x3f7eea9d,0x3f7e868b
.long 0x3f7f4e6d,0x3f7eea9d,0x3f7e70b0,0x3f7de0b1
.long 0x3f7f0e58,0x3f7e868b,0x3f7de0b1,0x3f7d1cdd
.long 0x3f7ec46d,0x3f7e1324,0x3f7d3aac,0x3f7c3b28
.long 0x3f7e70b0,0x3f7d906e,0x3f7c7eb0,0x3f7b3bab
.long 0x3f7e1324,0x3f7cfe73,0x3f7baccd,0x3f7a1e84
.long 0x3f7dabcc,0x3f7c5d3a,0x3f7ac516,0x3f78e3d6
.long 0x3f7d3aac,0x3f7baccd,0x3f79c79d,0x3f778bc5
.long 0x3f7cbfc9,0x3f7aed37,0x3f78b47b,0x3f76167a
.long 0x3f7c3b28,0x3f7a1e84,0x3f778bc5,0x3f748422
.long 0x3f7baccd,0x3f7940c0,0x3f764d97,0x3f72d4eb
.long 0x3f800000,0x3f800000,0x3f800000,0x3f800000
.long 0x3f7fec43,0x3f7fe705,0x3f7fe129,0x3f7fdaaf
.long 0x3f7fb10f,0x3f7f9c18,0x3f7f84ab,0x3f7f6ac7
.long 0x3f7f4e6d,0x3f7f1f49,0x3f7eea9d,0x3f7eb069
.long 0x3f7ec46d,0x3f7e70b0,0x3f7e1324,0x3f7dabcc
.long 0x3f7e1324,0x3f7d906e,0x3f7cfe73,0x3f7c5d3a
.long 0x3f7d3aac,0x3f7c7eb0,0x3f7baccd,0x3f7ac516
.long 0x3f7c3b28,0x3f7b3bab,0x3f7a1e84,0x3f78e3d6
.long 0x3f7b14be,0x3f79c79d,0x3f7853f8,0x3f76ba07
.long 0x3f79c79d,0x3f7822d1,0x3f764d97,0x3f74484b
.long 0x3f7853f8,0x3f764d97,0x3f740bdd,0x3f718f57
.long 0x3f76ba07,0x3f74484b,0x3f718f57,0x3f6e8ff8
.long 0x3f74fa0b,0x3f721352,0x3f6ed89e,0x3f6b4b0c
.long 0x3f731447,0x3f6faf1b,0x3f6be858,0x3f67c187
.long 0x3f710908,0x3f6d1c1d,0x3f68bf3c,0x3f63f473
.long 0x3f6ed89e,0x3f6a5ad9,0x3f655e0b,0x3f5fe4e9
.long 0x3f800000,0x3f800000,0x3f800000,0x3f800000
.long 0x3f7fd397,0x3f7fcbe2,0x3f7fc38f,0x3f7fba9e
.long 0x3f7f4e6d,0x3f7f2f9d,0x3f7f0e58,0x3f7eea9d
.long 0x3f7e70b0,0x3f7e2b72,0x3f7de0b1,0x3f7d906e
.long 0x3f7d3aac,0x3f7cbfc9,0x3f7c3b28,0x3f7baccd
.long 0x3f7baccd,0x3f7aed37,0x3f7a1e84,0x3f7940c0
.long 0x3f79c79d,0x3f78b47b,0x3f778bc5,0x3f764d97
.long 0x3f778bc5,0x3f76167a,0x3f748422,0x3f72d4eb
.long 0x3f74fa0b,0x3f731447,0x3f710908,0x3f6ed89e
.long 0x3f721352,0x3f6faf1b,0x3f6d1c1d,0x3f6a5ad9
.long 0x3f6ed89e,0x3f6be858,0x3f68bf3c,0x3f655e0b
.long 0x3f6b4b0c,0x3f67c187,0x3f63f473,0x3f5fe4e9
.long 0x3f676bd8,0x3f633c5a,0x3f5ebe05,0x3f59f26a
.long 0x3f633c5a,0x3f5e5aa6,0x3f591e6a,0x3f5389c7
.long 0x3f5ebe05,0x3f591e6a,0x3f531849,0x3f4cae79
.long 0x3f59f26a,0x3f5389c7,0x3f4cae79,0x3f456439
.long 0x0,0x0,0x0,0x0
.long 0x0,0x3b490fc6,0x3bc90f88,0x3c16cb58
.long 0x0,0x3bc90f88,0x3c490e90,0x3c96c9b6
.long 0x0,0x3c16cb58,0x3c96c9b6,0x3ce22a7a
.long 0x0,0x3c490e90,0x3cc90ab0,0x3d16c32c
.long 0x0,0x3c7b514b,0x3cfb49ba,0x3d3c6dd5
.long 0x0,0x3c96c9b6,0x3d16c32c,0x3d621469
.long 0x0,0x3cafea69,0x3d2fe007,0x3d83db0a
.long 0x0,0x3cc90ab0,0x3d48fb30,0x3d96a905
.long 0x0,0x3ce22a7a,0x3d621469,0x3da973ba
.long 0x0,0x3cfb49ba,0x3d7b2b74,0x3dbc3ac3
.long 0x0,0x3d0a342f,0x3d8a200a,0x3dcefdb7
.long 0x0,0x3d16c32c,0x3d96a905,0x3de1bc2e
.long 0x0,0x3d2351cb,0x3da3308c,0x3df475c0
.long 0x0,0x3d2fe007,0x3dafb680,0x3e039502
.long 0x0,0x3d3c6dd5,0x3dbc3ac3,0x3e0cec4a
.long 0x0,0x0,0x0,0x0
.long 0x3c490e90,0x3c7b514b,0x3c96c9b6,0x3cafea69
.long 0x3cc90ab0,0x3cfb49ba,0x3d16c32c,0x3d2fe007
.long 0x3d16c32c,0x3d3c6dd5,0x3d621469,0x3d83db0a
.long 0x3d48fb30,0x3d7b2b74,0x3d96a905,0x3dafb680
.long 0x3d7b2b74,0x3d9cecf9,0x3dbc3ac3,0x3ddb7d37
.long 0x3d96a905,0x3dbc3ac3,0x3de1bc2e,0x3e039502
.long 0x3dafb680,0x3ddb7d37,0x3e039502,0x3e195be0
.long 0x3dc8bd36,0x3dfab273,0x3e164083,0x3e2f10a2
.long 0x3de1bc2e,0x3e0cec4a,0x3e28defc,0x3e44b0b9
.long 0x3dfab273,0x3e1c76de,0x3e3b6ecf,0x3e5a3997
.long 0x3e09cf86,0x3e2bf804,0x3e4dee60,0x3e6fa8b2
.long 0x3e164083,0x3e3b6ecf,0x3e605c13,0x3e827dc0
.long 0x3e22abb6,0x3e4ada4f,0x3e72b651,0x3e8d17c0
.long 0x3e2f10a2,0x3e5a3997,0x3e827dc0,0x3e97a117
.long 0x3e3b6ecf,0x3e698bba,0x3e8b9507,0x3ea21887
.long 0x0,0x0,0x0,0x0
.long 0x3cc90ab0,0x3ce22a7a,0x3cfb49ba,0x3d0a342f
.long 0x3d48fb30,0x3d621469,0x3d7b2b74,0x3d8a200a
.long 0x3d96a905,0x3da973ba,0x3dbc3ac3,0x3dcefdb7
.long 0x3dc8bd36,0x3de1bc2e,0x3dfab273,0x3e09cf86
.long 0x3dfab273,0x3e0cec4a,0x3e1c76de,0x3e2bf804
.long 0x3e164083,0x3e28defc,0x3e3b6ecf,0x3e4dee60
.long 0x3e2f10a2,0x3e44b0b9,0x3e5a3997,0x3e6fa8b2
.long 0x3e47c5c2,0x3e605c13,0x3e78cfcc,0x3e888e93
.long 0x3e605c13,0x3e7bdba4,0x3e8b9507,0x3e9920fe
.long 0x3e78cfcc,0x3e8b9507,0x3e9aa086,0x3ea986c4
.long 0x3e888e93,0x3e9920fe,0x3ea986c4,0x3eb9bb1e
.long 0x3e94a031,0x3ea68f12,0x3eb8442a,0x3ec9b953
.long 0x3ea09ae5,0x3eb3dca5,0x3ec6d529,0x3ed97cb9
.long 0x3eac7cd4,0x3ec1071e,0x3ed53641,0x3ee900b7
.long 0x3eb8442a,0x3ece0bea,0x3ee363fa,0x3ef840c8
.long 0x0,0x0,0x0,0x0
.long 0x3d16c32c,0x3d2351cb,0x3d2fe007,0x3d3c6dd5
.long 0x3d96a905,0x3da3308c,0x3dafb680,0x3dbc3ac3
.long 0x3de1bc2e,0x3df475c0,0x3e039502,0x3e0cec4a
.long 0x3e164083,0x3e22abb6,0x3e2f10a2,0x3e3b6ecf
.long 0x3e3b6ecf,0x3e4ada4f,0x3e5a3997,0x3e698bba
.long 0x3e605c13,0x3e72b651,0x3e827dc0,0x3e8b9507
.long 0x3e827dc0,0x3e8d17c0,0x3e97a117,0x3ea21887
.long 0x3e94a031,0x3ea09ae5,0x3eac7cd4,0x3eb8442a
.long 0x3ea68f12,0x3eb3dca5,0x3ec1071e,0x3ece0bea
.long 0x3eb8442a,0x3ec6d529,0x3ed53641,0x3ee363fa
.long 0x3ec9b953,0x3ed97cb9,0x3ee900b7,0x3ef840c8
.long 0x3edae880,0x3eebcbbb,0x3efc5d27,0x3f064b82
.long 0x3eebcbbb,0x3efdbabb,0x3f07a136,0x3f102dd5
.long 0x3efc5d27,0x3f07a136,0x3f10d3cd,0x3f19c200
.long 0x3f064b82,0x3f102dd5,0x3f19c200,0x3f2302d3
.long 0x3f800000,0x3f800000,0x3f800000,0x3f800000
.long 0x3f7fb10f,0x3f7fa6e3,0x3f7f9c18,0x3f7f90b1
.long 0x3f7ec46d,0x3f7e9bc9,0x3f7e70b0,0x3f7e4323
.long 0x3f7d3aac,0x3f7cdf6c,0x3f7c7eb0,0x3f7c187a
.long 0x3f7b14be,0x3f7a7302,0x3f79c79d,0x3f791298
.long 0x3f7853f8,0x3f77583a,0x3f764d97,0x3f75341d
.long 0x3f74fa0b,0x3f73913f,0x3f721352,0x3f708066
.long 0x3f710908,0x3f6f20b0,0x3f6d1c1d,0x3f6afb8c
.long 0x3f6c835e,0x3f6a09a7,0x3f676bd8,0x3f64aa59
.long 0x3f676bd8,0x3f644fac,0x3f6106f2,0x3f5d924d
.long 0x3f61c598,0x3f5df6be,0x3f59f26a,0x3f55b993
.long 0x3f5b941a,0x3f570348,0x3f5233c6,0x3f4d26fd
.long 0x3f54db31,0x3f4f7a1f,0x3f49d112,0x3f43e200
.long 0x3f4d9f02,0x3f476085,0x3f40d0da,0x3f39f2ac
.long 0x3f45e403,0x3f3ebc1b,0x3f373a23,0x3f2f61a5
.long 0x3f3daef9,0x3f3592e7,0x3f2d1469,0x3f24381a
.long 0x3f800000,0x3f800000,0x3f800000,0x3f800000
.long 0x3f7f84ab,0x3f7f7808,0x3f7f6ac7,0x3f7f5ce9
.long 0x3f7e1324,0x3f7de0b1,0x3f7dabcc,0x3f7d7474
.long 0x3f7baccd,0x3f7b3bab,0x3f7ac516,0x3f7a4910
.long 0x3f7853f8,0x3f778bc5,0x3f76ba07,0x3f75dec6
.long 0x3f740bdd,0x3f72d4eb,0x3f718f57,0x3f703b37
.long 0x3f6ed89e,0x3f6d1c1d,0x3f6b4b0c,0x3f696591
.long 0x3f68bf3c,0x3f666771,0x3f63f473,0x3f61668a
.long 0x3f61c598,0x3f5ebe05,0x3f5b941a,0x3f584853
.long 0x3f59f26a,0x3f5627fe,0x3f5233c6,0x3f4e1689
.long 0x3f514d3d,0x3f4cae79,0x3f47de65,0x3f42de29
.long 0x3f47de65,0x3f425b89,0x3f3ca003,0x3f36ad7f
.long 0x3f3daef9,0x3f373a23,0x3f3085bb,0x3f299415
.long 0x3f32c8c9,0x3f2b561b,0x3f239da9,0x3f1ba299
.long 0x3f273656,0x3f1ebc12,0x3f15f6d9,0x3f0cead0
.long 0x3f1b02c6,0x3f11796b,0x3f07a136,0x3efafef7
.long 0x3f800000,0x3f800000,0x3f800000,0x3f800000
.long 0x3f7f4e6d,0x3f7f3f54,0x3f7f2f9d,0x3f7f1f49
.long 0x3f7d3aac,0x3f7cfe73,0x3f7cbfc9,0x3f7c7eb0
.long 0x3f79c79d,0x3f7940c0,0x3f78b47b,0x3f7822d1
.long 0x3f74fa0b,0x3f740bdd,0x3f731447,0x3f721352
.long 0x3f6ed89e,0x3f6d67a1,0x3f6be858,0x3f6a5ad9
.long 0x3f676bd8,0x3f655e0b,0x3f633c5a,0x3f6106f2
.long 0x3f5ebe05,0x3f5bfb34,0x3f591e6a,0x3f5627fe
.long 0x3f54db31,0x3f514d3d,0x3f4d9f02,0x3f49d112
.long 0x3f49d112,0x3f456439,0x3f40d0da,0x3f3c17d9
.long 0x3f3daef9,0x3f385216,0x3f32c8c9,0x3f2d1469
.long 0x3f3085bb,0x3f2a2a80,0x3f239da9,0x3f1ce11f
.long 0x3f226799,0x3f1b02c6,0x3f13682a,0x3f0b9a6b
.long 0x3f13682a,0x3f0af1b7,0x3f0242b1,0x3ef2bd43
.long 0x3f039c3d,0x3ef41f07,0x3ee0924f,0x3ecc9b8b
.long 0x3ee63375,0x3ed0eb2a,0x3ebb31a0,0x3ea5129f
.long 0x3f800000,0x3f800000,0x3f800000,0x3f800000
.long 0x3f7f0e58,0x3f7efcc9,0x3f7eea9d,0x3f7ed7d4
.long 0x3f7c3b28,0x3f7bf531,0x3f7baccd,0x3f7b61fc
.long 0x3f778bc5,0x3f76ef5b,0x3f764d97,0x3f75a67b
.long 0x3f710908,0x3f6ff573,0x3f6ed89e,0x3f6db293
.long 0x3f68bf3c,0x3f671599,0x3f655e0b,0x3f6398ac
.long 0x3f5ebe05,0x3f5c61c7,0x3f59f26a,0x3f577026
.long 0x3f531849,0x3f4fefa8,0x3f4cae79,0x3f495521
.long 0x3f45e403,0x3f41d870,0x3f3daef9,0x3f396842
.long 0x3f373a23,0x3f3238aa,0x3f2d1469,0x3f27ce61
.long 0x3f273656,0x3f212ff9,0x3f1b02c6,0x3f14b039
.long 0x3f15f6d9,0x3f0ee0db,0x3f07a136,0x3f003a06
.long 0x3f039c3d,0x3ef6e0cb,0x3ee63375,0x3ed53641
.long 0x3ee0924f,0x3ece0bea,0x3ebb31a0,0x3ea80b1f
.long 0x3eb8442a,0x3ea395c5,0x3e8e9a22,0x3e72b651
.long 0x3e8e9a22,0x3e6fa8b2,0x3e419b37,0x3e1324ca
.long 0x0,0x0,0x0,0x0
.long 0x3d48fb30,0x3d55880e,0x3d621469,0x3d6ea038
.long 0x3dc8bd36,0x3dd53db9,0x3de1bc2e,0x3dee3876
.long 0x3e164083,0x3e1f917b,0x3e28defc,0x3e3228d4
.long 0x3e47c5c2,0x3e541501,0x3e605c13,0x3e6c9a7f
.long 0x3e78cfcc,0x3e840270,0x3e8b9507,0x3e931f35
.long 0x3e94a031,0x3e9d9e78,0x3ea68f12,0x3eaf713a
.long 0x3eac7cd4,0x3eb6ccc3,0x3ec1071e,0x3ecb2aae
.long 0x3ec3ef15,0x3ecf7bca,0x3edae880,0x3ee63375
.long 0x3edae880,0x3ee79a5d,0x3ef41f07,0x3f003a06
.long 0x3ef15aea,0x3eff17b2,0x3f064b82,0x3f0cead0
.long 0x3f039c3d,0x3f0af1b7,0x3f121eb0,0x3f19210f
.long 0x3f0e39da,0x3f15f6d9,0x3f1d7fd1,0x3f24d225
.long 0x3f187fc0,0x3f209393,0x3f286605,0x3f2ff3e6
.long 0x3f226799,0x3f2ac082,0x3f32c8c9,0x3f3a7ca4
.long 0x3f2beb4a,0x3f34768f,0x3f3ca003,0x3f446337
.long 0x0,0x0,0x0,0x0
.long 0x3d7b2b74,0x3d83db0a,0x3d8a200a,0x3d9064b4
.long 0x3dfab273,0x3e039502,0x3e09cf86,0x3e1008b7
.long 0x3e3b6ecf,0x3e44b0b9,0x3e4dee60,0x3e57278f
.long 0x3e78cfcc,0x3e827dc0,0x3e888e93,0x3e8e9a22
.long 0x3e9aa086,0x3ea21887,0x3ea986c4,0x3eb0eacb
.long 0x3eb8442a,0x3ec1071e,0x3ec9b953,0x3ed25a09
.long 0x3ed53641,0x3edf28a9,0x3ee900b7,0x3ef2bd43
.long 0x3ef15aea,0x3efc5d27,0x3f039c3d,0x3f08f59b
.long 0x3f064b82,0x3f0c42c9,0x3f121eb0,0x3f17de12
.long 0x3f13682a,0x3f19c200,0x3f1ff6cb,0x3f26050a
.long 0x3f1ff6cb,0x3f269de3,0x3f2d1469,0x3f33587a
.long 0x3f2beb4a,0x3f32c8c9,0x3f396842,0x3f3fc767
.long 0x3f373a23,0x3f3e35c5,0x3f44e3f5,0x3f4b41fa
.long 0x3f41d870,0x3f48d8b3,0x3f4f7a1f,0x3f55b993
.long 0x3f4bbbf8,0x3f52a649,0x3f591e6a,0x3f5f20db
.long 0x0,0x0,0x0,0x0
.long 0x3d96a905,0x3d9cecf9,0x3da3308c,0x3da973ba
.long 0x3e164083,0x3e1c76de,0x3e22abb6,0x3e28defc
.long 0x3e605c13,0x3e698bba,0x3e72b651,0x3e7bdba4
.long 0x3e94a031,0x3e9aa086,0x3ea09ae5,0x3ea68f12
.long 0x3eb8442a,0x3ebf926f,0x3ec6d529,0x3ece0bea
.long 0x3edae880,0x3ee363fa,0x3eebcbbb,0x3ef41f07
.long 0x3efc5d27,0x3f02ef9f,0x3f07a136,0x3f0c42c9
.long 0x3f0e39da,0x3f13682a,0x3f187fc0,0x3f1d7fd1
.long 0x3f1d7fd1,0x3f2302d3,0x3f286605,0x3f2da859
.long 0x3f2beb4a,0x3f31a81d,0x3f373a23,0x3f3ca003
.long 0x3f396842,0x3f3f41fc,0x3f44e3f5,0x3f4a4c87
.long 0x3f45e403,0x3f4bbbf8,0x3f514d3d,0x3f5695e5
.long 0x3f514d3d,0x3f570348,0x3f5c61c7,0x3f61668a
.long 0x3f5b941a,0x3f6106f2,0x3f660f88,0x3f6aab7b
.long 0x3f64aa59,0x3f69b7e4,0x3f6e46be,0x3f725470
.long 0x0,0x0,0x0,0x0
.long 0x3dafb680,0x3db5f8da,0x3dbc3ac3,0x3dc27c39
.long 0x3e2f10a2,0x3e354098,0x3e3b6ecf,0x3e419b37
.long 0x3e827dc0,0x3e870ada,0x3e8b9507,0x3e901c2c
.long 0x3eac7cd4,0x3eb263ef,0x3eb8442a,0x3ebe1d4a
.long 0x3ed53641,0x3edc53c1,0x3ee363fa,0x3eea6681
.long 0x3efc5d27,0x3f0242b1,0x3f064b82,0x3f0a48ad
.long 0x3f10d3cd,0x3f1553b7,0x3f19c200,0x3f1e1e22
.long 0x3f226799,0x3f273656,0x3f2beb4a,0x3f3085bb
.long 0x3f32c8c9,0x3f37c655,0x3f3ca003,0x3f4154e1
.long 0x3f41d870,0x3f46e22a,0x3f4bbbf8,0x3f5064af
.long 0x3f4f7a1f,0x3f546b3b,0x3f591e6a,0x3f5d924d
.long 0x3f5b941a,0x3f604621,0x3f64aa59,0x3f68bf3c
.long 0x3f660f88,0x3f6a5ad9,0x3f6e46be,0x3f71d19f
.long 0x3f6ed89e,0x3f7294f8,0x3f75dec6,0x3f78b47b
.long 0x3f75dec6,0x3f78e3d6,0x3f7b61fc,0x3f7d57de
.long 0x3f800000,0x3f7fb10f,0x3f7ec46d,0x3f7d3aac
.long 0x3f800000,0x3f7fa6e3,0x3f7e9bc9,0x3f7cdf6c
.long 0x3f800000,0x3f7f9c18,0x3f7e70b0,0x3f7c7eb0
.long 0x3f800000,0x3f7f90b1,0x3f7e4323,0x3f7c187a
.long 0x3f800000,0x3f7f84ab,0x3f7e1324,0x3f7baccd
.long 0x3f800000,0x3f7f7808,0x3f7de0b1,0x3f7b3bab
.long 0x3f800000,0x3f7f6ac7,0x3f7dabcc,0x3f7ac516
.long 0x3f800000,0x3f7f5ce9,0x3f7d7474,0x3f7a4910
.long 0x3f800000,0x3f7f4e6d,0x3f7d3aac,0x3f79c79d
.long 0x3f800000,0x3f7f3f54,0x3f7cfe73,0x3f7940c0
.long 0x3f800000,0x3f7f2f9d,0x3f7cbfc9,0x3f78b47b
.long 0x3f800000,0x3f7f1f49,0x3f7c7eb0,0x3f7822d1
.long 0x3f800000,0x3f7f0e58,0x3f7c3b28,0x3f778bc5
.long 0x3f800000,0x3f7efcc9,0x3f7bf531,0x3f76ef5b
.long 0x3f800000,0x3f7eea9d,0x3f7baccd,0x3f764d97
.long 0x3f800000,0x3f7ed7d4,0x3f7b61fc,0x3f75a67b
.long 0x3f7b14be,0x3f7853f8,0x3f74fa0b,0x3f710908
.long 0x3f7a7302,0x3f77583a,0x3f73913f,0x3f6f20b0
.long 0x3f79c79d,0x3f764d97,0x3f721352,0x3f6d1c1d
.long 0x3f791298,0x3f75341d,0x3f708066,0x3f6afb8c
.long 0x3f7853f8,0x3f740bdd,0x3f6ed89e,0x3f68bf3c
.long 0x3f778bc5,0x3f72d4eb,0x3f6d1c1d,0x3f666771
.long 0x3f76ba07,0x3f718f57,0x3f6b4b0c,0x3f63f473
.long 0x3f75dec6,0x3f703b37,0x3f696591,0x3f61668a
.long 0x3f74fa0b,0x3f6ed89e,0x3f676bd8,0x3f5ebe05
.long 0x3f740bdd,0x3f6d67a1,0x3f655e0b,0x3f5bfb34
.long 0x3f731447,0x3f6be858,0x3f633c5a,0x3f591e6a
.long 0x3f721352,0x3f6a5ad9,0x3f6106f2,0x3f5627fe
.long 0x3f710908,0x3f68bf3c,0x3f5ebe05,0x3f531849
.long 0x3f6ff573,0x3f671599,0x3f5c61c7,0x3f4fefa8
.long 0x3f6ed89e,0x3f655e0b,0x3f59f26a,0x3f4cae79
.long 0x3f6db293,0x3f6398ac,0x3f577026,0x3f495521
.long 0x3f6c835e,0x3f676bd8,0x3f61c598,0x3f5b941a
.long 0x3f6a09a7,0x3f644fac,0x3f5df6be,0x3f570348
.long 0x3f676bd8,0x3f6106f2,0x3f59f26a,0x3f5233c6
.long 0x3f64aa59,0x3f5d924d,0x3f55b993,0x3f4d26fd
.long 0x3f61c598,0x3f59f26a,0x3f514d3d,0x3f47de65
.long 0x3f5ebe05,0x3f5627fe,0x3f4cae79,0x3f425b89
.long 0x3f5b941a,0x3f5233c6,0x3f47de65,0x3f3ca003
.long 0x3f584853,0x3f4e1689,0x3f42de29,0x3f36ad7f
.long 0x3f54db31,0x3f49d112,0x3f3daef9,0x3f3085bb
.long 0x3f514d3d,0x3f456439,0x3f385216,0x3f2a2a80
.long 0x3f4d9f02,0x3f40d0da,0x3f32c8c9,0x3f239da9
.long 0x3f49d112,0x3f3c17d9,0x3f2d1469,0x3f1ce11f
.long 0x3f45e403,0x3f373a23,0x3f273656,0x3f15f6d9
.long 0x3f41d870,0x3f3238aa,0x3f212ff9,0x3f0ee0db
.long 0x3f3daef9,0x3f2d1469,0x3f1b02c6,0x3f07a136
.long 0x3f396842,0x3f27ce61,0x3f14b039,0x3f003a06
.long 0x3f54db31,0x3f4d9f02,0x3f45e403,0x3f3daef9
.long 0x3f4f7a1f,0x3f476085,0x3f3ebc1b,0x3f3592e7
.long 0x3f49d112,0x3f40d0da,0x3f373a23,0x3f2d1469
.long 0x3f43e200,0x3f39f2ac,0x3f2f61a5,0x3f24381a
.long 0x3f3daef9,0x3f32c8c9,0x3f273656,0x3f1b02c6
.long 0x3f373a23,0x3f2b561b,0x3f1ebc12,0x3f11796b
.long 0x3f3085bb,0x3f239da9,0x3f15f6d9,0x3f07a136
.long 0x3f299415,0x3f1ba299,0x3f0cead0,0x3efafef7
.long 0x3f226799,0x3f13682a,0x3f039c3d,0x3ee63375
.long 0x3f1b02c6,0x3f0af1b7,0x3ef41f07,0x3ed0eb2a
.long 0x3f13682a,0x3f0242b1,0x3ee0924f,0x3ebb31a0
.long 0x3f0b9a6b,0x3ef2bd43,0x3ecc9b8b,0x3ea5129f
.long 0x3f039c3d,0x3ee0924f,0x3eb8442a,0x3e8e9a22
.long 0x3ef6e0cb,0x3ece0bea,0x3ea395c5,0x3e6fa8b2
.long 0x3ee63375,0x3ebb31a0,0x3e8e9a22,0x3e419b37
.long 0x3ed53641,0x3ea80b1f,0x3e72b651,0x3e1324ca
.long 0x0,0x3d48fb30,0x3dc8bd36,0x3e164083
.long 0x0,0x3d55880e,0x3dd53db9,0x3e1f917b
.long 0x0,0x3d621469,0x3de1bc2e,0x3e28defc
.long 0x0,0x3d6ea038,0x3dee3876,0x3e3228d4
.long 0x0,0x3d7b2b74,0x3dfab273,0x3e3b6ecf
.long 0x0,0x3d83db0a,0x3e039502,0x3e44b0b9
.long 0x0,0x3d8a200a,0x3e09cf86,0x3e4dee60
.long 0x0,0x3d9064b4,0x3e1008b7,0x3e57278f
.long 0x0,0x3d96a905,0x3e164083,0x3e605c13
.long 0x0,0x3d9cecf9,0x3e1c76de,0x3e698bba
.long 0x0,0x3da3308c,0x3e22abb6,0x3e72b651
.long 0x0,0x3da973ba,0x3e28defc,0x3e7bdba4
.long 0x0,0x3dafb680,0x3e2f10a2,0x3e827dc0
.long 0x0,0x3db5f8da,0x3e354098,0x3e870ada
.long 0x0,0x3dbc3ac3,0x3e3b6ecf,0x3e8b9507
.long 0x0,0x3dc27c39,0x3e419b37,0x3e901c2c
.long 0x3e47c5c2,0x3e78cfcc,0x3e94a031,0x3eac7cd4
.long 0x3e541501,0x3e840270,0x3e9d9e78,0x3eb6ccc3
.long 0x3e605c13,0x3e8b9507,0x3ea68f12,0x3ec1071e
.long 0x3e6c9a7f,0x3e931f35,0x3eaf713a,0x3ecb2aae
.long 0x3e78cfcc,0x3e9aa086,0x3eb8442a,0x3ed53641
.long 0x3e827dc0,0x3ea21887,0x3ec1071e,0x3edf28a9
.long 0x3e888e93,0x3ea986c4,0x3ec9b953,0x3ee900b7
.long 0x3e8e9a22,0x3eb0eacb,0x3ed25a09,0x3ef2bd43
.long 0x3e94a031,0x3eb8442a,0x3edae880,0x3efc5d27
.long 0x3e9aa086,0x3ebf926f,0x3ee363fa,0x3f02ef9f
.long 0x3ea09ae5,0x3ec6d529,0x3eebcbbb,0x3f07a136
.long 0x3ea68f12,0x3ece0bea,0x3ef41f07,0x3f0c42c9
.long 0x3eac7cd4,0x3ed53641,0x3efc5d27,0x3f10d3cd
.long 0x3eb263ef,0x3edc53c1,0x3f0242b1,0x3f1553b7
.long 0x3eb8442a,0x3ee363fa,0x3f064b82,0x3f19c200
.long 0x3ebe1d4a,0x3eea6681,0x3f0a48ad,0x3f1e1e22
.long 0x3ec3ef15,0x3edae880,0x3ef15aea,0x3f039c3d
.long 0x3ecf7bca,0x3ee79a5d,0x3eff17b2,0x3f0af1b7
.long 0x3edae880,0x3ef41f07,0x3f064b82,0x3f121eb0
.long 0x3ee63375,0x3f003a06,0x3f0cead0,0x3f19210f
.long 0x3ef15aea,0x3f064b82,0x3f13682a,0x3f1ff6cb
.long 0x3efc5d27,0x3f0c42c9,0x3f19c200,0x3f269de3
.long 0x3f039c3d,0x3f121eb0,0x3f1ff6cb,0x3f2d1469
.long 0x3f08f59b,0x3f17de12,0x3f26050a,0x3f33587a
.long 0x3f0e39da,0x3f1d7fd1,0x3f2beb4a,0x3f396842
.long 0x3f13682a,0x3f2302d3,0x3f31a81d,0x3f3f41fc
.long 0x3f187fc0,0x3f286605,0x3f373a23,0x3f44e3f5
.long 0x3f1d7fd1,0x3f2da859,0x3f3ca003,0x3f4a4c87
.long 0x3f226799,0x3f32c8c9,0x3f41d870,0x3f4f7a1f
.long 0x3f273656,0x3f37c655,0x3f46e22a,0x3f546b3b
.long 0x3f2beb4a,0x3f3ca003,0x3f4bbbf8,0x3f591e6a
.long 0x3f3085bb,0x3f4154e1,0x3f5064af,0x3f5d924d
.long 0x3f0e39da,0x3f187fc0,0x3f226799,0x3f2beb4a
.long 0x3f15f6d9,0x3f209393,0x3f2ac082,0x3f34768f
.long 0x3f1d7fd1,0x3f286605,0x3f32c8c9,0x3f3ca003
.long 0x3f24d225,0x3f2ff3e6,0x3f3a7ca4,0x3f446337
.long 0x3f2beb4a,0x3f373a23,0x3f41d870,0x3f4bbbf8
.long 0x3f32c8c9,0x3f3e35c5,0x3f48d8b3,0x3f52a649
.long 0x3f396842,0x3f44e3f5,0x3f4f7a1f,0x3f591e6a
.long 0x3f3fc767,0x3f4b41fa,0x3f55b993,0x3f5f20db
.long 0x3f45e403,0x3f514d3d,0x3f5b941a,0x3f64aa59
.long 0x3f4bbbf8,0x3f570348,0x3f6106f2,0x3f69b7e4
.long 0x3f514d3d,0x3f5c61c7,0x3f660f88,0x3f6e46be
.long 0x3f5695e5,0x3f61668a,0x3f6aab7b,0x3f725470
.long 0x3f5b941a,0x3f660f88,0x3f6ed89e,0x3f75dec6
.long 0x3f604621,0x3f6a5ad9,0x3f7294f8,0x3f78e3d6
.long 0x3f64aa59,0x3f6e46be,0x3f75dec6,0x3f7b61fc
.long 0x3f68bf3c,0x3f71d19f,0x3f78b47b,0x3f7d57de
.long 0x3f3504f3,0x3f2beb4a,0x3f226799,0x3f187fc0
.long 0x3f2beb4a,0x3f21cbfb,0x3f173c07,0x3f0c42c9
.long 0x3f226799,0x3f173c07,0x3f0b9a6b,0x3eff17b2
.long 0x3f187fc0,0x3f0c42c9,0x3eff17b2,0x3ee4cbfe
.long 0x3f0e39da,0x3f00e7e4,0x3ee63375,0x3ec9b953
.long 0x3f039c3d,0x3eea6681,0x3ecc9b8b,0x3eadf73c
.long 0x3ef15aea,0x3ed25a09,0x3eb263ef,0x3e919ddd
.long 0x3edae880,0x3eb9bb1e,0x3e97a117,0x3e698bba
.long 0x3ec3ef15,0x3ea09ae5,0x3e78cfcc,0x3e2f10a2
.long 0x3eac7cd4,0x3e870ada,0x3e419b37,0x3de7fa9a
.long 0x3e94a031,0x3e5a3997,0x3e09cf86,0x3d621469
.long 0x3e78cfcc,0x3e25c58c,0x3da3308c,0xbb490fc6
.long 0x3e47c5c2,0x3de1bc2e,0x3cc90ab0,0xbd7b2b74
.long 0x3e164083,0x3d6ea038,0xbcfb49ba,0xbdf475c0
.long 0x3dc8bd36,0x3bc90f88,0xbdafb680,0xbe354098
.long 0x3d48fb30,0xbd3c6dd5,0xbe1008b7,0xbe6fa8b2
.long 0x3f0e39da,0x3f039c3d,0x3ef15aea,0x3edae880
.long 0x3f00e7e4,0x3eea6681,0x3ed25a09,0x3eb9bb1e
.long 0x3ee63375,0x3ecc9b8b,0x3eb263ef,0x3e97a117
.long 0x3ec9b953,0x3eadf73c,0x3e919ddd,0x3e698bba
.long 0x3eac7cd4,0x3e8e9a22,0x3e605c13,0x3e22abb6
.long 0x3e8e9a22,0x3e5d4b1a,0x3e1c76de,0x3db5f8da
.long 0x3e605c13,0x3e1c76de,0x3dafb680,0x3c96c9b6
.long 0x3e22abb6,0x3db5f8da,0x3c96c9b6,0xbd55880e
.long 0x3dc8bd36,0x3cc90ab0,0xbd48fb30,0xbdfab273
.long 0x3d16c32c,0xbd2351cb,0xbdee3876,0xbe44b0b9
.long 0xbcc90ab0,0xbdd53db9,0xbe3b6ecf,0xbe8586ce
.long 0xbdafb680,0xbe2bf804,0xbe7ee6e1,0xbea80b1f
.long 0xbe164083,0xbe6c9a7f,0xbea09ae5,0xbec9b953
.long 0xbe541501,0xbe9620d2,0xbec1071e,0xbeea6681
.long 0xbe888e93,0xbeb554ec,0xbee0924f,0xbf04f484
.long 0xbea68f12,0xbed3c867,0xbeff17b2,0xbf140c5f
.long 0x3ec3ef15,0x3eac7cd4,0x3e94a031,0x3e78cfcc
.long 0x3ea09ae5,0x3e870ada,0x3e5a3997,0x3e25c58c
.long 0x3e78cfcc,0x3e419b37,0x3e09cf86,0x3da3308c
.long 0x3e2f10a2,0x3de7fa9a,0x3d621469,0xbb490fc6
.long 0x3dc8bd36,0x3d16c32c,0xbcc90ab0,0xbdafb680
.long 0x3cc90ab0,0xbd2351cb,0xbdd53db9,0xbe2bf804
.long 0xbd48fb30,0xbdee3876,0xbe3b6ecf,0xbe7ee6e1
.long 0xbdfab273,0xbe44b0b9,0xbe8586ce,0xbea80b1f
.long 0xbe47c5c2,0xbe888e93,0xbeac7cd4,0xbecf7bca
.long 0xbe888e93,0xbeadf73c,0xbed25a09,0xbef58035
.long 0xbeac7cd4,0xbed25a09,0xbef6e0cb,0xbf0cead0
.long 0xbecf7bca,0xbef58035,0xbf0cead0,0xbf1e1e22
.long 0xbef15aea,0xbf0b9a6b,0xbf1d7fd1,0xbf2e3bde
.long 0xbf08f59b,0xbf1ba299,0xbf2d1469,0xbf3d27b8
.long 0xbf187fc0,0xbf2ac082,0xbf3b8f3b,0xbf4ac77f
.long 0xbf273656,0xbf38dd65,0xbf48d8b3,0xbf570348
.long 0x3e47c5c2,0x3e164083,0x3dc8bd36,0x3d48fb30
.long 0x3de1bc2e,0x3d6ea038,0x3bc90f88,0xbd3c6dd5
.long 0x3cc90ab0,0xbcfb49ba,0xbdafb680,0xbe1008b7
.long 0xbd7b2b74,0xbdf475c0,0xbe354098,0xbe6fa8b2
.long 0xbe164083,0xbe541501,0xbe888e93,0xbea68f12
.long 0xbe6c9a7f,0xbe9620d2,0xbeb554ec,0xbed3c867
.long 0xbea09ae5,0xbec1071e,0xbee0924f,0xbeff17b2
.long 0xbec9b953,0xbeea6681,0xbf04f484,0xbf140c5f
.long 0xbef15aea,0xbf08f59b,0xbf187fc0,0xbf273656
.long 0xbf0b9a6b,0xbf1ba299,0xbf2ac082,0xbf38dd65
.long 0xbf1d7fd1,0xbf2d1469,0xbf3b8f3b,0xbf48d8b3
.long 0xbf2e3bde,0xbf3d27b8,0xbf4ac77f,0xbf570348
.long 0xbf3daef9,0xbf4bbbf8,0xbf584853,0xbf633c5a
.long 0xbf4bbbf8,0xbf58b3a1,0xbf63f473,0xbf6d67a1
.long 0xbf584853,0xbf63f473,0xbf6db293,0xbf756d97
.long 0xbf633c5a,0xbf6d67a1,0xbf756d97,0xbf7b3bab
.long 0x3f3504f3,0x3f3daef9,0x3f45e403,0x3f4d9f02
.long 0x3f3daef9,0x3f466354,0x3f4e8d90,0x3f5627fe
.long 0x3f45e403,0x3f4e8d90,0x3f5695e5,0x3f5df6be
.long 0x3f4d9f02,0x3f5627fe,0x3f5df6be,0x3f650479
.long 0x3f54db31,0x3f5d2d53,0x3f64aa59,0x3f6b4b0c
.long 0x3f5b941a,0x3f6398ac,0x3f6aab7b,0x3f70c501
.long 0x3f61c598,0x3f696591,0x3f6ff573,0x3f756d97
.long 0x3f676bd8,0x3f6e8ff8,0x3f748422,0x3f7940c0
.long 0x3f6c835e,0x3f731447,0x3f7853f8,0x3f7c3b28
.long 0x3f710908,0x3f76ef5b,0x3f7b61fc,0x3f7e5a38
.long 0x3f74fa0b,0x3f7a1e84,0x3f7dabcc,0x3f7f9c18
.long 0x3f7853f8,0x3f7c9f8a,0x3f7f2f9d,0x3f7fffb1
.long 0x3f7b14be,0x3f7e70b0,0x3f7fec43,0x3f7f84ab
.long 0x3f7d3aac,0x3f7f90b1,0x3f7fe129,0x3f7e2b72
.long 0x3f7ec46d,0x3f7ffec4,0x3f7f0e58,0x3f7bf531
.long 0x3f7fb10f,0x3f7fba9e,0x3f7d7474,0x3f78e3d6
.long 0x3f54db31,0x3f5b941a,0x3f61c598,0x3f676bd8
.long 0x3f5d2d53,0x3f6398ac,0x3f696591,0x3f6e8ff8
.long 0x3f64aa59,0x3f6aab7b,0x3f6ff573,0x3f748422
.long 0x3f6b4b0c,0x3f70c501,0x3f756d97,0x3f7940c0
.long 0x3f710908,0x3f75dec6,0x3f79c79d,0x3f7cbfc9
.long 0x3f75dec6,0x3f79f35e,0x3f7cfe73,0x3f7efcc9
.long 0x3f79c79d,0x3f7cfe73,0x3f7f0e58,0x3f7ff4e6
.long 0x3f7cbfc9,0x3f7efcc9,0x3f7ff4e6,0x3f7fa6e3
.long 0x3f7ec46d,0x3f7fec43,0x3f7fb10f,0x3f7e1324
.long 0x3f7fd397,0x3f7fcbe2,0x3f7e4323,0x3f7b3bab
.long 0x3f7fec43,0x3f7e9bc9,0x3f7baccd,0x3f772417
.long 0x3f7f0e58,0x3f7c5d3a,0x3f77f110,0x3f71d19f
.long 0x3f7d3aac,0x3f791298,0x3f731447,0x3f6b4b0c
.long 0x3f7a7302,0x3f74bf62,0x3f6d1c1d,0x3f6398ac
.long 0x3f76ba07,0x3f6f6830,0x3f660f88,0x3f5ac450
.long 0x3f721352,0x3f6912ae,0x3f5df6be,0x3f50d937
.long 0x3f6c835e,0x3f710908,0x3f74fa0b,0x3f7853f8
.long 0x3f731447,0x3f76ef5b,0x3f7a1e84,0x3f7c9f8a
.long 0x3f7853f8,0x3f7b61fc,0x3f7dabcc,0x3f7f2f9d
.long 0x3f7c3b28,0x3f7e5a38,0x3f7f9c18,0x3f7fffb1
.long 0x3f7ec46d,0x3f7fd397,0x3f7fec43,0x3f7f0e58
.long 0x3f7fec43,0x3f7fcbe2,0x3f7e9bc9,0x3f7c5d3a
.long 0x3f7fb10f,0x3f7e4323,0x3f7baccd,0x3f77f110
.long 0x3f7e1324,0x3f7b3bab,0x3f772417,0x3f71d19f
.long 0x3f7b14be,0x3f76ba07,0x3f710908,0x3f6a09a7
.long 0x3f76ba07,0x3f70c501,0x3f696591,0x3f60a6cf
.long 0x3f710908,0x3f696591,0x3f604621,0x3f55b993
.long 0x3f6a09a7,0x3f60a6cf,0x3f55b993,0x3f495521
.long 0x3f61c598,0x3f5695e5,0x3f49d112,0x3f3b8f3b
.long 0x3f584853,0x3f4b41fa,0x3f3ca003,0x3f2c800f
.long 0x3f4d9f02,0x3f3ebc1b,0x3f2e3bde,0x3f1c420c
.long 0x3f41d870,0x3f311722,0x3f1ebc12,0x3f0af1b7
.long 0x3f7b14be,0x3f7d3aac,0x3f7ec46d,0x3f7fb10f
.long 0x3f7e70b0,0x3f7f90b1,0x3f7ffec4,0x3f7fba9e
.long 0x3f7fec43,0x3f7fe129,0x3f7f0e58,0x3f7d7474
.long 0x3f7f84ab,0x3f7e2b72,0x3f7bf531,0x3f78e3d6
.long 0x3f7d3aac,0x3f7a7302,0x3f76ba07,0x3f721352
.long 0x3f791298,0x3f74bf62,0x3f6f6830,0x3f6912ae
.long 0x3f731447,0x3f6d1c1d,0x3f660f88,0x3f5df6be
.long 0x3f6b4b0c,0x3f6398ac,0x3f5ac450,0x3f50d937
.long 0x3f61c598,0x3f584853,0x3f4d9f02,0x3f41d870
.long 0x3f5695e5,0x3f4b41fa,0x3f3ebc1b,0x3f311722
.long 0x3f49d112,0x3f3ca003,0x3f2e3bde,0x3f1ebc12
.long 0x3f3b8f3b,0x3f2c800f,0x3f1c420c,0x3f0af1b7
.long 0x3f2beb4a,0x3f1b02c6,0x3f08f59b,0x3eebcbbb
.long 0x3f1b02c6,0x3f084b92,0x3ee900b7,0x3ebf926f
.long 0x3f08f59b,0x3ee900b7,0x3ebe1d4a,0x3e919ddd
.long 0x3eebcbbb,0x3ebf926f,0x3e919ddd,0x3e44b0b9
.long 0x3f800000,0x3f7ec46d,0x3f7b14be,0x3f74fa0b
.long 0x3f800000,0x3f7eb069,0x3f7ac516,0x3f74484b
.long 0x3f800000,0x3f7e9bc9,0x3f7a7302,0x3f73913f
.long 0x3f800000,0x3f7e868b,0x3f7a1e84,0x3f72d4eb
.long 0x3f800000,0x3f7e70b0,0x3f79c79d,0x3f721352
.long 0x3f800000,0x3f7e5a38,0x3f796e4e,0x3f714c7a
.long 0x3f800000,0x3f7e4323,0x3f791298,0x3f708066
.long 0x3f800000,0x3f7e2b72,0x3f78b47b,0x3f6faf1b
.long 0x3f800000,0x3f7e1324,0x3f7853f8,0x3f6ed89e
.long 0x3f800000,0x3f7dfa38,0x3f77f110,0x3f6dfcf2
.long 0x3f800000,0x3f7de0b1,0x3f778bc5,0x3f6d1c1d
.long 0x3f800000,0x3f7dc68c,0x3f772417,0x3f6c3624
.long 0x3f800000,0x3f7dabcc,0x3f76ba07,0x3f6b4b0c
.long 0x3f800000,0x3f7d906e,0x3f764d97,0x3f6a5ad9
.long 0x3f800000,0x3f7d7474,0x3f75dec6,0x3f696591
.long 0x3f800000,0x3f7d57de,0x3f756d97,0x3f686b39
.long 0x3f6c835e,0x3f61c598,0x3f54db31,0x3f45e403
.long 0x3f6b4b0c,0x3f5fe4e9,0x3f5233c6,0x3f425b89
.long 0x3f6a09a7,0x3f5df6be,0x3f4f7a1f,0x3f3ebc1b
.long 0x3f68bf3c,0x3f5bfb34,0x3f4cae79,0x3f3b0629
.long 0x3f676bd8,0x3f59f26a,0x3f49d112,0x3f373a23
.long 0x3f660f88,0x3f57dc7f,0x3f46e22a,0x3f33587a
.long 0x3f64aa59,0x3f55b993,0x3f43e200,0x3f2f61a5
.long 0x3f633c5a,0x3f5389c7,0x3f40d0da,0x3f2b561b
.long 0x3f61c598,0x3f514d3d,0x3f3daef9,0x3f273656
.long 0x3f604621,0x3f4f0417,0x3f3a7ca4,0x3f2302d3
.long 0x3f5ebe05,0x3f4cae79,0x3f373a23,0x3f1ebc12
.long 0x3f5d2d53,0x3f4a4c87,0x3f33e7bc,0x3f1a6293
.long 0x3f5b941a,0x3f47de65,0x3f3085bb,0x3f15f6d9
.long 0x3f59f26a,0x3f456439,0x3f2d1469,0x3f11796b
.long 0x3f584853,0x3f42de29,0x3f299415,0x3f0cead0
.long 0x3f5695e5,0x3f404c5c,0x3f26050a,0x3f084b92
.long 0x3f3504f3,0x3f226799,0x3f0e39da,0x3ef15aea
.long 0x3f3085bb,0x3f1ce11f,0x3f07a136,0x3ee1fb6a
.long 0x3f2beb4a,0x3f173c07,0x3f00e7e4,0x3ed25a09
.long 0x3f273656,0x3f11796b,0x3ef41f07,0x3ec27b55
.long 0x3f226799,0x3f0b9a6b,0x3ee63375,0x3eb263ef
.long 0x3f1d7fd1,0x3f05a02c,0x3ed8106b,0x3ea21887
.long 0x3f187fc0,0x3eff17b2,0x3ec9b953,0x3e919ddd
.long 0x3f13682a,0x3ef2bd43,0x3ebb31a0,0x3e80f8c0
.long 0x3f0e39da,0x3ee63375,0x3eac7cd4,0x3e605c13
.long 0x3f08f59b,0x3ed97cb9,0x3e9d9e78,0x3e3e853e
.long 0x3f039c3d,0x3ecc9b8b,0x3e8e9a22,0x3e1c76de
.long 0x3efc5d27,0x3ebf926f,0x3e7ee6e1,0x3df475c0
.long 0x3ef15aea,0x3eb263ef,0x3e605c13,0x3dafb680
.long 0x3ee63375,0x3ea5129f,0x3e419b37,0x3d55880e
.long 0x3edae880,0x3e97a117,0x3e22abb6,0x3c96c9b6
.long 0x3ecf7bca,0x3e8a11f7,0x3e039502,0xbc7b514b
.long 0x3ec3ef15,0x3e94a031,0x3e47c5c2,0x3dc8bd36
.long 0x3eb263ef,0x3e80f8c0,0x3e1c76de,0x3d55880e
.long 0x3ea09ae5,0x3e5a3997,0x3de1bc2e,0x3bc90f88
.long 0x3e8e9a22,0x3e3228d4,0x3d8a200a,0xbd2351cb
.long 0x3e78cfcc,0x3e09cf86,0x3cc90ab0,0xbdafb680
.long 0x3e541501,0x3dc27c39,0xbc96c9b6,0xbe06b26e
.long 0x3e2f10a2,0x3d621469,0xbd7b2b74,0xbe354098
.long 0x3e09cf86,0x3c7b514b,0xbdd53db9,0xbe636c83
.long 0x3dc8bd36,0xbcc90ab0,0xbe164083,0xbe888e93
.long 0x3d7b2b74,0xbd83db0a,0xbe419b37,0xbe9f1cdf
.long 0x3cc90ab0,0xbdd53db9,0xbe6c9a7f,0xbeb554ec
.long 0xbc490e90,0xbe1324ca,0xbe8b9507,0xbecb2aae
.long 0xbd48fb30,0xbe3b6ecf,0xbea09ae5,0xbee0924f
.long 0xbdafb680,0xbe636c83,0xbeb554ec,0xbef58035
.long 0xbdfab273,0xbe8586ce,0xbec9b953,0xbf04f484
.long 0xbe22abb6,0xbe9920fe,0xbeddbe79,0xbf0ee0db
.long 0x0,0x3dc8bd36,0x3e47c5c2,0x3e94a031
.long 0x0,0x3dcefdb7,0x3e4dee60,0x3e9920fe
.long 0x0,0x3dd53db9,0x3e541501,0x3e9d9e78
.long 0x0,0x3ddb7d37,0x3e5a3997,0x3ea21887
.long 0x0,0x3de1bc2e,0x3e605c13,0x3ea68f12
.long 0x0,0x3de7fa9a,0x3e667c66,0x3eab0201
.long 0x0,0x3dee3876,0x3e6c9a7f,0x3eaf713a
.long 0x0,0x3df475c0,0x3e72b651,0x3eb3dca5
.long 0x0,0x3dfab273,0x3e78cfcc,0x3eb8442a
.long 0x0,0x3e007745,0x3e7ee6e1,0x3ebca7af
.long 0x0,0x3e039502,0x3e827dc0,0x3ec1071e
.long 0x0,0x3e06b26e,0x3e8586ce,0x3ec5625c
.long 0x0,0x3e09cf86,0x3e888e93,0x3ec9b953
.long 0x0,0x3e0cec4a,0x3e8b9507,0x3ece0bea
.long 0x0,0x3e1008b7,0x3e8e9a22,0x3ed25a09
.long 0x0,0x3e1324ca,0x3e919ddd,0x3ed6a399
.long 0x3ec3ef15,0x3ef15aea,0x3f0e39da,0x3f226799
.long 0x3ec9b953,0x3ef840c8,0x3f121eb0,0x3f269de3
.long 0x3ecf7bca,0x3eff17b2,0x3f15f6d9,0x3f2ac082
.long 0x3ed53641,0x3f02ef9f,0x3f19c200,0x3f2ecef7
.long 0x3edae880,0x3f064b82,0x3f1d7fd1,0x3f32c8c9
.long 0x3ee0924f,0x3f099f4e,0x3f212ff9,0x3f36ad7f
.long 0x3ee63375,0x3f0cead0,0x3f24d225,0x3f3a7ca4
.long 0x3eebcbbb,0x3f102dd5,0x3f286605,0x3f3e35c5
.long 0x3ef15aea,0x3f13682a,0x3f2beb4a,0x3f41d870
.long 0x3ef6e0cb,0x3f16999f,0x3f2f61a5,0x3f456439
.long 0x3efc5d27,0x3f19c200,0x3f32c8c9,0x3f48d8b3
.long 0x3f00e7e4,0x3f1ce11f,0x3f36206c,0x3f4c3578
.long 0x3f039c3d,0x3f1ff6cb,0x3f396842,0x3f4f7a1f
.long 0x3f064b82,0x3f2302d3,0x3f3ca003,0x3f52a649
.long 0x3f08f59b,0x3f26050a,0x3f3fc767,0x3f55b993
.long 0x3f0b9a6b,0x3f28fd41,0x3f42de29,0x3f58b3a1
.long 0x3f3504f3,0x3f45e403,0x3f54db31,0x3f61c598
.long 0x3f396842,0x3f4a4c87,0x3f591e6a,0x3f65b710
.long 0x3f3daef9,0x3f4e8d90,0x3f5d2d53,0x3f696591
.long 0x3f41d870,0x3f52a649,0x3f6106f2,0x3f6cd007
.long 0x3f45e403,0x3f5695e5,0x3f64aa59,0x3f6ff573
.long 0x3f49d112,0x3f5a5ba0,0x3f6816a8,0x3f72d4eb
.long 0x3f4d9f02,0x3f5df6be,0x3f6b4b0c,0x3f756d97
.long 0x3f514d3d,0x3f61668a,0x3f6e46be,0x3f77beb7
.long 0x3f54db31,0x3f64aa59,0x3f710908,0x3f79c79d
.long 0x3f584853,0x3f67c187,0x3f73913f,0x3f7b87b2
.long 0x3f5b941a,0x3f6aab7b,0x3f75dec6,0x3f7cfe73
.long 0x3f5ebe05,0x3f6d67a1,0x3f77f110,0x3f7e2b72
.long 0x3f61c598,0x3f6ff573,0x3f79c79d,0x3f7f0e58
.long 0x3f64aa59,0x3f725470,0x3f7b61fc,0x3f7fa6e3
.long 0x3f676bd8,0x3f748422,0x3f7cbfc9,0x3f7ff4e6
.long 0x3f6a09a7,0x3f76841b,0x3f7de0b1,0x3f7ff84a
.long 0x3f6c835e,0x3f74fa0b,0x3f7b14be,0x3f7ec46d
.long 0x3f6ff573,0x3f77beb7,0x3f7cfe73,0x3f7fa6e3
.long 0x3f731447,0x3f7a1e84,0x3f7e70b0,0x3f7ffec4
.long 0x3f75dec6,0x3f7c187a,0x3f7f6ac7,0x3f7fcbe2
.long 0x3f7853f8,0x3f7dabcc,0x3f7fec43,0x3f7f0e58
.long 0x3f7a7302,0x3f7ed7d4,0x3f7ff4e6,0x3f7dc68c
.long 0x3f7c3b28,0x3f7f9c18,0x3f7f84ab,0x3f7bf531
.long 0x3f7dabcc,0x3f7ff84a,0x3f7e9bc9,0x3f799b43
.long 0x3f7ec46d,0x3f7fec43,0x3f7d3aac,0x3f76ba07
.long 0x3f7f84ab,0x3f7f7808,0x3f7b61fc,0x3f73530e
.long 0x3f7fec43,0x3f7e9bc9,0x3f791298,0x3f6f6830
.long 0x3f7ffb11,0x3f7d57de,0x3f764d97,0x3f6afb8c
.long 0x3f7fb10f,0x3f7baccd,0x3f731447,0x3f660f88
.long 0x3f7f0e58,0x3f799b43,0x3f6f6830,0x3f60a6cf
.long 0x3f7e1324,0x3f772417,0x3f6b4b0c,0x3f5ac450
.long 0x3f7cbfc9,0x3f74484b,0x3f66becc,0x3f546b3b
.long 0x248d3132,0xbdc8bd36,0xbe47c5c2,0xbe94a031
.long 0xbd48fb30,0xbe195be0,0xbe7ee6e1,0xbeb0eacb
.long 0xbdc8bd36,0xbe4dee60,0xbe9aa086,0xbecc9b8b
.long 0xbe164083,0xbe80f8c0,0xbeb554ec,0xbee79a5d
.long 0xbe47c5c2,0xbe9aa086,0xbecf7bca,0xbf00e7e4
.long 0xbe78cfcc,0xbeb3dca5,0xbee900b7,0xbf0d9281
.long 0xbe94a031,0xbecc9b8b,0xbf00e7e4,0xbf19c200
.long 0xbeac7cd4,0xbee4cbfe,0xbf0cead0,0xbf256bcb
.long 0xbec3ef15,0xbefc5d27,0xbf187fc0,0xbf3085bb
.long 0xbedae880,0xbf099f4e,0xbf239da9,0xbf3b0629
.long 0xbef15aea,0xbf14b039,0xbf2e3bde,0xbf44e3f5
.long 0xbf039c3d,0xbf1f599f,0xbf385216,0xbf4e1689
.long 0xbf0e39da,0xbf299415,0xbf41d870,0xbf5695e5
.long 0xbf187fc0,0xbf33587a,0xbf4ac77f,0xbf5e5aa6
.long 0xbf226799,0xbf3ca003,0xbf531849,0xbf655e0b
.long 0xbf2beb4a,0xbf456439,0xbf5ac450,0xbf6b99fb
.long 0xbec3ef15,0xbef15aea,0xbf0e39da,0xbf226799
.long 0xbee0924f,0xbf06f686,0xbf1c420c,0xbf2ff3e6
.long 0xbefc5d27,0xbf14b039,0xbf299415,0xbf3ca003
.long 0xbf0b9a6b,0xbf21cbfb,0xbf36206c,0xbf485bca
.long 0xbf187fc0,0xbf2e3bde,0xbf41d870,0xbf531849
.long 0xbf24d225,0xbf39f2ac,0xbf4cae79,0xbf5cc7d1
.long 0xbf3085bb,0xbf44e3f5,0xbf5695e5,0xbf655e0b
.long 0xbf3b8f3b,0xbf4f0417,0xbf5f8327,0xbf6cd007
.long 0xbf45e403,0xbf584853,0xbf676bd8,0xbf731447
.long 0xbf4f7a1f,0xbf60a6cf,0xbf6e46be,0xbf7822d1
.long 0xbf584853,0xbf6816a8,0xbf740bdd,0xbf7bf531
.long 0xbf604621,0xbf6e8ff8,0xbf78b47b,0xbf7e868b
.long 0xbf676bd8,0xbf740bdd,0xbf7c3b28,0xbf7fd397
.long 0xbf6db293,0xbf788486,0xbf7e9bc9,0xbf7fdaaf
.long 0xbf731447,0xbf7bf531,0xbf7fd397,0xbf7e9bc9
.long 0xbf778bc5,0xbf7e5a38,0xbf7fe129,0xbf7c187a
.long 0xbf3504f3,0xbf45e403,0xbf54db31,0xbf61c598
.long 0xbf41d870,0xbf51c0c2,0xbf5f8327,0xbf6afb8c
.long 0xbf4d9f02,0xbf5c61c7,0xbf68bf3c,0xbf7294f8
.long 0xbf584853,0xbf65b710,0xbf708066,0xbf788486
.long 0xbf61c598,0xbf6db293,0xbf76ba07,0xbf7cbfc9
.long 0xbf6a09a7,0xbf74484b,0xbf7b61fc,0xbf7f3f54
.long 0xbf710908,0xbf796e4e,0xbf7e70b0,0xbf7ffec4
.long 0xbf76ba07,0xbf7d1cdd,0xbf7fe129,0xbf7efcc9
.long 0xbf7b14be,0xbf7f4e6d,0xbf7fb10f,0xbf7c3b28
.long 0xbf7e1324,0xbf7fffb1,0xbf7de0b1,0xbf77beb7
.long 0xbf7fb10f,0xbf7f2f9d,0xbf7a7302,0xbf718f57
.long 0xbf7fec43,0xbf7cdf6c,0xbf756d97,0xbf69b7e4
.long 0xbf7ec46d,0xbf791298,0xbf6ed89e,0xbf604621
.long 0xbf7c3b28,0xbf73ced9,0xbf66becc,0xbf554aa4
.long 0xbf7853f8,0xbf6d1c1d,0xbf5d2d53,0xbf48d8b3
.long 0xbf731447,0xbf650479,0xbf5233c6,0xbf3b0629
.long 0xbf6c835e,0xbf74fa0b,0xbf7b14be,0xbf7ec46d
.long 0xbf740bdd,0xbf7a9c59,0xbf7e9bc9,0xbf7fffb1
.long 0xbf79c79d,0xbf7e4323,0xbf7ffb11,0xbf7eea9d
.long 0xbf7dabcc,0xbf7fe705,0xbf7f2f9d,0xbf7b87b2
.long 0xbf7fb10f,0xbf7f84ab,0xbf7c3b28,0xbf75dec6
.long 0xbf7fd397,0xbf7d1cdd,0xbf772417,0xbf6dfcf2
.long 0xbf7e1324,0xbf78b47b,0xbf6ff573,0xbf63f473
.long 0xbf7a7302,0xbf725470,0xbf66becc,0xbf57dc7f
.long 0xbf74fa0b,0xbf6a09a7,0xbf5b941a,0xbf49d112
.long 0xbf6db293,0xbf5fe4e9,0xbf4e8d90,0xbf39f2ac
.long 0xbf64aa59,0xbf53fac3,0xbf3fc767,0xbf286605
.long 0xbf59f26a,0xbf466354,0xbf2f61a5,0xbf1553b7
.long 0xbf4d9f02,0xbf373a23,0xbf1d7fd1,0xbf00e7e4
.long 0xbf3fc767,0xbf269de3,0xbf0a48ad,0xbed6a399
.long 0xbf3085bb,0xbf14b039,0xbeebcbbb,0xbea986c4
.long 0xbf1ff6cb,0xbf019573,0xbec1071e,0xbe75c35a
.long 0x3f800000,0x3f7ec46d,0x3f7b14be,0x3f74fa0b
.long 0x3f7fb10f,0x3f7d1cdd,0x3f77f110,0x3f703b37
.long 0x3f7ec46d,0x3f7ac516,0x3f740bdd,0x3f6aab7b
.long 0x3f7d3aac,0x3f77beb7,0x3f6f6830,0x3f644fac
.long 0x3f7b14be,0x3f740bdd,0x3f6a09a7,0x3f5d2d53
.long 0x3f7853f8,0x3f6faf1b,0x3f63f473,0x3f554aa4
.long 0x3f74fa0b,0x3f6aab7b,0x3f5d2d53,0x3f4cae79
.long 0x3f710908,0x3f650479,0x3f55b993,0x3f436051
.long 0x3f6c835e,0x3f5ebe05,0x3f4d9f02,0x3f396842
.long 0x3f676bd8,0x3f57dc7f,0x3f44e3f5,0x3f2ecef7
.long 0x3f61c598,0x3f5064af,0x3f3b8f3b,0x3f239da9
.long 0x3f5b941a,0x3f485bca,0x3f31a81d,0x3f17de12
.long 0x3f54db31,0x3f3fc767,0x3f273656,0x3f0b9a6b
.long 0x3f4d9f02,0x3f36ad7f,0x3f1c420c,0x3efdbabb
.long 0x3f45e403,0x3f2d1469,0x3f10d3cd,0x3ee363fa
.long 0x3f3daef9,0x3f2302d3,0x3f04f484,0x3ec8477c
.long 0x3f6c835e,0x3f61c598,0x3f54db31,0x3f45e403
.long 0x3f660f88,0x3f5988ad,0x3f4ac77f,0x3f39f2ac
.long 0x3f5ebe05,0x3f5064af,0x3f3fc767,0x3f2d1469
.long 0x3f5695e5,0x3f466354,0x3f33e7bc,0x3f1f599f
.long 0x3f4d9f02,0x3f3b8f3b,0x3f273656,0x3f10d3cd
.long 0x3f43e200,0x3f2ff3e6,0x3f19c200,0x3f019573
.long 0x3f396842,0x3f239da9,0x3f0b9a6b,0x3ee363fa
.long 0x3f2e3bde,0x3f16999f,0x3ef9a02d,0x3ec27b55
.long 0x3f226799,0x3f08f59b,0x3edae880,0x3ea09ae5
.long 0x3f15f6d9,0x3ef58035,0x3ebb31a0,0x3e7bdba4
.long 0x3f08f59b,0x3ed8106b,0x3e9aa086,0x3e354098
.long 0x3ef6e0cb,0x3eb9bb1e,0x3e72b651,0x3ddb7d37
.long 0x3edae880,0x3e9aa086,0x3e2f10a2,0x3d16c32c
.long 0x3ebe1d4a,0x3e75c35a,0x3dd53db9,0xbd0a342f
.long 0x3ea09ae5,0x3e354098,0x3d16c32c,0xbdd53db9
.long 0x3e827dc0,0x3de7fa9a,0xbcfb49ba,0xbe3228d4
.long 0x3f3504f3,0x3f226799,0x3f0e39da,0x3ef15aea
.long 0x3f273656,0x3f12c39a,0x3ef9a02d,0x3ecb2aae
.long 0x3f187fc0,0x3f0242b1,0x3ed53641,0x3ea395c5
.long 0x3f08f59b,0x3ee1fb6a,0x3eaf713a,0x3e75c35a
.long 0x3ef15aea,0x3ebe1d4a,0x3e888e93,0x3e22abb6
.long 0x3ecf7bca,0x3e9920fe,0x3e419b37,0x3d9cecf9
.long 0x3eac7cd4,0x3e667c66,0x3de1bc2e,0xbbc90f88
.long 0x3e888e93,0x3e195be0,0x3cfb49ba,0xbdb5f8da
.long 0x3e47c5c2,0x3d96a905,0xbd48fb30,0xbe2f10a2
.long 0x3dfab273,0xbb490fc6,0xbe039502,0xbe80f8c0
.long 0x3d48fb30,0xbda3308c,0xbe541501,0xbea986c4
.long 0xbcc90ab0,0xbe1f917b,0xbe919ddd,0xbed0eb2a
.long 0xbdc8bd36,0xbe6c9a7f,0xbeb8442a,0xbef6e0cb
.long 0xbe2f10a2,0xbe9c1faf,0xbeddbe79,0xbf0d9281
.long 0xbe78cfcc,0xbec1071e,0xbf00e7e4,0xbf1ebc12
.long 0xbea09ae5,0xbee4cbfe,0xbf121eb0,0xbf2ecef7
.long 0x3ec3ef15,0x3e94a031,0x3e47c5c2,0x3dc8bd36
.long 0x3e9aa086,0x3e5101f1,0x3dd53db9,0x3b490fc6
.long 0x3e605c13,0x3dee3876,0x3c490e90,0xbdbc3ac3
.long 0x3e09cf86,0x3ce22a7a,0xbda3308c,0xbe3e853e
.long 0x3d48fb30,0xbd7b2b74,0xbe2f10a2,0xbe8e9a22
.long 0xbd16c32c,0xbe195be0,0xbe8586ce,0xbebca7af
.long 0xbdfab273,0xbe72b651,0xbeb263ef,0xbee900b7
.long 0xbe541501,0xbea5129f,0xbeddbe79,0xbf099f4e
.long 0xbe94a031,0xbecf7bca,0xbf039c3d,0xbf1d7fd1
.long 0xbebe1d4a,0xbef840c8,0xbf173c07,0xbf2ff3e6
.long 0xbee63375,0xbf0f8784,0xbf299415,0xbf40d0da
.long 0xbf064b82,0xbf21cbfb,0xbf3a7ca4,0xbf4fefa8
.long 0xbf187fc0,0xbf32c8c9,0xbf49d112,0xbf5d2d53
.long 0xbf299415,0xbf425b89,0xbf577026,0xbf686b39
.long 0xbf396842,0xbf5064af,0xbf633c5a,0xbf718f57
.long 0xbf47de65,0xbf5cc7d1,0xbf6d1c1d,0xbf788486
.long 0x3f800000,0x3f7d3aac,0x3f74fa0b,0x3f676bd8
.long 0x3f800000,0x3f7d1cdd,0x3f748422,0x3f666771
.long 0x3f800000,0x3f7cfe73,0x3f740bdd,0x3f655e0b
.long 0x3f800000,0x3f7cdf6c,0x3f73913f,0x3f644fac
.long 0x3f800000,0x3f7cbfc9,0x3f731447,0x3f633c5a
.long 0x3f800000,0x3f7c9f8a,0x3f7294f8,0x3f62241a
.long 0x3f800000,0x3f7c7eb0,0x3f721352,0x3f6106f2
.long 0x3f800000,0x3f7c5d3a,0x3f718f57,0x3f5fe4e9
.long 0x3f800000,0x3f7c3b28,0x3f710908,0x3f5ebe05
.long 0x3f800000,0x3f7c187a,0x3f708066,0x3f5d924d
.long 0x3f800000,0x3f7bf531,0x3f6ff573,0x3f5c61c7
.long 0x3f800000,0x3f7bd14d,0x3f6f6830,0x3f5b2c79
.long 0x3f800000,0x3f7baccd,0x3f6ed89e,0x3f59f26a
.long 0x3f800000,0x3f7b87b2,0x3f6e46be,0x3f58b3a1
.long 0x3f800000,0x3f7b61fc,0x3f6db293,0x3f577026
.long 0x3f800000,0x3f7b3bab,0x3f6d1c1d,0x3f5627fe
.long 0x3f54db31,0x3f3daef9,0x3f226799,0x3f039c3d
.long 0x3f531849,0x3f3b0629,0x3f1ebc12,0x3efdbabb
.long 0x3f514d3d,0x3f385216,0x3f1b02c6,0x3ef41f07
.long 0x3f4f7a1f,0x3f3592e7,0x3f173c07,0x3eea6681
.long 0x3f4d9f02,0x3f32c8c9,0x3f13682a,0x3ee0924f
.long 0x3f4bbbf8,0x3f2ff3e6,0x3f0f8784,0x3ed6a399
.long 0x3f49d112,0x3f2d1469,0x3f0b9a6b,0x3ecc9b8b
.long 0x3f47de65,0x3f2a2a80,0x3f07a136,0x3ec27b55
.long 0x3f45e403,0x3f273656,0x3f039c3d,0x3eb8442a
.long 0x3f43e200,0x3f24381a,0x3eff17b2,0x3eadf73c
.long 0x3f41d870,0x3f212ff9,0x3ef6e0cb,0x3ea395c5
.long 0x3f3fc767,0x3f1e1e22,0x3eee9479,0x3e9920fe
.long 0x3f3daef9,0x3f1b02c6,0x3ee63375,0x3e8e9a22
.long 0x3f3b8f3b,0x3f17de12,0x3eddbe79,0x3e840270
.long 0x3f396842,0x3f14b039,0x3ed53641,0x3e72b651
.long 0x3f373a23,0x3f11796b,0x3ecc9b8b,0x3e5d4b1a
.long 0x3ec3ef15,0x3e78cfcc,0x3dc8bd36,0xbd48fb30
.long 0x3eb8442a,0x3e5d4b1a,0x3d8a200a,0xbda973ba
.long 0x3eac7cd4,0x3e419b37,0x3d16c32c,0xbdee3876
.long 0x3ea09ae5,0x3e25c58c,0x3bc90f88,0xbe195be0
.long 0x3e94a031,0x3e09cf86,0xbcc90ab0,0xbe3b6ecf
.long 0x3e888e93,0x3ddb7d37,0xbd621469,0xbe5d4b1a
.long 0x3e78cfcc,0x3da3308c,0xbdafb680,0xbe7ee6e1
.long 0x3e605c13,0x3d55880e,0xbdee3876,0xbe901c2c
.long 0x3e47c5c2,0x3cc90ab0,0xbe164083,0xbea09ae5
.long 0x3e2f10a2,0xbb490fc6,0xbe354098,0xbeb0eacb
.long 0x3e164083,0xbcfb49ba,0xbe541501,0xbec1071e
.long 0x3dfab273,0xbd6ea038,0xbe72b651,0xbed0eb2a
.long 0x3dc8bd36,0xbdafb680,0xbe888e93,0xbee0924f
.long 0x3d96a905,0xbde7fa9a,0xbe97a117,0xbeeff7fb
.long 0x3d48fb30,0xbe1008b7,0xbea68f12,0xbeff17b2
.long 0x3cc90ab0,0xbe2bf804,0xbeb554ec,0xbf06f686
.long 0xbe47c5c2,0xbeac7cd4,0xbef15aea,0xbf187fc0
.long 0xbe6c9a7f,0xbebf926f,0xbf0242b1,0xbf21cbfb
.long 0xbe888e93,0xbed25a09,0xbf0b9a6b,0xbf2ac082
.long 0xbe9aa086,0xbee4cbfe,0xbf14b039,0xbf33587a
.long 0xbeac7cd4,0xbef6e0cb,0xbf1d7fd1,0xbf3b8f3b
.long 0xbebe1d4a,0xbf044889,0xbf26050a,0xbf436051
.long 0xbecf7bca,0xbf0cead0,0xbf2e3bde,0xbf4ac77f
.long 0xbee0924f,0xbf1553b7,0xbf36206c,0xbf51c0c2
.long 0xbef15aea,0xbf1d7fd1,0xbf3daef9,0xbf584853
.long 0xbf00e7e4,0xbf256bcb,0xbf44e3f5,0xbf5e5aa6
.long 0xbf08f59b,0xbf2d1469,0xbf4bbbf8,0xbf63f473
.long 0xbf10d3cd,0xbf34768f,0xbf5233c6,0xbf6912ae
.long 0xbf187fc0,0xbf3b8f3b,0xbf584853,0xbf6db293
.long 0xbf1ff6cb,0xbf425b89,0xbf5df6be,0xbf71d19f
.long 0xbf273656,0xbf48d8b3,0xbf633c5a,0xbf756d97
.long 0xbf2e3bde,0xbf4f0417,0xbf6816a8,0xbf788486
.long 0x0,0x3e164083,0x3e94a031,0x3edae880
.long 0x0,0x3e195be0,0x3e97a117,0x3edf28a9
.long 0x0,0x3e1c76de,0x3e9aa086,0x3ee363fa
.long 0x0,0x3e1f917b,0x3e9d9e78,0x3ee79a5d
.long 0x0,0x3e22abb6,0x3ea09ae5,0x3eebcbbb
.long 0x0,0x3e25c58c,0x3ea395c5,0x3eeff7fb
.long 0x0,0x3e28defc,0x3ea68f12,0x3ef41f07
.long 0x0,0x3e2bf804,0x3ea986c4,0x3ef840c8
.long 0x0,0x3e2f10a2,0x3eac7cd4,0x3efc5d27
.long 0x0,0x3e3228d4,0x3eaf713a,0x3f003a06
.long 0x0,0x3e354098,0x3eb263ef,0x3f0242b1
.long 0x0,0x3e3857ec,0x3eb554ec,0x3f044889
.long 0x0,0x3e3b6ecf,0x3eb8442a,0x3f064b82
.long 0x0,0x3e3e853e,0x3ebb31a0,0x3f084b92
.long 0x0,0x3e419b37,0x3ebe1d4a,0x3f0a48ad
.long 0x0,0x3e44b0b9,0x3ec1071e,0x3f0c42c9
.long 0x3f0e39da,0x3f2beb4a,0x3f45e403,0x3f5b941a
.long 0x3f10d3cd,0x3f2ecef7,0x3f48d8b3,0x3f5e5aa6
.long 0x3f13682a,0x3f31a81d,0x3f4bbbf8,0x3f6106f2
.long 0x3f15f6d9,0x3f34768f,0x3f4e8d90,0x3f6398ac
.long 0x3f187fc0,0x3f373a23,0x3f514d3d,0x3f660f88
.long 0x3f1b02c6,0x3f39f2ac,0x3f53fac3,0x3f686b39
.long 0x3f1d7fd1,0x3f3ca003,0x3f5695e5,0x3f6aab7b
.long 0x3f1ff6cb,0x3f3f41fc,0x3f591e6a,0x3f6cd007
.long 0x3f226799,0x3f41d870,0x3f5b941a,0x3f6ed89e
.long 0x3f24d225,0x3f446337,0x3f5df6be,0x3f70c501
.long 0x3f273656,0x3f46e22a,0x3f604621,0x3f7294f8
.long 0x3f299415,0x3f495521,0x3f628210,0x3f74484b
.long 0x3f2beb4a,0x3f4bbbf8,0x3f64aa59,0x3f75dec6
.long 0x3f2e3bde,0x3f4e1689,0x3f66becc,0x3f77583a
.long 0x3f3085bb,0x3f5064af,0x3f68bf3c,0x3f78b47b
.long 0x3f32c8c9,0x3f52a649,0x3f6aab7b,0x3f79f35e
.long 0x3f6c835e,0x3f7853f8,0x3f7ec46d,0x3f7fb10f
.long 0x3f6ed89e,0x3f79f35e,0x3f7f6ac7,0x3f7f1f49
.long 0x3f710908,0x3f7b61fc,0x3f7fd397,0x3f7e4323
.long 0x3f731447,0x3f7c9f8a,0x3f7ffec4,0x3f7d1cdd
.long 0x3f74fa0b,0x3f7dabcc,0x3f7fec43,0x3f7baccd
.long 0x3f76ba07,0x3f7e868b,0x3f7f9c18,0x3f79f35e
.long 0x3f7853f8,0x3f7f2f9d,0x3f7f0e58,0x3f77f110
.long 0x3f79c79d,0x3f7fa6e3,0x3f7e4323,0x3f75a67b
.long 0x3f7b14be,0x3f7fec43,0x3f7d3aac,0x3f731447
.long 0x3f7c3b28,0x3f7fffb1,0x3f7bf531,0x3f703b37
.long 0x3f7d3aac,0x3f7fe129,0x3f7a7302,0x3f6d1c1d
.long 0x3f7e1324,0x3f7f90b1,0x3f78b47b,0x3f69b7e4
.long 0x3f7ec46d,0x3f7f0e58,0x3f76ba07,0x3f660f88
.long 0x3f7f4e6d,0x3f7e5a38,0x3f748422,0x3f62241a
.long 0x3f7fb10f,0x3f7d7474,0x3f721352,0x3f5df6be
.long 0x3f7fec43,0x3f7c5d3a,0x3f6f6830,0x3f5988ad
.long 0x3f7b14be,0x3f710908,0x3f61c598,0x3f4d9f02
.long 0x3f791298,0x3f6d67a1,0x3f5c61c7,0x3f466354
.long 0x3f76ba07,0x3f696591,0x3f5695e5,0x3f3ebc1b
.long 0x3f740bdd,0x3f650479,0x3f5064af,0x3f36ad7f
.long 0x3f710908,0x3f604621,0x3f49d112,0x3f2e3bde
.long 0x3f6db293,0x3f5b2c79,0x3f42de29,0x3f256bcb
.long 0x3f6a09a7,0x3f55b993,0x3f3b8f3b,0x3f1c420c
.long 0x3f660f88,0x3f4fefa8,0x3f33e7bc,0x3f12c39a
.long 0x3f61c598,0x3f49d112,0x3f2beb4a,0x3f08f59b
.long 0x3f5d2d53,0x3f436051,0x3f239da9,0x3efdbabb
.long 0x3f584853,0x3f3ca003,0x3f1b02c6,0x3ee900b7
.long 0x3f531849,0x3f3592e7,0x3f121eb0,0x3ed3c867
.long 0x3f4d9f02,0x3f2e3bde,0x3f08f59b,0x3ebe1d4a
.long 0x3f47de65,0x3f269de3,0x3eff17b2,0x3ea80b1f
.long 0x3f41d870,0x3f1ebc12,0x3eebcbbb,0x3e919ddd
.long 0x3f3b8f3b,0x3f16999f,0x3ed8106b,0x3e75c35a
.long 0xbf3504f3,0xbf4d9f02,0xbf61c598,0xbf710908
.long 0xbf3daef9,0xbf554aa4,0xbf6816a8,0xbf75a67b
.long 0xbf45e403,0xbf5c61c7,0xbf6db293,0xbf796e4e
.long 0xbf4d9f02,0xbf62df7b,0xbf7294f8,0xbf7c5d3a
.long 0xbf54db31,0xbf68bf3c,0xbf76ba07,0xbf7e70b0
.long 0xbf5b941a,0xbf6dfcf2,0xbf7a1e84,0xbf7fa6e3
.long 0xbf61c598,0xbf7294f8,0xbf7cbfc9,0xbf7ffec4
.long 0xbf676bd8,0xbf76841b,0xbf7e9bc9,0xbf7f7808
.long 0xbf6c835e,0xbf79c79d,0xbf7fb10f,0xbf7e1324
.long 0xbf710908,0xbf7c5d3a,0xbf7ffec4,0xbf7bd14d
.long 0xbf74fa0b,0xbf7e4323,0xbf7f84ab,0xbf78b47b
.long 0xbf7853f8,0xbf7f7808,0xbf7e4323,0xbf74bf62
.long 0xbf7b14be,0xbf7ffb11,0xbf7c3b28,0xbf6ff573
.long 0xbf7d3aac,0xbf7fcbe2,0xbf796e4e,0xbf6a5ad9
.long 0xbf7ec46d,0xbf7eea9d,0xbf75dec6,0xbf63f473
.long 0xbf7fb10f,0xbf7d57de,0xbf718f57,0xbf5cc7d1
.long 0xbf7b14be,0xbf7fb10f,0xbf7ec46d,0xbf7853f8
.long 0xbf7dabcc,0xbf7ff84a,0xbf7c7eb0,0xbf73530e
.long 0xbf7f4e6d,0xbf7f2f9d,0xbf791298,0xbf6d1c1d
.long 0xbf7ffb11,0xbf7d57de,0xbf748422,0xbf65b710
.long 0xbf7fb10f,0xbf7a7302,0xbf6ed89e,0xbf5d2d53
.long 0xbf7e70b0,0xbf76841b,0xbf6816a8,0xbf5389c7
.long 0xbf7c3b28,0xbf718f57,0xbf604621,0xbf48d8b3
.long 0xbf791298,0xbf6b99fb,0xbf577026,0xbf3d27b8
.long 0xbf74fa0b,0xbf64aa59,0xbf4d9f02,0xbf3085bb
.long 0xbf6ff573,0xbf5cc7d1,0xbf42de29,0xbf2302d3
.long 0xbf6a09a7,0xbf53fac3,0xbf373a23,0xbf14b039
.long 0xbf633c5a,0xbf4a4c87,0xbf2ac082,0xbf05a02c
.long 0xbf5b941a,0xbf3fc767,0xbf1d7fd1,0xbeebcbbb
.long 0xbf531849,0xbf34768f,0xbf0f8784,0xbecb2aae
.long 0xbf49d112,0xbf286605,0xbf00e7e4,0xbea986c4
.long 0xbf3fc767,0xbf1ba299,0xbee363fa,0xbe870ada
.long 0xbf6c835e,0xbf5b941a,0xbf45e403,0xbf2beb4a
.long 0xbf64aa59,0xbf50d937,0xbf385216,0xbf1ba299
.long 0xbf5b941a,0xbf44e3f5,0xbf299415,0xbf0a48ad
.long 0xbf514d3d,0xbf37c655,0xbf19c200,0xbeeff7fb
.long 0xbf45e403,0xbf299415,0xbf08f59b,0xbec9b953
.long 0xbf396842,0xbf1a6293,0xbeee9479,0xbea21887
.long 0xbf2beb4a,0xbf0a48ad,0xbec9b953,0xbe72b651
.long 0xbf1d7fd1,0xbef2bd43,0xbea395c5,0xbe1f917b
.long 0xbf0e39da,0xbecf7bca,0xbe78cfcc,0xbd96a905
.long 0xbefc5d27,0xbeab0201,0xbe28defc,0x3c16cb58
.long 0xbedae880,0xbe8586ce,0xbdafb680,0x3dbc3ac3
.long 0xbeb8442a,0xbe3e853e,0xbbc90f88,0x3e3228d4
.long 0xbe94a031,0xbde1bc2e,0x3d96a905,0x3e827dc0
.long 0xbe605c13,0xbd0a342f,0x3e1c76de,0x3eab0201
.long 0xbe164083,0x3d2fe007,0x3e6c9a7f,0x3ed25a09
.long 0xbd96a905,0x3df475c0,0x3e9d9e78,0x3ef840c8
.long 0xbf0e39da,0xbedae880,0xbe94a031,0xbe164083
.long 0xbef6e0cb,0xbeb0eacb,0xbe4dee60,0xbd55880e
.long 0xbecf7bca,0xbe8586ce,0xbde1bc2e,0x3d2fe007
.long 0xbea68f12,0xbe3228d4,0xbc96c9b6,0x3e0cec4a
.long 0xbe78cfcc,0xbdafb680,0x3d96a905,0x3e6c9a7f
.long 0xbe22abb6,0x3b490fc6,0x3e28defc,0x3ea5129f
.long 0xbd96a905,0x3dbc3ac3,0x3e827dc0,0x3ed25a09
.long 0x3c490e90,0x3e3857ec,0x3eaf713a,0x3efdbabb
.long 0x3dc8bd36,0x3e888e93,0x3edae880,0x3f13682a
.long 0x3e3b6ecf,0x3eb3dca5,0x3f0242b1,0x3f269de3
.long 0x3e888e93,0x3eddbe79,0x3f15f6d9,0x3f385216
.long 0x3eb263ef,0x3f02ef9f,0x3f286605,0x3f485bca
.long 0x3edae880,0x3f15f6d9,0x3f396842,0x3f5695e5
.long 0x3f00e7e4,0x3f27ce61,0x3f48d8b3,0x3f62df7b
.long 0x3f13682a,0x3f385216,0x3f5695e5,0x3f6d1c1d
.long 0x3f24d225,0x3f476085,0x3f628210,0x3f75341d
.long 0x3f3504f3,0x3f187fc0,0x3ef15aea,0x3eac7cd4
.long 0x3f2beb4a,0x3f0d9281,0x3ed8106b,0x3e901c2c
.long 0x3f226799,0x3f0242b1,0x3ebe1d4a,0x3e667c66
.long 0x3f187fc0,0x3eed3063,0x3ea395c5,0x3e2bf804
.long 0x3f0e39da,0x3ed53641,0x3e888e93,0x3de1bc2e
.long 0x3f039c3d,0x3ebca7af,0x3e5a3997,0x3d55880e
.long 0x3ef15aea,0x3ea395c5,0x3e22abb6,0xbbc90f88
.long 0x3edae880,0x3e8a11f7,0x3dd53db9,0xbd83db0a
.long 0x3ec3ef15,0x3e605c13,0x3d48fb30,0xbdfab273
.long 0x3eac7cd4,0x3e2bf804,0xbbc90f88,0xbe3857ec
.long 0x3e94a031,0x3dee3876,0xbd7b2b74,0xbe72b651
.long 0x3e78cfcc,0x3d83db0a,0xbdee3876,0xbe9620d2
.long 0x3e47c5c2,0x3c490e90,0xbe2f10a2,0xbeb263ef
.long 0x3e164083,0xbd2351cb,0xbe667c66,0xbece0bea
.long 0x3dc8bd36,0xbdbc3ac3,0xbe8e9a22,0xbee900b7
.long 0x3d48fb30,0xbe1324ca,0xbea986c4,0xbf019573
.long 0x3e47c5c2,0x3d48fb30,0xbdc8bd36,0xbe78cfcc
.long 0x3e09cf86,0xbc7b514b,0xbe28defc,0xbe9f1cdf
.long 0x3d96a905,0xbda3308c,0xbe6c9a7f,0xbec1071e
.long 0x3c490e90,0xbe1324ca,0xbe97a117,0xbee1fb6a
.long 0xbd48fb30,0xbe541501,0xbeb8442a,0xbf00e7e4
.long 0xbde1bc2e,0xbe8a11f7,0xbed8106b,0xbf102dd5
.long 0xbe2f10a2,0xbea986c4,0xbef6e0cb,0xbf1ebc12
.long 0xbe6c9a7f,0xbec8477c,0xbf0a48ad,0xbf2c800f
.long 0xbe94a031,0xbee63375,0xbf187fc0,0xbf396842
.long 0xbeb263ef,0xbf019573,0xbf26050a,0xbf456439
.long 0xbecf7bca,0xbf0f8784,0xbf32c8c9,0xbf5064af
.long 0xbeebcbbb,0xbf1ce11f,0xbf3ebc1b,0xbf5a5ba0
.long 0xbf039c3d,0xbf299415,0xbf49d112,0xbf633c5a
.long 0xbf10d3cd,0xbf3592e7,0xbf53fac3,0xbf6afb8c
.long 0xbf1d7fd1,0xbf40d0da,0xbf5d2d53,0xbf718f57
.long 0xbf299415,0xbf4b41fa,0xbf655e0b,0xbf76ef5b
.long 0xbec3ef15,0xbf039c3d,0xbf226799,0xbf3daef9
.long 0xbee63375,0xbf140c5f,0xbf31a81d,0xbf4b41fa
.long 0xbf039c3d,0xbf239da9,0xbf3fc767,0xbf577026
.long 0xbf13682a,0xbf3238aa,0xbf4cae79,0xbf62241a
.long 0xbf226799,0xbf3fc767,0xbf584853,0xbf6b4b0c
.long 0xbf3085bb,0xbf4c3578,0xbf628210,0xbf72d4eb
.long 0xbf3daef9,0xbf577026,0xbf6b4b0c,0xbf78b47b
.long 0xbf49d112,0xbf61668a,0xbf7294f8,0xbf7cdf6c
.long 0xbf54db31,0xbf6a09a7,0xbf7853f8,0xbf7f4e6d
.long 0xbf5ebe05,0xbf714c7a,0xbf7c7eb0,0xbf7ffd39
.long 0xbf676bd8,0xbf772417,0xbf7f0e58,0xbf7eea9d
.long 0xbf6ed89e,0xbf7b87b2,0xbf7ffec4,0xbf7c187a
.long 0xbf74fa0b,0xbf7e70b0,0xbf7f4e6d,0xbf778bc5
.long 0xbf79c79d,0xbf7fdaaf,0xbf7cfe73,0xbf714c7a
.long 0xbf7d3aac,0xbf7fc38f,0xbf791298,0xbf696591
.long 0xbf7f4e6d,0xbf7e2b72,0xbf73913f,0xbf5fe4e9
.long 0xbf54db31,0xbf676bd8,0xbf74fa0b,0xbf7d3aac
.long 0xbf604621,0xbf703b37,0xbf7ac516,0xbf7fa6e3
.long 0xbf6a09a7,0xbf772417,0xbf7e70b0,0xbf7fc38f
.long 0xbf721352,0xbf7c187a,0xbf7ff4e6,0xbf7d906e
.long 0xbf7853f8,0xbf7f0e58,0xbf7f4e6d,0xbf791298
.long 0xbf7cbfc9,0xbf7fffb1,0xbf7c7eb0,0xbf725470
.long 0xbf7f4e6d,0xbf7eea9d,0xbf778bc5,0xbf696591
.long 0xbf7ffb11,0xbf7bd14d,0xbf708066,0xbf5e5aa6
.long 0xbf7ec46d,0xbf76ba07,0xbf676bd8,0xbf514d3d
.long 0xbf7baccd,0xbf6faf1b,0xbf5c61c7,0xbf425b89
.long 0xbf76ba07,0xbf66becc,0xbf4f7a1f,0xbf31a81d
.long 0xbf6ff573,0xbf5bfb34,0xbf40d0da,0xbf1f599f
.long 0xbf676bd8,0xbf4f7a1f,0xbf3085bb,0xbf0b9a6b
.long 0xbf5d2d53,0xbf4154e1,0xbf1ebc12,0xbeed3063
.long 0xbf514d3d,0xbf31a81d,0xbf0b9a6b,0xbec1071e
.long 0xbf43e200,0xbf209393,0xbeee9479,0xbe931f35
.size TABS, .-TABS
.text
```
